```python
import torch

def _softmax(x, axis=-1):
    return torch.softmax(x, dim=axis)

def _gelu(x):
    return torch.nn.functional.gelu(x, approximate='tanh')

def _silu(x):
    return torch.nn.functional.silu(x)

def _sigmoid(x):
    return torch.sigmoid(x)

def _layernorm(x, axis=-1, eps=1e-05):
    m = x.mean(dim=axis, keepdim=True)
    v = x.var(dim=axis, keepdim=True, unbiased=False)
    return (x - m) / torch.sqrt(v + eps)

def _scatter_add(tgt, idx, src, axis=0):
    return tgt.clone().index_add_(axis, idx, src)

def _segment_sum(src, seg, n):
    out = torch.zeros((n,) + src.shape[1:], dtype=src.dtype)
    return out.index_add_(0, seg, src)

def _pad(x, pw):
    flat = tuple((v for pair in reversed(pw) for v in pair))
    return torch.nn.functional.pad(x, flat)
kernel_name = 'standalone__varlen_attn_packed__ragged'

def setup_inputs():

    _w = lambda a: (lambda t: t.to(torch.bfloat16) if t.is_floating_point() else t)(torch.as_tensor(a))
    cu = torch.tensor([0, 289, 520, 939, 1289, 1402, 1666, 1973, 2275], dtype=torch.int64)
    T, H, D = (int(cu[-1]), 16, 128)
    return {'q': _w((lambda *s: torch.randn(*s, dtype=torch.bfloat16) * 0.8)(T, H, D)), 'k': _w((lambda *s: torch.randn(*s, dtype=torch.bfloat16) * 0.8)(T, H, D)), 'v': _w((lambda *s: torch.randn(*s, dtype=torch.bfloat16) * 0.05)(T, H, D)), 'cu': _w(cu)}

def reference(q, k, v, cu):
    T, H, D = q.shape
    out = torch.zeros_like(q)
    scale = D ** (-0.5)
    outs = []
    for i in range(len(cu) - 1):
        s, e = (int(cu[i]), int(cu[i + 1]))
        qi, ki, vi = (q[s:e].clone(), k[s:e].clone(), v[s:e].clone())
        p = _softmax(torch.einsum('qhd,khd->hqk', qi, ki) * scale, axis=-1)
        outs.append(torch.einsum('hqk,khd->qhd', p, vi))
    return torch.concatenate(outs, axis=0)
```

```asm
; @launch grid=(256,1,1) block=(512,1,1) lds=163840
.amdgcn_target "amdgcn-amd-amdhsa--gfx950"
.text
.globl standalone__varlen_attn_packed__ragged_kernel
.p2align 8
.type standalone__varlen_attn_packed__ragged_kernel,@function
standalone__varlen_attn_packed__ragged_kernel:
    s_load_dwordx4 s[4:7], s[0:1], 0
    v_lshrrev_b32 v14, 6, v0
    s_getpc_b64 s[84:85]
L_pc:
    s_bfe_u32 s82, s2, 0x30005
    s_bfe_u32 s81, s2, 0x10002
    s_mul_i32 s83, s81, 7
    s_bfe_u32 s14, s2, 0x10003
    s_add_u32 s15, s14, 7
    s_cmp_eq_u32 s82, 7
    s_cselect_b32 s83, s15, s83
    s_cselect_b32 s14, s81, s14
    s_add_u32 s82, s82, s83
    s_lshl_b32 s15, s82, 3
    s_load_dwordx2 s[86:87], s[84:85], s15 offset:68
    v_readfirstlane_b32 s80, v14
    s_branch L_go
.type L_small,@object
L_small:
.if (L_small - L_pc) != 68
.error "table offset"
.endif
    .long 0x880e7121, 0xff060bff, 0x281a3208, 0xff0612f0, 0x289a3208, 0xff0612f0, 0x271a3208, 0xf70612f0, 0x277a3208, 0xf70612f0, 0x6a133682, 0xf706fbf7, 0x6ab33682, 0xf706fbf7, 0x810857a, 0xff060bff, 0x6a121000, 0xf706fbf7, 0x6ab21000, 0xf706fbf7, 0x38071509, 0xff0c18f0, 0x2815e3ab, 0xf00652f0, 0x2895e3ab, 0xf00652f0, 0x2715e3ab, 0xf00652f0, 0x6a12e7b5, 0xf706fbf7, 0x6ab2e7b5, 0xf706fbf7
.size L_small, .-L_small
L_go:
    v_and_b32 v1, 63, v0
    s_bfe_u32 s83, s2, 0x50003
    v_lshl_add_u32 v14, s83, 9, v0
    v_lshlrev_b32 v14, 2, v14
    global_load_dword v128, v14, s[84:85]
    s_and_b32 s83, s83, 2
    s_add_u32 s14, s14, s83
    s_lshl_b32 s14, s14, 2
    s_and_b32 s82, s2, 3
    s_add_u32 s14, s14, s82
    s_lshl_b32 s14, s14, 8
    s_cmp_eq_u32 s82, 1
    s_cselect_b32 s40, 24, 0
    s_add_u32 s39, s40, s80
    v_lshrrev_b32 v14, 4, v1
    v_lshlrev_b32 v15, 2, v14
    v_and_b32 v70, 15, v1
    v_xor_b32 v70, v70, v15
    v_lshlrev_b32 v70, 4, v70
    v_lshl_add_u32 v70, v14, 12, v70
    s_mov_b32 s19, 0x20000
    s_and_b32 s81, s80, 3
    s_lshr_b32 s82, s80, 2
    s_lshl_b32 s83, s82, 1
    s_lshl_b32 s32, 1040, s83
    s_lshl_b32 s33, 0x4000, s83
    s_lshr_b32 s34, 8, s82
    s_mul_i32 s83, s82, 3
    s_lshr_b32 s35, 8320, s83
    s_mul_i32 s35, s35, s81
    s_addk_i32 s35, 32000
    s_lshr_b32 s36, s19, s83
    s_mul_i32 s36, s36, s81
    s_lshl_b32 s37, s82, 3
    s_add_u32 s37, s37, 0x40008
    s_cmp_ge_u32 s80, 4
    s_cselect_b32 s38, 0, 0x40015
    s_cbranch_scc0 L_kp
    s_setprio 3
L_kp:
    s_waitcnt lgkmcnt(0)
    s_cselect_b64 s[16:17], s[6:7], s[4:5]
    s_bfe_u32 s82, s87, s37
    s_mulk_i32 s82, 8320
    s_add_u32 m0, s82, s35
    s_and_b32 s11, s86, 0xfff
    s_lshl_b32 s11, s11, 12
    s_add_u32 s11, s11, s14
    s_add_u32 s16, s16, s11
    s_addc_u32 s17, s17, 0
    s_and_b32 s18, s86, 0x1ff000
    s_addk_i32 s18, -3840
    s_bfe_u32 s82, s86, s38
    s_lshl_b32 s82, s82, 17
    s_add_u32 s36, s36, s82
    s_bitcmp1_b32 s87, s39
    s_cbranch_scc0 L_first_done
L_first:
    buffer_load_dwordx4 v70, s[16:19], s36 offen lds
    s_add_u32 m0, m0, s32
    s_add_u32 s36, s36, s33
    s_sub_u32 s34, s34, 1
    s_cmp_lg_u32 s34, 0
    s_cbranch_scc1 L_first
L_first_done:
    s_setprio 0
    s_cmp_ge_u32 s2, 256
    s_cbranch_scc1 L_end
    s_load_dwordx2 s[8:9], s[0:1], 16
    s_load_dwordx2 s[12:13], s[0:1], 32
    s_add_u32 s15, s15, s80
    s_lshl_b32 s15, s15, 6
    s_add_u32 s15, s15, L_table-L_pc
    v_mul_u32_u24 v14, 1040, v1
    v_add_u32 v14, 82944, v14
    v_mov_b32 v96, -1.0
    v_mov_b32 v97, -1.0
    v_mov_b32 v98, -1.0
    v_mov_b32 v99, -1.0
    ds_write_b128 v14, v[96:99]
    s_waitcnt lgkmcnt(0)
    s_load_dwordx16 s[64:79], s[84:85], s15
    s_bfe_u32 s15, s86, 0x1001c
    s_lshr_b32 s40, s40, 3
    s_and_b32 s40, s40, 2
    s_add_u32 s40, s40, 0x2000c
    s_bfe_u32 s40, s87, s40
    s_barrier
    s_cmp_ge_u32 s80, 4
    s_cbranch_scc1 L_first_kv
    s_cmp_lg_u32 s34, 0
    s_cbranch_scc1 L_late_q
L_q_issued:
    s_waitcnt lgkmcnt(0)
    s_mov_b32 s81, 0
    s_branch L_compute
L_ich:
    s_branch L_go
L_late_q:
    s_bfe_u32 s82, s86, 0x30019
    s_cmp_ge_u32 s80, s82
    s_cbranch_scc1 L_idle
    s_lshl_b32 s83, s15, 4
    s_add_u32 s82, s40, s83
    s_mul_i32 s82, s82, 1040
    s_add_u32 s82, s82, 81904
    v_and_b32 v14, 3, v1
    v_lshl_add_u32 v0, v14, 2, s82
    s_waitcnt lgkmcnt(0)
L_hold:
    s_cselect_b32 s64, 1, 0
    s_sub_u32 s67, s67, 1
    s_cbranch_scc1 L_end
    s_cmp_lg_u32 s64, 0
    s_sleep 1
    ds_read_b32 v3, v0 offset:0
    s_waitcnt lgkmcnt(0)
    v_cmp_gt_f32 vcc, 0, v3
    s_cbranch_vccnz L_hold
    s_add_u32 s16, s4, s11
    s_addc_u32 s17, s5, 0
    buffer_load_dwordx4 v70, s[16:19], s36 offen lds
    s_add_u32 m0, m0, 1040
    s_addk_i32 s36, 0x4000
    buffer_load_dwordx4 v70, s[16:19], s36 offen lds
    s_add_u32 m0, m0, 1040
    s_addk_i32 s36, 0x4000
    buffer_load_dwordx4 v70, s[16:19], s36 offen lds
    s_add_u32 m0, m0, 1040
    s_addk_i32 s36, 0x4000
    buffer_load_dwordx4 v70, s[16:19], s36 offen lds
    s_add_u32 m0, m0, 1040
    s_addk_i32 s36, 0x4000
    buffer_load_dwordx4 v70, s[16:19], s36 offen lds
    s_add_u32 m0, m0, 1040
    s_addk_i32 s36, 0x4000
    buffer_load_dwordx4 v70, s[16:19], s36 offen lds
    s_add_u32 m0, m0, 1040
    s_addk_i32 s36, 0x4000
    buffer_load_dwordx4 v70, s[16:19], s36 offen lds
    s_add_u32 m0, m0, 1040
    s_addk_i32 s36, 0x4000
    buffer_load_dwordx4 v70, s[16:19], s36 offen lds
    s_branch L_q_issued
L_first_kv:
    s_mov_b64 s[20:21], s[16:17]
    s_mov_b32 s22, s18
    s_mov_b32 s23, 0x20000
    s_add_u32 s24, s8, s11
    s_addc_u32 s25, s9, 0
    s_mov_b32 s26, s18
    s_mov_b32 s27, 0x20000
    s_lshl_b32 s82, s81, 14
    v_add_u32 v64, s82, v70
    v_add_u32 v65, 0x10000, v64
    s_mul_i32 s84, s81, 1040
    s_mov_b32 s83, 0x40000
    s_mul_i32 s82, s15, 16640
    s_lshl_b32 s85, s81, 2
    s_add_u32 s82, s82, s85
    s_add_u32 s82, s82, 82944
    v_mov_b32 v66, s82
    v_mov_b32 v67, 0x46800000
    s_lshl_b32 s85, s81, 10
    s_mul_i32 s82, s15, 49152
    s_bitcmp1_b32 s86, 31
    s_cbranch_scc1 L_md_first
    s_waitcnt vmcnt(0)
L_md_back:
    ds_write_b32 v66, v67
    buffer_load_dwordx4 v64, s[20:23], s83 offen lds
    s_add_u32 m0, m0, 4160
    s_nop 0
    buffer_load_dwordx4 v65, s[20:23], s83 offen lds
    s_add_u32 m0, s82, s85
    s_nop 0
    buffer_load_dwordx4 v64, s[24:27], 0 offen lds
    s_add_u32 m0, m0, 4096
    s_nop 0
    buffer_load_dwordx4 v65, s[24:27], 0 offen lds
    s_waitcnt lgkmcnt(0)
    s_add_u32 s11, s14, s64
    s_and_b32 s81, s68, 15
    s_bitcmp1_b32 s68, 6
    s_cbranch_scc0 L_pass_done
    s_mov_b32 s18, s65
    s_mov_b32 s82, s69
    s_mov_b32 m0, s70
    s_add_u32 s16, s4, s11
    s_addc_u32 s17, s5, 0
    buffer_load_dwordx4 v70, s[16:19], s82 offen lds
    s_add_u32 m0, m0, 1040
    s_addk_i32 s82, 0x4000
    buffer_load_dwordx4 v70, s[16:19], s82 offen lds
    s_add_u32 m0, m0, 1040
    s_addk_i32 s82, 0x4000
    buffer_load_dwordx4 v70, s[16:19], s82 offen lds
    s_add_u32 m0, m0, 1040
    s_addk_i32 s82, 0x4000
    buffer_load_dwordx4 v70, s[16:19], s82 offen lds
    s_add_u32 m0, m0, 1040
    s_addk_i32 s82, 0x4000
    buffer_load_dwordx4 v70, s[16:19], s82 offen lds
    s_add_u32 m0, m0, 1040
    s_addk_i32 s82, 0x4000
    buffer_load_dwordx4 v70, s[16:19], s82 offen lds
    s_add_u32 m0, m0, 1040
    s_addk_i32 s82, 0x4000
    buffer_load_dwordx4 v70, s[16:19], s82 offen lds
    s_add_u32 m0, m0, 1040
    s_addk_i32 s82, 0x4000
    buffer_load_dwordx4 v70, s[16:19], s82 offen lds
L_pass_done:
    s_cmp_ge_u32 s81, 3
    s_cbranch_scc1 L_loaders
L_compute:
    s_mov_b32 s84, s81
    s_mov_b32 s30, s65
    s_mov_b32 s31, 0x20000
    s_add_u32 s28, s12, s11
    s_addc_u32 s29, s13, 0
    v_and_b32 v14, 3, v1
    v_lshl_add_u32 v0, v14, 2, s73
    v_bfe_u32 v15, v1, 2, 3
    v_mul_u32_u24 v15, 1040, v15
    v_lshl_add_u32 v15, v14, 8, v15
    v_lshrrev_b32 v12, 5, v1
    v_lshl_add_u32 v15, v12, 4, v15
    v_xor_b32 v4, 0, v14
    v_lshl_add_u32 v4, v4, 6, v15
    v_add_u32 v176, s70, v4
    v_add_u32 v4, s71, v4
    v_xor_b32 v5, 1, v14
    v_lshl_add_u32 v5, v5, 6, v15
    v_add_u32 v177, s70, v5
    v_add_u32 v5, s71, v5
    v_xor_b32 v6, 2, v14
    v_lshl_add_u32 v6, v6, 6, v15
    v_add_u32 v178, s70, v6
    v_add_u32 v6, s71, v6
    v_xor_b32 v7, 3, v14
    v_lshl_add_u32 v7, v7, 6, v15
    v_add_u32 v179, s70, v7
    v_add_u32 v7, s71, v7
    v_lshrrev_b32 v15, 3, v1
    v_and_b32 v14, 7, v1
    v_lshlrev_b32 v13, 4, v14
    v_lshl_add_u32 v189, v15, 12, v13
    v_xor_b32 v15, v15, v1
    v_lshl_add_u32 v188, v15, 4, s76
    v_and_b32 v15, 31, v1
    v_lshl_add_u32 v15, v15, 7, s76
    v_lshl_add_u32 v15, v12, 3, v15
    v_xor_b32 v184, 0, v14
    v_lshl_add_u32 v184, v184, 4, v15
    v_xor_b32 v185, 1, v14
    v_lshl_add_u32 v185, v185, 4, v15
    v_xor_b32 v186, 2, v14
    v_lshl_add_u32 v186, v186, 4, v15
    v_xor_b32 v187, 3, v14
    v_lshl_add_u32 v187, v187, 4, v15
    v_bfe_u32 v14, v1, 2, 2
    v_lshl_add_u32 v15, v12, 2, v14
    v_lshl_add_u32 v15, v15, 8, s72
    v_bfe_u32 v13, v1, 4, 1
    v_lshl_add_u32 v15, v13, 5, v15
    v_and_b32 v13, 3, v1
    v_lshl_add_u32 v15, v13, 3, v15
    v_xor_b32 v8, 0, v14
    v_lshl_add_u32 v8, v8, 6, v15
    v_xor_b32 v9, 1, v14
    v_lshl_add_u32 v9, v9, 6, v15
    v_xor_b32 v10, 2, v14
    v_lshl_add_u32 v10, v10, 6, v15
    v_xor_b32 v11, 3, v14
    v_lshl_add_u32 v11, v11, 6, v15
    s_bfe_u32 s82, s68, 0x30008
    s_bfe_u32 s83, s68, 0x3000b
    v_and_b32 v190, 7, v1
    v_max_u32 v190, s82, v190
    v_min_u32 v190, s83, v190
    v_mul_u32_u24 v190, 1040, v190
    v_add_u32 v190, 116224, v190
    v_lshlrev_b32 v14, 2, v12
    v_sub_u32 v14, s75, v14
    v_cmp_lt_i32 s[32:33], 0, v14
    v_cmp_lt_i32 s[34:35], 1, v14
    v_cmp_lt_i32 s[36:37], 2, v14
    v_cmp_lt_i32 s[38:39], 3, v14
    v_cmp_lt_i32 s[40:41], 8, v14
    v_cmp_lt_i32 s[42:43], 9, v14
    v_cmp_lt_i32 s[44:45], 10, v14
    v_cmp_lt_i32 s[46:47], 11, v14
    v_cmp_lt_i32 s[48:49], 16, v14
    v_cmp_lt_i32 s[50:51], 17, v14
    v_cmp_lt_i32 s[52:53], 18, v14
    v_cmp_lt_i32 s[54:55], 19, v14
    v_cmp_lt_i32 s[56:57], 24, v14
    v_cmp_lt_i32 s[58:59], 25, v14
    v_cmp_lt_i32 s[60:61], 26, v14
    v_cmp_lt_i32 s[62:63], 27, v14
    v_mov_b64 v[192:193], 0
    v_mov_b64 v[194:195], 0
    v_mov_b64 v[196:197], 0
    v_mov_b64 v[198:199], 0
    v_mov_b64 v[200:201], 0
    v_mov_b64 v[202:203], 0
    v_mov_b64 v[204:205], 0
    v_mov_b64 v[206:207], 0
    v_mov_b64 v[208:209], 0
    v_mov_b64 v[210:211], 0
    v_mov_b64 v[212:213], 0
    v_mov_b64 v[214:215], 0
    v_mov_b64 v[216:217], 0
    v_mov_b64 v[218:219], 0
    v_mov_b64 v[220:221], 0
    v_mov_b64 v[222:223], 0
    v_mov_b64 v[224:225], 0
    v_mov_b64 v[226:227], 0
    v_mov_b64 v[228:229], 0
    v_mov_b64 v[230:231], 0
    v_mov_b64 v[232:233], 0
    v_mov_b64 v[234:235], 0
    v_mov_b64 v[236:237], 0
    v_mov_b64 v[238:239], 0
    v_mov_b64 v[240:241], 0
    v_mov_b64 v[242:243], 0
    v_mov_b64 v[244:245], 0
    v_mov_b64 v[246:247], 0
    v_mov_b64 v[248:249], 0
    v_mov_b64 v[250:251], 0
    v_mov_b64 v[252:253], 0
    v_mov_b64 v[254:255], 0
    v_mov_b64 v[16:17], 0
    v_mov_b64 v[18:19], 0
    v_mov_b64 v[20:21], 0
    v_mov_b64 v[22:23], 0
    v_mov_b64 v[24:25], 0
    v_mov_b64 v[26:27], 0
    v_mov_b64 v[28:29], 0
    v_mov_b64 v[30:31], 0
    v_mov_b32 v12, 0
    v_mov_b32 v15, 0xff800000
    v_mov_b32 v191, 1
    s_mov_b32 s98, 0x38800000
    s_mov_b32 s3, 0x46800000
    s_bitcmp1_b32 s68, 7
    s_cselect_b32 s86, 6, 0
    s_cselect_b32 s87, 8, 0
    s_mov_b32 s99, 16640
    s_mov_b32 s10, 16384
    s_mov_b32 s81, 2
    s_sub_u32 s14, s74, 1
    s_mov_b32 s15, s66
    s_mul_i32 s82, s80, 1040
    s_add_u32 s82, s82, 116224
    v_mov_b32 v2, s82
    s_cmp_lg_u32 s84, 0
    s_cbranch_scc1 L_init
L_noinit:
    s_waitcnt vmcnt(0)
L_noinit2:
    ds_read_b128 v[32:35], v176 offset:0
    ds_read_b128 v[36:39], v176 offset:32
    ds_read_b128 v[40:43], v177 offset:0
    ds_read_b128 v[44:47], v177 offset:32
    ds_read_b128 v[48:51], v178 offset:0
    ds_read_b128 v[52:55], v178 offset:32
    ds_read_b128 v[56:59], v179 offset:0
    ds_read_b128 v[60:63], v179 offset:32
    s_waitcnt lgkmcnt(0)
    ds_write_b32 v2, v12
    s_cmp_lg_u32 s84, 0
    s_cbranch_scc1 L_scale_h
    s_mov_b32 s84, 0x3e0293ee
    s_mov_b32 s85, 0x3e0293ee
    s_mov_b32 s82, 0xffff0000
    v_lshlrev_b32 v144, 16, v32
    v_and_b32 v145, s82, v32
    v_lshlrev_b32 v146, 16, v33
    v_and_b32 v147, s82, v33
    v_lshlrev_b32 v148, 16, v34
    v_and_b32 v149, s82, v34
    v_lshlrev_b32 v150, 16, v35
    v_and_b32 v151, s82, v35
    v_pk_mul_f32 v[144:145], v[144:145], s[84:85]
    v_pk_mul_f32 v[146:147], v[146:147], s[84:85]
    v_pk_mul_f32 v[148:149], v[148:149], s[84:85]
    v_pk_mul_f32 v[150:151], v[150:151], s[84:85]
    v_cvt_pk_bf16_f32 v32, v144, v145
    v_cvt_pk_bf16_f32 v33, v146, v147
    v_cvt_pk_bf16_f32 v34, v148, v149
    v_cvt_pk_bf16_f32 v35, v150, v151
    v_lshlrev_b32 v152, 16, v36
    v_and_b32 v153, s82, v36
    v_lshlrev_b32 v154, 16, v37
    v_and_b32 v155, s82, v37
    v_lshlrev_b32 v156, 16, v38
    v_and_b32 v157, s82, v38
    v_lshlrev_b32 v158, 16, v39
    v_and_b32 v159, s82, v39
    v_pk_mul_f32 v[152:153], v[152:153], s[84:85]
    v_pk_mul_f32 v[154:155], v[154:155], s[84:85]
    v_pk_mul_f32 v[156:157], v[156:157], s[84:85]
    v_pk_mul_f32 v[158:159], v[158:159], s[84:85]
    v_cvt_pk_bf16_f32 v36, v152, v153
    v_cvt_pk_bf16_f32 v37, v154, v155
    v_cvt_pk_bf16_f32 v38, v156, v157
    v_cvt_pk_bf16_f32 v39, v158, v159
    v_lshlrev_b32 v144, 16, v40
    v_and_b32 v145, s82, v40
    v_lshlrev_b32 v146, 16, v41
    v_and_b32 v147, s82, v41
    v_lshlrev_b32 v148, 16, v42
    v_and_b32 v149, s82, v42
    v_lshlrev_b32 v150, 16, v43
    v_and_b32 v151, s82, v43
    v_pk_mul_f32 v[144:145], v[144:145], s[84:85]
    v_pk_mul_f32 v[146:147], v[146:147], s[84:85]
    v_pk_mul_f32 v[148:149], v[148:149], s[84:85]
    v_pk_mul_f32 v[150:151], v[150:151], s[84:85]
    v_cvt_pk_bf16_f32 v40, v144, v145
    v_cvt_pk_bf16_f32 v41, v146, v147
    v_cvt_pk_bf16_f32 v42, v148, v149
    v_cvt_pk_bf16_f32 v43, v150, v151
    v_lshlrev_b32 v152, 16, v44
    v_and_b32 v153, s82, v44
    v_lshlrev_b32 v154, 16, v45
    v_and_b32 v155, s82, v45
    v_lshlrev_b32 v156, 16, v46
    v_and_b32 v157, s82, v46
    v_lshlrev_b32 v158, 16, v47
    v_and_b32 v159, s82, v47
    v_pk_mul_f32 v[152:153], v[152:153], s[84:85]
    v_pk_mul_f32 v[154:155], v[154:155], s[84:85]
    v_pk_mul_f32 v[156:157], v[156:157], s[84:85]
    v_pk_mul_f32 v[158:159], v[158:159], s[84:85]
    v_cvt_pk_bf16_f32 v44, v152, v153
    v_cvt_pk_bf16_f32 v45, v154, v155
    v_cvt_pk_bf16_f32 v46, v156, v157
    v_cvt_pk_bf16_f32 v47, v158, v159
    ds_read_b32 v3, v0
    v_lshlrev_b32 v144, 16, v48
    v_and_b32 v145, s82, v48
    v_lshlrev_b32 v146, 16, v49
    v_and_b32 v147, s82, v49
    v_lshlrev_b32 v148, 16, v50
    v_and_b32 v149, s82, v50
    v_lshlrev_b32 v150, 16, v51
    v_and_b32 v151, s82, v51
    v_pk_mul_f32 v[144:145], v[144:145], s[84:85]
    v_pk_mul_f32 v[146:147], v[146:147], s[84:85]
    v_pk_mul_f32 v[148:149], v[148:149], s[84:85]
    v_pk_mul_f32 v[150:151], v[150:151], s[84:85]
    v_cvt_pk_bf16_f32 v48, v144, v145
    v_cvt_pk_bf16_f32 v49, v146, v147
    v_cvt_pk_bf16_f32 v50, v148, v149
    v_cvt_pk_bf16_f32 v51, v150, v151
    s_waitcnt lgkmcnt(0)
    v_cmp_gt_f32 vcc, 0, v3
    v_lshlrev_b32 v152, 16, v52
    v_and_b32 v153, s82, v52
    v_lshlrev_b32 v154, 16, v53
    v_and_b32 v155, s82, v53
    v_lshlrev_b32 v156, 16, v54
    v_and_b32 v157, s82, v54
    v_lshlrev_b32 v158, 16, v55
    v_and_b32 v159, s82, v55
    v_pk_mul_f32 v[152:153], v[152:153], s[84:85]
    v_pk_mul_f32 v[154:155], v[154:155], s[84:85]
    v_pk_mul_f32 v[156:157], v[156:157], s[84:85]
    v_pk_mul_f32 v[158:159], v[158:159], s[84:85]
    v_cvt_pk_bf16_f32 v52, v152, v153
    v_cvt_pk_bf16_f32 v53, v154, v155
    v_cvt_pk_bf16_f32 v54, v156, v157
    v_cvt_pk_bf16_f32 v55, v158, v159
    s_cbranch_vccz L_back_pre
L_spin_pre:
    s_cselect_b32 s64, 1, 0
    s_sub_u32 s67, s67, 1
    s_cbranch_scc1 L_end
    s_cmp_lg_u32 s64, 0
    ds_read_b32 v3, v0 offset:0
    s_waitcnt lgkmcnt(0)
    v_cmp_gt_f32 vcc, 0, v3
    s_cbranch_vccnz L_spin_pre
L_back_pre:
    ds_read_b128 v[64:67], v4 offset:0
    ds_read_b128 v[68:71], v4 offset:32
    ds_read_b128 v[72:75], v5 offset:0
    ds_read_b128 v[76:79], v5 offset:32
    ds_read_b128 v[80:83], v6 offset:0
    ds_read_b128 v[84:87], v6 offset:32
    ds_read_b128 v[88:91], v7 offset:0
    ds_read_b128 v[92:95], v7 offset:32
    v_lshlrev_b32 v144, 16, v56
    v_and_b32 v145, s82, v56
    v_lshlrev_b32 v146, 16, v57
    v_and_b32 v147, s82, v57
    v_lshlrev_b32 v148, 16, v58
    v_and_b32 v149, s82, v58
    v_lshlrev_b32 v150, 16, v59
    v_and_b32 v151, s82, v59
    v_pk_mul_f32 v[144:145], v[144:145], s[84:85]
    v_pk_mul_f32 v[146:147], v[146:147], s[84:85]
    v_pk_mul_f32 v[148:149], v[148:149], s[84:85]
    v_pk_mul_f32 v[150:151], v[150:151], s[84:85]
    v_cvt_pk_bf16_f32 v56, v144, v145
    v_cvt_pk_bf16_f32 v57, v146, v147
    v_cvt_pk_bf16_f32 v58, v148, v149
    v_cvt_pk_bf16_f32 v59, v150, v151
    v_lshlrev_b32 v152, 16, v60
    v_and_b32 v153, s82, v60
    v_lshlrev_b32 v154, 16, v61
    v_and_b32 v155, s82, v61
    v_lshlrev_b32 v156, 16, v62
    v_and_b32 v157, s82, v62
    v_lshlrev_b32 v158, 16, v63
    v_and_b32 v159, s82, v63
    v_pk_mul_f32 v[152:153], v[152:153], s[84:85]
    v_pk_mul_f32 v[154:155], v[154:155], s[84:85]
    v_pk_mul_f32 v[156:157], v[156:157], s[84:85]
    v_pk_mul_f32 v[158:159], v[158:159], s[84:85]
    v_cvt_pk_bf16_f32 v60, v152, v153
    v_cvt_pk_bf16_f32 v61, v154, v155
    v_cvt_pk_bf16_f32 v62, v156, v157
    v_cvt_pk_bf16_f32 v63, v158, v159
L_qk0:
    s_waitcnt lgkmcnt(0)
    v_mfma_f32_32x32x16_bf16 v[128:143], v[64:67], v[32:35], 0
    ds_read_b128 v[64:67], v4 offset:8320
    v_mfma_f32_32x32x16_bf16 v[128:143], v[68:71], v[36:39], v[128:143]
    ds_read_b128 v[68:71], v4 offset:8352
    v_mfma_f32_32x32x16_bf16 v[128:143], v[72:75], v[40:43], v[128:143]
    ds_read_b128 v[72:75], v5 offset:8320
    v_mfma_f32_32x32x16_bf16 v[128:143], v[76:79], v[44:47], v[128:143]
    ds_read_b128 v[76:79], v5 offset:8352
    ds_read_b32 v3, v0 offset:1040
    v_mfma_f32_32x32x16_bf16 v[128:143], v[80:83], v[48:51], v[128:143]
    ds_read_b128 v[80:83], v6 offset:8320
    v_mfma_f32_32x32x16_bf16 v[128:143], v[84:87], v[52:55], v[128:143]
    ds_read_b128 v[84:87], v6 offset:8352
    v_mfma_f32_32x32x16_bf16 v[128:143], v[88:91], v[56:59], v[128:143]
    ds_read_b128 v[88:91], v7 offset:8320
    s_waitcnt lgkmcnt(3)
    v_cmp_gt_f32 vcc, 0, v3
    v_mfma_f32_32x32x16_bf16 v[128:143], v[92:95], v[60:63], v[128:143]
    ds_read_b128 v[92:95], v7 offset:8352
    s_cbranch_vccz L_back_pre2
L_spin_pre2:
    s_cselect_b32 s64, 1, 0
    s_sub_u32 s67, s67, 1
    s_cbranch_scc1 L_end
    s_cmp_lg_u32 s64, 0
    ds_read_b32 v3, v0 offset:1040
    s_waitcnt lgkmcnt(0)
    v_cmp_gt_f32 vcc, 0, v3
    s_cbranch_vccnz L_spin_pre2
L_back_pre2:
    s_nop 7
    s_waitcnt lgkmcnt(4)
    v_mfma_f32_32x32x16_bf16 v[144:159], v[64:67], v[32:35], v[16:31]
    ds_read_b128 v[64:67], v4 offset:16640
    ds_read_b64_tr_b16 v[96:97], v8 offset:0
    ds_read_b64_tr_b16 v[98:99], v8 offset:2048
    v_exp_f32 v176, v128
    v_exp_f32 v177, v129
    v_exp_f32 v178, v130
    v_add_f32 v13, v176, v177
    v_cvt_pk_bf16_f32 v160, v176, v177
    v_mfma_f32_32x32x16_bf16 v[144:159], v[68:71], v[36:39], v[144:159]
    ds_read_b128 v[68:71], v4 offset:16672
    ds_read_b64_tr_b16 v[100:101], v9 offset:0
    ds_read_b64_tr_b16 v[102:103], v9 offset:2048
    v_exp_f32 v179, v131
    v_add_f32 v13, v13, v178
    v_exp_f32 v180, v132
    v_add_f32 v13, v13, v179
    v_cvt_pk_bf16_f32 v161, v178, v179
    s_waitcnt lgkmcnt(6)
    v_mfma_f32_32x32x16_bf16 v[144:159], v[72:75], v[40:43], v[144:159]
    ds_read_b128 v[72:75], v5 offset:16640
    ds_read_b64_tr_b16 v[104:105], v10 offset:0
    ds_read_b64_tr_b16 v[106:107], v10 offset:2048
    v_exp_f32 v181, v133
    v_add_f32 v13, v13, v180
    v_exp_f32 v182, v134
    v_add_f32 v13, v13, v181
    v_cvt_pk_bf16_f32 v162, v180, v181
    v_mfma_f32_32x32x16_bf16 v[144:159], v[76:79], v[44:47], v[144:159]
    ds_read_b128 v[76:79], v5 offset:16672
    ds_read_b64_tr_b16 v[108:109], v11 offset:0
    ds_read_b64_tr_b16 v[110:111], v11 offset:2048
    ds_read_b32 v3, v0 offset:2080
    v_exp_f32 v183, v135
    v_add_f32 v13, v13, v182
    v_exp_f32 v176, v136
    v_add_f32 v13, v13, v183
    v_cvt_pk_bf16_f32 v163, v182, v183
    v_mfma_f32_32x32x16_bf16 v[144:159], v[80:83], v[48:51], v[144:159]
    ds_read_b128 v[80:83], v6 offset:16640
    ds_read_b64_tr_b16 v[112:113], v8 offset:4096
    ds_read_b64_tr_b16 v[114:115], v8 offset:6144
    ds_write_b32 v2, v191
    v_exp_f32 v177, v137
    v_add_f32 v13, v13, v176
    v_exp_f32 v178, v138
    v_add_f32 v13, v13, v177
    v_cvt_pk_bf16_f32 v164, v176, v177
    v_mfma_f32_32x32x16_bf16 v[144:159], v[84:87], v[52:55], v[144:159]
    ds_read_b128 v[84:87], v6 offset:16672
    ds_read_b64_tr_b16 v[116:117], v9 offset:4096
    ds_read_b64_tr_b16 v[118:119], v9 offset:6144
    v_exp_f32 v179, v139
    v_add_f32 v13, v13, v178
    v_exp_f32 v180, v140
    v_add_f32 v13, v13, v179
    v_cvt_pk_bf16_f32 v165, v178, v179
    v_mfma_f32_32x32x16_bf16 v[144:159], v[88:91], v[56:59], v[144:159]
    ds_read_b128 v[88:91], v7 offset:16640
    ds_read_b64_tr_b16 v[120:121], v10 offset:4096
    ds_read_b64_tr_b16 v[122:123], v10 offset:6144
    v_exp_f32 v181, v141
    v_add_f32 v13, v13, v180
    v_exp_f32 v182, v142
    v_add_f32 v13, v13, v181
    v_cvt_pk_bf16_f32 v166, v180, v181
    v_mfma_f32_32x32x16_bf16 v[144:159], v[92:95], v[60:63], v[144:159]
    ds_read_b128 v[92:95], v7 offset:16672
    ds_read_b64_tr_b16 v[124:125], v11 offset:4096
    ds_read_b64_tr_b16 v[126:127], v11 offset:6144
    v_exp_f32 v183, v143
    v_add_f32 v13, v13, v182
    v_add_f32 v13, v13, v183
    v_cvt_pk_bf16_f32 v167, v182, v183
    s_waitcnt lgkmcnt(13)
    v_cmp_lt_f32 vcc, v3, v13
    v_cmp_gt_f32 s[84:85], s98, v13
    s_or_b64 vcc, vcc, s[84:85]
    s_cbranch_vccnz L_rare_i0
L_back_i0:
    s_bitcmp1_b32 s68, 20
    s_cbranch_scc1 L_leave
L_loop:
    s_waitcnt lgkmcnt(12)
    v_mfma_f32_32x32x16_bf16 v[128:143], v[64:67], v[32:35], v[16:31]
    ds_read_b128 v[64:67], v4 offset:24960
    v_add_f32 v12, v12, v13
    v_exp_f32 v176, v144
    v_exp_f32 v177, v145
    v_mfma_f32_32x32x16_bf16 v[192:207], v[96:99], v[160:163], v[192:207]
    ds_read_b64_tr_b16 v[96:97], v8 offset:8192
    ds_read_b64_tr_b16 v[98:99], v8 offset:10240
    v_exp_f32 v178, v146
    v_add_f32 v13, v176, v177
    v_cvt_pk_bf16_f32 v168, v176, v177
    v_mfma_f32_32x32x16_bf16 v[128:143], v[68:71], v[36:39], v[128:143]
    ds_read_b128 v[68:71], v4 offset:24992
    v_exp_f32 v179, v147
    v_add_f32 v13, v13, v178
    v_exp_f32 v180, v148
    v_mfma_f32_32x32x16_bf16 v[208:223], v[100:103], v[160:163], v[208:223]
    ds_read_b64_tr_b16 v[100:101], v9 offset:8192
    ds_read_b64_tr_b16 v[102:103], v9 offset:10240
    v_add_f32 v13, v13, v179
    v_cvt_pk_bf16_f32 v169, v178, v179
    v_exp_f32 v181, v149
    v_mfma_f32_32x32x16_bf16 v[128:143], v[72:75], v[40:43], v[128:143]
    ds_read_b128 v[72:75], v5 offset:24960
    ds_read_b32 v3, v0 offset:3120
    v_add_f32 v13, v13, v180
    v_exp_f32 v182, v150
    v_add_f32 v13, v13, v181
    v_mfma_f32_32x32x16_bf16 v[224:239], v[104:107], v[160:163], v[224:239]
    ds_read_b64_tr_b16 v[104:105], v10 offset:8192
    ds_read_b64_tr_b16 v[106:107], v10 offset:10240
    v_cvt_pk_bf16_f32 v170, v180, v181
    v_exp_f32 v183, v151
    v_add_f32 v13, v13, v182
    v_mfma_f32_32x32x16_bf16 v[128:143], v[76:79], v[44:47], v[128:143]
    ds_read_b128 v[76:79], v5 offset:24992
    v_exp_f32 v176, v152
    v_add_f32 v13, v13, v183
    v_cvt_pk_bf16_f32 v171, v182, v183
    s_cmp_eq_u32 s81, s86
    v_mfma_f32_32x32x16_bf16 v[240:255], v[108:111], v[160:163], v[240:255]
    ds_read_b64_tr_b16 v[108:109], v11 offset:8192
    ds_read_b64_tr_b16 v[110:111], v11 offset:10240
    v_exp_f32 v177, v153
    v_add_f32 v13, v13, v176
    s_waitcnt lgkmcnt(5)
    v_mfma_f32_32x32x16_bf16 v[128:143], v[80:83], v[48:51], v[128:143]
    ds_read_b128 v[80:83], v6 offset:24960
    ds_write_b32 v2, v0 offset:4
    v_exp_f32 v178, v154
    v_add_f32 v13, v13, v177
    v_cvt_pk_bf16_f32 v172, v176, v177
    v_mfma_f32_32x32x16_bf16 v[192:207], v[112:115], v[164:167], v[192:207]
    ds_read_b64_tr_b16 v[112:113], v8 offset:12288
    ds_read_b64_tr_b16 v[114:115], v8 offset:14336
    v_exp_f32 v179, v155
    v_add_f32 v13, v13, v178
    s_cselect_b32 s84, 0xffff3d00, s99
    v_mfma_f32_32x32x16_bf16 v[128:143], v[84:87], v[52:55], v[128:143]
    ds_read_b128 v[84:87], v6 offset:24992
    v_exp_f32 v180, v156
    v_add_f32 v13, v13, v179
    v_cvt_pk_bf16_f32 v173, v178, v179
    v_add_u32 v4, s84, v4
    v_mfma_f32_32x32x16_bf16 v[208:223], v[116:119], v[164:167], v[208:223]
    ds_read_b64_tr_b16 v[116:117], v9 offset:12288
    ds_read_b64_tr_b16 v[118:119], v9 offset:14336
    v_exp_f32 v181, v157
    v_add_f32 v13, v13, v180
    v_add_u32 v5, s84, v5
    v_mfma_f32_32x32x16_bf16 v[128:143], v[88:91], v[56:59], v[128:143]
    ds_read_b128 v[88:91], v7 offset:24960
    v_exp_f32 v182, v158
    v_add_f32 v13, v13, v181
    v_cvt_pk_bf16_f32 v174, v180, v181
    v_add_u32 v6, s84, v6
    v_mfma_f32_32x32x16_bf16 v[224:239], v[120:123], v[164:167], v[224:239]
    ds_read_b64_tr_b16 v[120:121], v10 offset:12288
    ds_read_b64_tr_b16 v[122:123], v10 offset:14336
    v_exp_f32 v183, v159
    v_add_f32 v13, v13, v182
    v_add_f32 v13, v13, v183
    v_mfma_f32_32x32x16_bf16 v[128:143], v[92:95], v[60:63], v[128:143]
    ds_read_b128 v[92:95], v7 offset:24992
    v_cvt_pk_bf16_f32 v175, v182, v183
    v_cmp_lt_f32 vcc, v3, v13
    s_cmp_eq_u32 s81, s14
    v_add_u32 v7, s84, v7
    v_mfma_f32_32x32x16_bf16 v[240:255], v[124:127], v[164:167], v[240:255]
    ds_read_b64_tr_b16 v[124:125], v11 offset:12288
    ds_read_b64_tr_b16 v[126:127], v11 offset:14336
    s_cbranch_vccnz L_rare_A
L_back_A:
    s_cbranch_scc1 L_tail_even
    s_waitcnt lgkmcnt(12)
    v_mfma_f32_32x32x16_bf16 v[144:159], v[64:67], v[32:35], v[16:31]
    ds_read_b128 v[64:67], v4 offset:16640
    v_add_f32 v12, v12, v13
    v_exp_f32 v176, v128
    v_exp_f32 v177, v129
    v_mfma_f32_32x32x16_bf16 v[192:207], v[96:99], v[168:171], v[192:207]
    ds_read_b64_tr_b16 v[96:97], v8 offset:16384
    ds_read_b64_tr_b16 v[98:99], v8 offset:18432
    v_exp_f32 v178, v130
    v_add_f32 v13, v176, v177
    v_cvt_pk_bf16_f32 v160, v176, v177
    v_mfma_f32_32x32x16_bf16 v[144:159], v[68:71], v[36:39], v[144:159]
    ds_read_b128 v[68:71], v4 offset:16672
    v_exp_f32 v179, v131
    v_add_f32 v13, v13, v178
    v_exp_f32 v180, v132
    v_mfma_f32_32x32x16_bf16 v[208:223], v[100:103], v[168:171], v[208:223]
    ds_read_b64_tr_b16 v[100:101], v9 offset:16384
    ds_read_b64_tr_b16 v[102:103], v9 offset:18432
    v_add_f32 v13, v13, v179
    v_cvt_pk_bf16_f32 v161, v178, v179
    v_exp_f32 v181, v133
    v_mfma_f32_32x32x16_bf16 v[144:159], v[72:75], v[40:43], v[144:159]
    ds_read_b128 v[72:75], v5 offset:16640
    ds_read_b32 v3, v0 offset:4160
    v_add_f32 v13, v13, v180
    v_exp_f32 v182, v134
    v_add_f32 v13, v13, v181
    v_mfma_f32_32x32x16_bf16 v[224:239], v[104:107], v[168:171], v[224:239]
    ds_read_b64_tr_b16 v[104:105], v10 offset:16384
    ds_read_b64_tr_b16 v[106:107], v10 offset:18432
    v_cvt_pk_bf16_f32 v162, v180, v181
    v_exp_f32 v183, v135
    v_add_f32 v13, v13, v182
    v_mfma_f32_32x32x16_bf16 v[144:159], v[76:79], v[44:47], v[144:159]
    ds_read_b128 v[76:79], v5 offset:16672
    v_exp_f32 v176, v136
    v_add_f32 v13, v13, v183
    v_cvt_pk_bf16_f32 v163, v182, v183
    s_cmp_eq_u32 s81, s87
    v_mfma_f32_32x32x16_bf16 v[240:255], v[108:111], v[168:171], v[240:255]
    ds_read_b64_tr_b16 v[108:109], v11 offset:16384
    ds_read_b64_tr_b16 v[110:111], v11 offset:18432
    v_exp_f32 v177, v137
    v_add_f32 v13, v13, v176
    s_waitcnt lgkmcnt(5)
    v_mfma_f32_32x32x16_bf16 v[144:159], v[80:83], v[48:51], v[144:159]
    ds_read_b128 v[80:83], v6 offset:16640
    ds_write_b32 v2, v0
    v_exp_f32 v178, v138
    v_add_f32 v13, v13, v177
    v_cvt_pk_bf16_f32 v164, v176, v177
    v_mfma_f32_32x32x16_bf16 v[192:207], v[112:115], v[172:175], v[192:207]
    ds_read_b64_tr_b16 v[112:113], v8 offset:20480
    ds_read_b64_tr_b16 v[114:115], v8 offset:22528
    v_exp_f32 v179, v139
    v_add_f32 v13, v13, v178
    s_cselect_b32 s85, 0xffff4000, s10
    v_mfma_f32_32x32x16_bf16 v[144:159], v[84:87], v[52:55], v[144:159]
    ds_read_b128 v[84:87], v6 offset:16672
    v_exp_f32 v180, v140
    v_add_f32 v13, v13, v179
    v_cvt_pk_bf16_f32 v165, v178, v179
    s_add_u32 s81, s81, 2
    v_mfma_f32_32x32x16_bf16 v[208:223], v[116:119], v[172:175], v[208:223]
    ds_read_b64_tr_b16 v[116:117], v9 offset:20480
    ds_read_b64_tr_b16 v[118:119], v9 offset:22528
    v_exp_f32 v181, v141
    v_add_f32 v13, v13, v180
    s_cmp_eq_u32 s81, s74
    v_mfma_f32_32x32x16_bf16 v[144:159], v[88:91], v[56:59], v[144:159]
    ds_read_b128 v[88:91], v7 offset:16640
    v_exp_f32 v182, v142
    v_add_f32 v13, v13, v181
    v_cvt_pk_bf16_f32 v166, v180, v181
    v_add_u32 v0, 2080, v0
    v_mfma_f32_32x32x16_bf16 v[224:239], v[120:123], v[172:175], v[224:239]
    ds_read_b64_tr_b16 v[120:121], v10 offset:20480
    ds_read_b64_tr_b16 v[122:123], v10 offset:22528
    v_exp_f32 v183, v143
    v_add_f32 v13, v13, v182
    v_add_f32 v13, v13, v183
    v_mfma_f32_32x32x16_bf16 v[144:159], v[92:95], v[60:63], v[144:159]
    ds_read_b128 v[92:95], v7 offset:16672
    v_cvt_pk_bf16_f32 v167, v182, v183
    v_cmp_lt_f32 vcc, v3, v13
    v_add_u32 v8, s85, v8
    v_add_u32 v9, s85, v9
    v_add_u32 v10, s85, v10
    v_mfma_f32_32x32x16_bf16 v[240:255], v[124:127], v[172:175], v[240:255]
    ds_read_b64_tr_b16 v[124:125], v11 offset:20480
    ds_read_b64_tr_b16 v[126:127], v11 offset:22528
    v_add_u32 v11, s85, v11
    s_cbranch_vccnz L_rare_B
L_back_B:
    s_cbranch_scc0 L_loop
L_tail_odd:
    s_bitcmp1_b32 s68, 22
    s_cbranch_scc1 L_tail_1_1
    s_bitcmp1_b32 s68, 23
    s_cbranch_scc1 L_tail_2_1
L_tail_0_1:
    s_waitcnt lgkmcnt(12)
    v_mfma_f32_32x32x16_bf16 v[192:207], v[96:99], v[160:163], v[192:207]
    ds_read_b64_tr_b16 v[64:65], v8 offset:8192
    ds_read_b64_tr_b16 v[66:67], v8 offset:10240
    ds_read_b64_tr_b16 v[68:69], v9 offset:8192
    ds_read_b64_tr_b16 v[70:71], v9 offset:10240
    v_add_f32 v12, v12, v13
    v_cndmask_b32 v144, v15, v144, s[32:33]
    v_cndmask_b32 v145, v15, v145, s[34:35]
    v_exp_f32 v176, v144
    v_cndmask_b32 v146, v15, v146, s[36:37]
    v_exp_f32 v177, v145
    s_waitcnt lgkmcnt(4)
    v_mfma_f32_32x32x16_bf16 v[192:207], v[112:115], v[164:167], v[192:207]
    ds_write_b32 v2, v0
    ds_read_b32 v3, v190
    ds_read_b64_tr_b16 v[72:73], v10 offset:8192
    ds_read_b64_tr_b16 v[74:75], v10 offset:10240
    ds_read_b64_tr_b16 v[76:77], v11 offset:8192
    ds_read_b64_tr_b16 v[78:79], v11 offset:10240
    v_cndmask_b32 v147, v15, v147, s[38:39]
    v_exp_f32 v178, v146
    v_add_f32 v13, v176, v177
    v_cvt_pk_bf16_f32 v168, v176, v177
    v_mfma_f32_32x32x16_bf16 v[208:223], v[100:103], v[160:163], v[208:223]
    v_exp_f32 v179, v147
    v_add_f32 v13, v13, v178
    v_add_f32 v13, v13, v179
    v_cvt_pk_bf16_f32 v169, v178, v179
    v_mov_b64 v[170:171], 0
    v_cmp_lt_f32 vcc, s3, v13
    v_mfma_f32_32x32x16_bf16 v[208:223], v[116:119], v[164:167], v[208:223]
    v_add_f32 v14, v12, v13
    v_add_f32 v191, v12, v13
    s_cbranch_vccnz L_rare_T01
    s_waitcnt lgkmcnt(4)
    v_mfma_f32_32x32x16_bf16 v[192:207], v[64:67], v[168:171], v[192:207]
    v_permlane32_swap_b32 v14, v191
    v_cmp_gt_i32 vcc, s15, v3
    v_mfma_f32_32x32x16_bf16 v[208:223], v[68:71], v[168:171], v[208:223]
    v_add_f32 v12, v14, v191
    v_rcp_f32 v12, v12
    s_cbranch_vccnz L_stg_T01
L_stgback_T01:
    v_mfma_f32_32x32x16_bf16 v[224:239], v[104:107], v[160:163], v[224:239]
    s_add_u32 s83, s69, 0x8000
    s_add_u32 s82, s69, 0x10000
    s_add_u32 s84, s69, 0x18000
    v_xor_b32 v24, 64, v184
    v_xor_b32 v25, 64, v185
    v_xor_b32 v26, 64, v186
    v_xor_b32 v27, 64, v187
    s_waitcnt lgkmcnt(0)
    v_mfma_f32_32x32x16_bf16 v[224:239], v[120:123], v[164:167], v[224:239]
    v_mul_f32 v192, v192, v12
    v_mul_f32 v193, v193, v12
    v_mul_f32 v194, v194, v12
    v_mul_f32 v195, v195, v12
    v_cvt_pk_bf16_f32 v176, v192, v193
    v_mfma_f32_32x32x16_bf16 v[224:239], v[72:75], v[168:171], v[224:239]
    v_cvt_pk_bf16_f32 v177, v194, v195
    ds_write_b64 v184, v[176:177]
    v_mul_f32 v196, v196, v12
    v_mul_f32 v197, v197, v12
    v_mul_f32 v198, v198, v12
    v_mfma_f32_32x32x16_bf16 v[240:255], v[108:111], v[160:163], v[240:255]
    v_mul_f32 v199, v199, v12
    v_cvt_pk_bf16_f32 v178, v196, v197
    v_cvt_pk_bf16_f32 v179, v198, v199
    ds_write_b64 v185, v[178:179]
    v_mul_f32 v200, v200, v12
    v_mfma_f32_32x32x16_bf16 v[240:255], v[124:127], v[164:167], v[240:255]
    v_mul_f32 v201, v201, v12
    v_mul_f32 v202, v202, v12
    v_mul_f32 v203, v203, v12
    v_cvt_pk_bf16_f32 v180, v200, v201
    v_cvt_pk_bf16_f32 v181, v202, v203
    v_mfma_f32_32x32x16_bf16 v[240:255], v[76:79], v[168:171], v[240:255]
    ds_write_b64 v186, v[180:181]
    v_mul_f32 v204, v204, v12
    v_mul_f32 v205, v205, v12
    v_mul_f32 v206, v206, v12
    v_mul_f32 v207, v207, v12
    v_cvt_pk_bf16_f32 v182, v204, v205
    v_cvt_pk_bf16_f32 v183, v206, v207
    ds_write_b64 v187, v[182:183]
    v_mul_f32 v208, v208, v12
    v_mul_f32 v209, v209, v12
    v_mul_f32 v210, v210, v12
    v_mul_f32 v211, v211, v12
    v_cvt_pk_bf16_f32 v176, v208, v209
    v_cvt_pk_bf16_f32 v177, v210, v211
    ds_write_b64 v24, v[176:177]
    v_mul_f32 v212, v212, v12
    v_mul_f32 v213, v213, v12
    v_mul_f32 v214, v214, v12
    v_mul_f32 v215, v215, v12
    v_cvt_pk_bf16_f32 v178, v212, v213
    v_cvt_pk_bf16_f32 v179, v214, v215
    ds_write_b64 v25, v[178:179]
    v_mul_f32 v216, v216, v12
    v_mul_f32 v217, v217, v12
    v_mul_f32 v218, v218, v12
    v_mul_f32 v219, v219, v12
    v_cvt_pk_bf16_f32 v180, v216, v217
    v_cvt_pk_bf16_f32 v181, v218, v219
    ds_write_b64 v26, v[180:181]
    v_mul_f32 v220, v220, v12
    v_mul_f32 v221, v221, v12
    v_mul_f32 v222, v222, v12
    v_mul_f32 v223, v223, v12
    v_cvt_pk_bf16_f32 v182, v220, v221
    v_cvt_pk_bf16_f32 v183, v222, v223
    ds_write_b64 v27, v[182:183]
    ds_read_b128 v[32:35], v188 offset:0
    ds_read_b128 v[36:39], v188 offset:1024
    ds_read_b128 v[40:43], v188 offset:2048
    ds_read_b128 v[44:47], v188 offset:3072
    v_mul_f32 v224, v224, v12
    v_mul_f32 v225, v225, v12
    v_mul_f32 v226, v226, v12
    v_mul_f32 v227, v227, v12
    v_cvt_pk_bf16_f32 v176, v224, v225
    v_cvt_pk_bf16_f32 v177, v226, v227
    ds_write_b64 v184, v[176:177]
    v_mul_f32 v228, v228, v12
    v_mul_f32 v229, v229, v12
    v_mul_f32 v230, v230, v12
    v_mul_f32 v231, v231, v12
    v_cvt_pk_bf16_f32 v178, v228, v229
    v_cvt_pk_bf16_f32 v179, v230, v231
    ds_write_b64 v185, v[178:179]
    s_waitcnt lgkmcnt(2)
    buffer_store_dwordx4 v[32:35], v189, s[28:31], s69 offen offset:0 sc1
    v_mul_f32 v232, v232, v12
    v_mul_f32 v233, v233, v12
    v_mul_f32 v234, v234, v12
    v_mul_f32 v235, v235, v12
    v_cvt_pk_bf16_f32 v180, v232, v233
    v_cvt_pk_bf16_f32 v181, v234, v235
    ds_write_b64 v186, v[180:181]
    buffer_store_dwordx4 v[36:39], v189, s[28:31], s83 offen offset:0 sc1
    v_mul_f32 v236, v236, v12
    v_mul_f32 v237, v237, v12
    v_mul_f32 v238, v238, v12
    v_mul_f32 v239, v239, v12
    v_cvt_pk_bf16_f32 v182, v236, v237
    v_cvt_pk_bf16_f32 v183, v238, v239
    ds_write_b64 v187, v[182:183]
    buffer_store_dwordx4 v[40:43], v189, s[28:31], s82 offen offset:0 sc1
    v_mul_f32 v240, v240, v12
    v_mul_f32 v241, v241, v12
    v_mul_f32 v242, v242, v12
    v_mul_f32 v243, v243, v12
    v_cvt_pk_bf16_f32 v176, v240, v241
    v_cvt_pk_bf16_f32 v177, v242, v243
    ds_write_b64 v24, v[176:177]
    buffer_store_dwordx4 v[44:47], v189, s[28:31], s84 offen offset:0 sc1
    v_mul_f32 v244, v244, v12
    v_mul_f32 v245, v245, v12
    v_mul_f32 v246, v246, v12
    v_mul_f32 v247, v247, v12
    v_cvt_pk_bf16_f32 v178, v244, v245
    v_cvt_pk_bf16_f32 v179, v246, v247
    ds_write_b64 v25, v[178:179]
    v_mul_f32 v248, v248, v12
    v_mul_f32 v249, v249, v12
    v_mul_f32 v250, v250, v12
    v_mul_f32 v251, v251, v12
    v_cvt_pk_bf16_f32 v180, v248, v249
    v_cvt_pk_bf16_f32 v181, v250, v251
    ds_write_b64 v26, v[180:181]
    v_mul_f32 v252, v252, v12
    v_mul_f32 v253, v253, v12
    v_mul_f32 v254, v254, v12
    v_mul_f32 v255, v255, v12
    v_cvt_pk_bf16_f32 v182, v252, v253
    v_cvt_pk_bf16_f32 v183, v254, v255
    ds_write_b64 v27, v[182:183]
    ds_read_b128 v[48:51], v188 offset:0
    ds_read_b128 v[52:55], v188 offset:1024
    ds_read_b128 v[56:59], v188 offset:2048
    ds_read_b128 v[60:63], v188 offset:3072
    s_waitcnt lgkmcnt(3)
    buffer_store_dwordx4 v[48:51], v189, s[28:31], s69 offen offset:128 sc1
    s_waitcnt lgkmcnt(2)
    buffer_store_dwordx4 v[52:55], v189, s[28:31], s83 offen offset:128 sc1
    s_waitcnt lgkmcnt(1)
    buffer_store_dwordx4 v[56:59], v189, s[28:31], s82 offen offset:128 sc1
    s_waitcnt lgkmcnt(0)
    buffer_store_dwordx4 v[60:63], v189, s[28:31], s84 offen offset:128 sc1
    s_endpgm
L_tail_1_1:
    s_waitcnt lgkmcnt(12)
    v_mfma_f32_32x32x16_bf16 v[192:207], v[96:99], v[160:163], v[192:207]
    ds_read_b64_tr_b16 v[64:65], v8 offset:8192
    ds_read_b64_tr_b16 v[66:67], v8 offset:10240
    v_add_f32 v12, v12, v13
    v_cndmask_b32 v144, v15, v144, s[32:33]
    v_cndmask_b32 v145, v15, v145, s[34:35]
    v_exp_f32 v176, v144
    v_cndmask_b32 v146, v15, v146, s[36:37]
    v_exp_f32 v177, v145
    v_cndmask_b32 v147, v15, v147, s[38:39]
    v_mfma_f32_32x32x16_bf16 v[208:223], v[100:103], v[160:163], v[208:223]
    ds_read_b64_tr_b16 v[68:69], v9 offset:8192
    ds_read_b64_tr_b16 v[70:71], v9 offset:10240
    v_exp_f32 v178, v146
    v_add_f32 v13, v176, v177
    v_cvt_pk_bf16_f32 v168, v176, v177
    v_cndmask_b32 v148, v15, v148, s[40:41]
    v_exp_f32 v179, v147
    v_add_f32 v13, v13, v178
    v_cndmask_b32 v149, v15, v149, s[42:43]
    v_mfma_f32_32x32x16_bf16 v[224:239], v[104:107], v[160:163], v[224:239]
    ds_read_b64_tr_b16 v[72:73], v10 offset:8192
    ds_read_b64_tr_b16 v[74:75], v10 offset:10240
    v_exp_f32 v180, v148
    v_add_f32 v13, v13, v179
    v_cvt_pk_bf16_f32 v169, v178, v179
    v_cndmask_b32 v150, v15, v150, s[44:45]
    v_exp_f32 v181, v149
    v_add_f32 v13, v13, v180
    v_cndmask_b32 v151, v15, v151, s[46:47]
    v_mfma_f32_32x32x16_bf16 v[240:255], v[108:111], v[160:163], v[240:255]
    ds_read_b64_tr_b16 v[76:77], v11 offset:8192
    ds_read_b64_tr_b16 v[78:79], v11 offset:10240
    v_exp_f32 v182, v150
    v_add_f32 v13, v13, v181
    v_cvt_pk_bf16_f32 v170, v180, v181
    v_cndmask_b32 v152, v15, v152, s[48:49]
    v_exp_f32 v183, v151
    v_add_f32 v13, v13, v182
    v_cndmask_b32 v153, v15, v153, s[50:51]
    s_waitcnt lgkmcnt(8)
    v_mfma_f32_32x32x16_bf16 v[192:207], v[112:115], v[164:167], v[192:207]
    ds_write_b32 v2, v0
    ds_read_b32 v3, v190
    ds_read_b64_tr_b16 v[80:81], v8 offset:12288
    ds_read_b64_tr_b16 v[82:83], v8 offset:14336
    v_exp_f32 v176, v152
    v_add_f32 v13, v13, v183
    v_cvt_pk_bf16_f32 v171, v182, v183
    v_cndmask_b32 v154, v15, v154, s[52:53]
    v_exp_f32 v177, v153
    v_add_f32 v13, v13, v176
    v_mfma_f32_32x32x16_bf16 v[208:223], v[116:119], v[164:167], v[208:223]
    ds_read_b64_tr_b16 v[84:85], v9 offset:12288
    ds_read_b64_tr_b16 v[86:87], v9 offset:14336
    v_cndmask_b32 v155, v15, v155, s[54:55]
    v_exp_f32 v178, v154
    v_add_f32 v13, v13, v177
    v_cvt_pk_bf16_f32 v172, v176, v177
    v_cndmask_b32 v156, v15, v156, s[56:57]
    v_exp_f32 v179, v155
    v_add_f32 v13, v13, v178
    v_cndmask_b32 v157, v15, v157, s[58:59]
    v_mfma_f32_32x32x16_bf16 v[224:239], v[120:123], v[164:167], v[224:239]
    ds_read_b64_tr_b16 v[88:89], v10 offset:12288
    ds_read_b64_tr_b16 v[90:91], v10 offset:14336
    v_exp_f32 v180, v156
    v_add_f32 v13, v13, v179
    v_cvt_pk_bf16_f32 v173, v178, v179
    v_cndmask_b32 v158, v15, v158, s[60:61]
    v_exp_f32 v181, v157
    v_add_f32 v13, v13, v180
    v_cndmask_b32 v159, v15, v159, s[62:63]
    v_mfma_f32_32x32x16_bf16 v[240:255], v[124:127], v[164:167], v[240:255]
    ds_read_b64_tr_b16 v[92:93], v11 offset:12288
    ds_read_b64_tr_b16 v[94:95], v11 offset:14336
    v_exp_f32 v182, v158
    v_add_f32 v13, v13, v181
    v_cvt_pk_bf16_f32 v174, v180, v181
    v_exp_f32 v183, v159
    v_add_f32 v13, v13, v182
    v_add_f32 v13, v13, v183
    v_cvt_pk_bf16_f32 v175, v182, v183
    v_cmp_lt_f32 vcc, s3, v13
    s_cbranch_vccnz L_rare_T11
L_back_T11:
    v_add_f32 v12, v12, v13
    s_waitcnt lgkmcnt(0)
    v_cmp_gt_i32 vcc, s15, v3
    v_mov_b32 v14, v12
    v_mfma_f32_32x32x16_bf16 v[192:207], v[64:67], v[168:171], v[192:207]
    v_mfma_f32_32x32x16_bf16 v[192:207], v[80:83], v[172:175], v[192:207]
    s_nop 0
    v_permlane32_swap_b32 v12, v14
    s_cbranch_vccnz L_stg_T11
L_stgback_T11:
    v_mfma_f32_32x32x16_bf16 v[208:223], v[68:71], v[168:171], v[208:223]
    v_add_f32 v12, v12, v14
    v_rcp_f32 v12, v12
    v_mfma_f32_32x32x16_bf16 v[208:223], v[84:87], v[172:175], v[208:223]
    s_add_u32 s83, s69, 0x8000
    s_add_u32 s82, s69, 0x10000
    s_add_u32 s84, s69, 0x18000
    v_xor_b32 v24, 64, v184
    v_xor_b32 v25, 64, v185
    v_xor_b32 v26, 64, v186
    v_xor_b32 v27, 64, v187
    v_mfma_f32_32x32x16_bf16 v[224:239], v[72:75], v[168:171], v[224:239]
    v_mul_f32 v192, v192, v12
    v_mul_f32 v193, v193, v12
    v_mul_f32 v194, v194, v12
    v_mul_f32 v195, v195, v12
    v_cvt_pk_bf16_f32 v176, v192, v193
    v_cvt_pk_bf16_f32 v177, v194, v195
    v_mfma_f32_32x32x16_bf16 v[224:239], v[88:91], v[172:175], v[224:239]
    ds_write_b64 v184, v[176:177]
    v_mul_f32 v196, v196, v12
    v_mul_f32 v197, v197, v12
    v_mul_f32 v198, v198, v12
    v_mul_f32 v199, v199, v12
    v_cvt_pk_bf16_f32 v178, v196, v197
    v_mfma_f32_32x32x16_bf16 v[240:255], v[76:79], v[168:171], v[240:255]
    v_cvt_pk_bf16_f32 v179, v198, v199
    ds_write_b64 v185, v[178:179]
    v_mul_f32 v200, v200, v12
    v_mul_f32 v201, v201, v12
    v_mul_f32 v202, v202, v12
    v_mul_f32 v203, v203, v12
    v_mfma_f32_32x32x16_bf16 v[240:255], v[92:95], v[172:175], v[240:255]
    v_cvt_pk_bf16_f32 v180, v200, v201
    v_cvt_pk_bf16_f32 v181, v202, v203
    ds_write_b64 v186, v[180:181]
    v_mul_f32 v204, v204, v12
    v_mul_f32 v205, v205, v12
    v_mul_f32 v206, v206, v12
    v_mul_f32 v207, v207, v12
    v_cvt_pk_bf16_f32 v182, v204, v205
    v_cvt_pk_bf16_f32 v183, v206, v207
    ds_write_b64 v187, v[182:183]
    v_mul_f32 v208, v208, v12
    v_mul_f32 v209, v209, v12
    v_mul_f32 v210, v210, v12
    v_mul_f32 v211, v211, v12
    v_cvt_pk_bf16_f32 v176, v208, v209
    v_cvt_pk_bf16_f32 v177, v210, v211
    ds_write_b64 v24, v[176:177]
    v_mul_f32 v212, v212, v12
    v_mul_f32 v213, v213, v12
    v_mul_f32 v214, v214, v12
    v_mul_f32 v215, v215, v12
    v_cvt_pk_bf16_f32 v178, v212, v213
    v_cvt_pk_bf16_f32 v179, v214, v215
    ds_write_b64 v25, v[178:179]
    v_mul_f32 v216, v216, v12
    v_mul_f32 v217, v217, v12
    v_mul_f32 v218, v218, v12
    v_mul_f32 v219, v219, v12
    v_cvt_pk_bf16_f32 v180, v216, v217
    v_cvt_pk_bf16_f32 v181, v218, v219
    ds_write_b64 v26, v[180:181]
    v_mul_f32 v220, v220, v12
    v_mul_f32 v221, v221, v12
    v_mul_f32 v222, v222, v12
    v_mul_f32 v223, v223, v12
    v_cvt_pk_bf16_f32 v182, v220, v221
    v_cvt_pk_bf16_f32 v183, v222, v223
    ds_write_b64 v27, v[182:183]
    ds_read_b128 v[32:35], v188 offset:0
    ds_read_b128 v[36:39], v188 offset:1024
    ds_read_b128 v[40:43], v188 offset:2048
    ds_read_b128 v[44:47], v188 offset:3072
    v_mul_f32 v224, v224, v12
    v_mul_f32 v225, v225, v12
    v_mul_f32 v226, v226, v12
    v_mul_f32 v227, v227, v12
    v_cvt_pk_bf16_f32 v176, v224, v225
    v_cvt_pk_bf16_f32 v177, v226, v227
    ds_write_b64 v184, v[176:177]
    v_mul_f32 v228, v228, v12
    v_mul_f32 v229, v229, v12
    v_mul_f32 v230, v230, v12
    v_mul_f32 v231, v231, v12
    v_cvt_pk_bf16_f32 v178, v228, v229
    v_cvt_pk_bf16_f32 v179, v230, v231
    ds_write_b64 v185, v[178:179]
    s_waitcnt lgkmcnt(2)
    buffer_store_dwordx4 v[32:35], v189, s[28:31], s69 offen offset:0 sc1
    v_mul_f32 v232, v232, v12
    v_mul_f32 v233, v233, v12
    v_mul_f32 v234, v234, v12
    v_mul_f32 v235, v235, v12
    v_cvt_pk_bf16_f32 v180, v232, v233
    v_cvt_pk_bf16_f32 v181, v234, v235
    ds_write_b64 v186, v[180:181]
    buffer_store_dwordx4 v[36:39], v189, s[28:31], s83 offen offset:0 sc1
    v_mul_f32 v236, v236, v12
    v_mul_f32 v237, v237, v12
    v_mul_f32 v238, v238, v12
    v_mul_f32 v239, v239, v12
    v_cvt_pk_bf16_f32 v182, v236, v237
    v_cvt_pk_bf16_f32 v183, v238, v239
    ds_write_b64 v187, v[182:183]
    buffer_store_dwordx4 v[40:43], v189, s[28:31], s82 offen offset:0 sc1
    v_mul_f32 v240, v240, v12
    v_mul_f32 v241, v241, v12
    v_mul_f32 v242, v242, v12
    v_mul_f32 v243, v243, v12
    v_cvt_pk_bf16_f32 v176, v240, v241
    v_cvt_pk_bf16_f32 v177, v242, v243
    ds_write_b64 v24, v[176:177]
    buffer_store_dwordx4 v[44:47], v189, s[28:31], s84 offen offset:0 sc1
    v_mul_f32 v244, v244, v12
    v_mul_f32 v245, v245, v12
    v_mul_f32 v246, v246, v12
    v_mul_f32 v247, v247, v12
    v_cvt_pk_bf16_f32 v178, v244, v245
    v_cvt_pk_bf16_f32 v179, v246, v247
    ds_write_b64 v25, v[178:179]
    v_mul_f32 v248, v248, v12
    v_mul_f32 v249, v249, v12
    v_mul_f32 v250, v250, v12
    v_mul_f32 v251, v251, v12
    v_cvt_pk_bf16_f32 v180, v248, v249
    v_cvt_pk_bf16_f32 v181, v250, v251
    ds_write_b64 v26, v[180:181]
    v_mul_f32 v252, v252, v12
    v_mul_f32 v253, v253, v12
    v_mul_f32 v254, v254, v12
    v_mul_f32 v255, v255, v12
    v_cvt_pk_bf16_f32 v182, v252, v253
    v_cvt_pk_bf16_f32 v183, v254, v255
    ds_write_b64 v27, v[182:183]
    ds_read_b128 v[48:51], v188 offset:0
    ds_read_b128 v[52:55], v188 offset:1024
    ds_read_b128 v[56:59], v188 offset:2048
    ds_read_b128 v[60:63], v188 offset:3072
    s_waitcnt lgkmcnt(3)
    buffer_store_dwordx4 v[48:51], v189, s[28:31], s69 offen offset:128 sc1
    s_waitcnt lgkmcnt(2)
    buffer_store_dwordx4 v[52:55], v189, s[28:31], s83 offen offset:128 sc1
    s_waitcnt lgkmcnt(1)
    buffer_store_dwordx4 v[56:59], v189, s[28:31], s82 offen offset:128 sc1
    s_waitcnt lgkmcnt(0)
    buffer_store_dwordx4 v[60:63], v189, s[28:31], s84 offen offset:128 sc1
    s_endpgm
L_tail_2_1:
    s_waitcnt lgkmcnt(12)
    v_mfma_f32_32x32x16_bf16 v[192:207], v[96:99], v[160:163], v[192:207]
    ds_read_b64_tr_b16 v[64:65], v8 offset:8192
    ds_read_b64_tr_b16 v[66:67], v8 offset:10240
    v_add_f32 v12, v12, v13
    v_cndmask_b32 v144, v15, v144, s[32:33]
    v_cndmask_b32 v145, v15, v145, s[34:35]
    v_exp_f32 v176, v144
    v_cndmask_b32 v146, v15, v146, s[36:37]
    v_exp_f32 v177, v145
    v_cndmask_b32 v147, v15, v147, s[38:39]
    v_mfma_f32_32x32x16_bf16 v[208:223], v[100:103], v[160:163], v[208:223]
    ds_read_b64_tr_b16 v[68:69], v9 offset:8192
    ds_read_b64_tr_b16 v[70:71], v9 offset:10240
    v_exp_f32 v178, v146
    v_add_f32 v13, v176, v177
    v_cvt_pk_bf16_f32 v168, v176, v177
    v_cndmask_b32 v148, v15, v148, s[40:41]
    v_exp_f32 v179, v147
    v_add_f32 v13, v13, v178
    v_cndmask_b32 v149, v15, v149, s[42:43]
    v_mfma_f32_32x32x16_bf16 v[224:239], v[104:107], v[160:163], v[224:239]
    ds_read_b64_tr_b16 v[72:73], v10 offset:8192
    ds_read_b64_tr_b16 v[74:75], v10 offset:10240
    v_exp_f32 v180, v148
    v_add_f32 v13, v13, v179
    v_cvt_pk_bf16_f32 v169, v178, v179
    v_cndmask_b32 v150, v15, v150, s[44:45]
    v_exp_f32 v181, v149
    v_add_f32 v13, v13, v180
    v_cndmask_b32 v151, v15, v151, s[46:47]
    v_mfma_f32_32x32x16_bf16 v[240:255], v[108:111], v[160:163], v[240:255]
    ds_read_b64_tr_b16 v[76:77], v11 offset:8192
    ds_read_b64_tr_b16 v[78:79], v11 offset:10240
    v_exp_f32 v182, v150
    v_add_f32 v13, v13, v181
    v_cvt_pk_bf16_f32 v170, v180, v181
    v_cndmask_b32 v152, v15, v152, s[48:49]
    v_exp_f32 v183, v151
    v_add_f32 v13, v13, v182
    v_cndmask_b32 v153, v15, v153, s[50:51]
    s_waitcnt lgkmcnt(8)
    v_mfma_f32_32x32x16_bf16 v[192:207], v[112:115], v[164:167], v[192:207]
    ds_write_b32 v2, v0
    ds_read_b32 v3, v190
    ds_read_b64_tr_b16 v[80:81], v8 offset:12288
    ds_read_b64_tr_b16 v[82:83], v8 offset:14336
    v_exp_f32 v176, v152
    v_add_f32 v13, v13, v183
    v_cvt_pk_bf16_f32 v171, v182, v183
    v_cndmask_b32 v154, v15, v154, s[52:53]
    v_exp_f32 v177, v153
    v_add_f32 v13, v13, v176
    v_mfma_f32_32x32x16_bf16 v[208:223], v[116:119], v[164:167], v[208:223]
    ds_read_b64_tr_b16 v[84:85], v9 offset:12288
    ds_read_b64_tr_b16 v[86:87], v9 offset:14336
    v_cndmask_b32 v155, v15, v155, s[54:55]
    v_exp_f32 v178, v154
    v_add_f32 v13, v13, v177
    v_cvt_pk_bf16_f32 v172, v176, v177
    v_cndmask_b32 v156, v15, v156, s[56:57]
    v_exp_f32 v179, v155
    v_add_f32 v13, v13, v178
    v_cndmask_b32 v157, v15, v157, s[58:59]
    v_mfma_f32_32x32x16_bf16 v[224:239], v[120:123], v[164:167], v[224:239]
    ds_read_b64_tr_b16 v[88:89], v10 offset:12288
    ds_read_b64_tr_b16 v[90:91], v10 offset:14336
    v_exp_f32 v180, v156
    v_add_f32 v13, v13, v179
    v_cvt_pk_bf16_f32 v173, v178, v179
    v_cndmask_b32 v158, v15, v158, s[60:61]
    v_exp_f32 v181, v157
    v_add_f32 v13, v13, v180
    v_cndmask_b32 v159, v15, v159, s[62:63]
    v_mfma_f32_32x32x16_bf16 v[240:255], v[124:127], v[164:167], v[240:255]
    ds_read_b64_tr_b16 v[92:93], v11 offset:12288
    ds_read_b64_tr_b16 v[94:95], v11 offset:14336
    v_exp_f32 v182, v158
    v_add_f32 v13, v13, v181
    v_cvt_pk_bf16_f32 v174, v180, v181
    v_exp_f32 v183, v159
    v_add_f32 v13, v13, v182
    v_add_f32 v13, v13, v183
    v_cvt_pk_bf16_f32 v175, v182, v183
    v_cmp_lt_f32 vcc, s3, v13
    s_cbranch_vccnz L_rare_T21
L_back_T21:
    v_add_f32 v12, v12, v13
    s_waitcnt lgkmcnt(0)
    v_cmp_gt_i32 vcc, s15, v3
    v_mfma_f32_32x32x16_bf16 v[192:207], v[64:67], v[168:171], v[192:207]
    v_mfma_f32_32x32x16_bf16 v[192:207], v[80:83], v[172:175], v[192:207]
    v_mfma_f32_32x32x16_bf16 v[208:223], v[68:71], v[168:171], v[208:223]
    v_mfma_f32_32x32x16_bf16 v[208:223], v[84:87], v[172:175], v[208:223]
    v_mfma_f32_32x32x16_bf16 v[224:239], v[72:75], v[168:171], v[224:239]
    v_mfma_f32_32x32x16_bf16 v[224:239], v[88:91], v[172:175], v[224:239]
    v_mfma_f32_32x32x16_bf16 v[240:255], v[76:79], v[168:171], v[240:255]
    v_mfma_f32_32x32x16_bf16 v[240:255], v[92:95], v[172:175], v[240:255]
    s_cbranch_vccnz L_stg_T21
L_stgback_T21:
    s_branch L_merge
L_tail_even:
    s_bitcmp1_b32 s68, 22
    s_cbranch_scc1 L_tail_1_0
    s_bitcmp1_b32 s68, 23
    s_cbranch_scc1 L_tail_2_0
L_tail_0_0:
    s_waitcnt lgkmcnt(12)
    v_mfma_f32_32x32x16_bf16 v[192:207], v[96:99], v[168:171], v[192:207]
    ds_read_b64_tr_b16 v[64:65], v8 offset:16384
    ds_read_b64_tr_b16 v[66:67], v8 offset:18432
    ds_read_b64_tr_b16 v[68:69], v9 offset:16384
    ds_read_b64_tr_b16 v[70:71], v9 offset:18432
    v_add_f32 v12, v12, v13
    v_cndmask_b32 v128, v15, v128, s[32:33]
    v_cndmask_b32 v129, v15, v129, s[34:35]
    v_exp_f32 v176, v128
    v_cndmask_b32 v130, v15, v130, s[36:37]
    v_exp_f32 v177, v129
    s_waitcnt lgkmcnt(4)
    v_mfma_f32_32x32x16_bf16 v[192:207], v[112:115], v[172:175], v[192:207]
    ds_write_b32 v2, v0
    ds_read_b32 v3, v190
    ds_read_b64_tr_b16 v[72:73], v10 offset:16384
    ds_read_b64_tr_b16 v[74:75], v10 offset:18432
    ds_read_b64_tr_b16 v[76:77], v11 offset:16384
    ds_read_b64_tr_b16 v[78:79], v11 offset:18432
    v_cndmask_b32 v131, v15, v131, s[38:39]
    v_exp_f32 v178, v130
    v_add_f32 v13, v176, v177
    v_cvt_pk_bf16_f32 v160, v176, v177
    v_mfma_f32_32x32x16_bf16 v[208:223], v[100:103], v[168:171], v[208:223]
    v_exp_f32 v179, v131
    v_add_f32 v13, v13, v178
    v_add_f32 v13, v13, v179
    v_cvt_pk_bf16_f32 v161, v178, v179
    v_mov_b64 v[162:163], 0
    v_cmp_lt_f32 vcc, s3, v13
    v_mfma_f32_32x32x16_bf16 v[208:223], v[116:119], v[172:175], v[208:223]
    v_add_f32 v14, v12, v13
    v_add_f32 v191, v12, v13
    s_cbranch_vccnz L_rare_T00
    s_waitcnt lgkmcnt(4)
    v_mfma_f32_32x32x16_bf16 v[192:207], v[64:67], v[160:163], v[192:207]
    v_permlane32_swap_b32 v14, v191
    v_cmp_gt_i32 vcc, s15, v3
    v_mfma_f32_32x32x16_bf16 v[208:223], v[68:71], v[160:163], v[208:223]
    v_add_f32 v12, v14, v191
    v_rcp_f32 v12, v12
    s_cbranch_vccnz L_stg_T00
L_stgback_T00:
    v_mfma_f32_32x32x16_bf16 v[224:239], v[104:107], v[168:171], v[224:239]
    s_add_u32 s83, s69, 0x8000
    s_add_u32 s82, s69, 0x10000
    s_add_u32 s84, s69, 0x18000
    v_xor_b32 v24, 64, v184
    v_xor_b32 v25, 64, v185
    v_xor_b32 v26, 64, v186
    v_xor_b32 v27, 64, v187
    s_waitcnt lgkmcnt(0)
    v_mfma_f32_32x32x16_bf16 v[224:239], v[120:123], v[172:175], v[224:239]
    v_mul_f32 v192, v192, v12
    v_mul_f32 v193, v193, v12
    v_mul_f32 v194, v194, v12
    v_mul_f32 v195, v195, v12
    v_cvt_pk_bf16_f32 v176, v192, v193
    v_mfma_f32_32x32x16_bf16 v[224:239], v[72:75], v[160:163], v[224:239]
    v_cvt_pk_bf16_f32 v177, v194, v195
    ds_write_b64 v184, v[176:177]
    v_mul_f32 v196, v196, v12
    v_mul_f32 v197, v197, v12
    v_mul_f32 v198, v198, v12
    v_mfma_f32_32x32x16_bf16 v[240:255], v[108:111], v[168:171], v[240:255]
    v_mul_f32 v199, v199, v12
    v_cvt_pk_bf16_f32 v178, v196, v197
    v_cvt_pk_bf16_f32 v179, v198, v199
    ds_write_b64 v185, v[178:179]
    v_mul_f32 v200, v200, v12
    v_mfma_f32_32x32x16_bf16 v[240:255], v[124:127], v[172:175], v[240:255]
    v_mul_f32 v201, v201, v12
    v_mul_f32 v202, v202, v12
    v_mul_f32 v203, v203, v12
    v_cvt_pk_bf16_f32 v180, v200, v201
    v_cvt_pk_bf16_f32 v181, v202, v203
    v_mfma_f32_32x32x16_bf16 v[240:255], v[76:79], v[160:163], v[240:255]
    ds_write_b64 v186, v[180:181]
    v_mul_f32 v204, v204, v12
    v_mul_f32 v205, v205, v12
    v_mul_f32 v206, v206, v12
    v_mul_f32 v207, v207, v12
    v_cvt_pk_bf16_f32 v182, v204, v205
    v_cvt_pk_bf16_f32 v183, v206, v207
    ds_write_b64 v187, v[182:183]
    v_mul_f32 v208, v208, v12
    v_mul_f32 v209, v209, v12
    v_mul_f32 v210, v210, v12
    v_mul_f32 v211, v211, v12
    v_cvt_pk_bf16_f32 v176, v208, v209
    v_cvt_pk_bf16_f32 v177, v210, v211
    ds_write_b64 v24, v[176:177]
    v_mul_f32 v212, v212, v12
    v_mul_f32 v213, v213, v12
    v_mul_f32 v214, v214, v12
    v_mul_f32 v215, v215, v12
    v_cvt_pk_bf16_f32 v178, v212, v213
    v_cvt_pk_bf16_f32 v179, v214, v215
    ds_write_b64 v25, v[178:179]
    v_mul_f32 v216, v216, v12
    v_mul_f32 v217, v217, v12
    v_mul_f32 v218, v218, v12
    v_mul_f32 v219, v219, v12
    v_cvt_pk_bf16_f32 v180, v216, v217
    v_cvt_pk_bf16_f32 v181, v218, v219
    ds_write_b64 v26, v[180:181]
    v_mul_f32 v220, v220, v12
    v_mul_f32 v221, v221, v12
    v_mul_f32 v222, v222, v12
    v_mul_f32 v223, v223, v12
    v_cvt_pk_bf16_f32 v182, v220, v221
    v_cvt_pk_bf16_f32 v183, v222, v223
    ds_write_b64 v27, v[182:183]
    ds_read_b128 v[32:35], v188 offset:0
    ds_read_b128 v[36:39], v188 offset:1024
    ds_read_b128 v[40:43], v188 offset:2048
    ds_read_b128 v[44:47], v188 offset:3072
    v_mul_f32 v224, v224, v12
    v_mul_f32 v225, v225, v12
    v_mul_f32 v226, v226, v12
    v_mul_f32 v227, v227, v12
    v_cvt_pk_bf16_f32 v176, v224, v225
    v_cvt_pk_bf16_f32 v177, v226, v227
    ds_write_b64 v184, v[176:177]
    v_mul_f32 v228, v228, v12
    v_mul_f32 v229, v229, v12
    v_mul_f32 v230, v230, v12
    v_mul_f32 v231, v231, v12
    v_cvt_pk_bf16_f32 v178, v228, v229
    v_cvt_pk_bf16_f32 v179, v230, v231
    ds_write_b64 v185, v[178:179]
    s_waitcnt lgkmcnt(2)
    buffer_store_dwordx4 v[32:35], v189, s[28:31], s69 offen offset:0 sc1
    v_mul_f32 v232, v232, v12
    v_mul_f32 v233, v233, v12
    v_mul_f32 v234, v234, v12
    v_mul_f32 v235, v235, v12
    v_cvt_pk_bf16_f32 v180, v232, v233
    v_cvt_pk_bf16_f32 v181, v234, v235
    ds_write_b64 v186, v[180:181]
    buffer_store_dwordx4 v[36:39], v189, s[28:31], s83 offen offset:0 sc1
    v_mul_f32 v236, v236, v12
    v_mul_f32 v237, v237, v12
    v_mul_f32 v238, v238, v12
    v_mul_f32 v239, v239, v12
    v_cvt_pk_bf16_f32 v182, v236, v237
    v_cvt_pk_bf16_f32 v183, v238, v239
    ds_write_b64 v187, v[182:183]
    buffer_store_dwordx4 v[40:43], v189, s[28:31], s82 offen offset:0 sc1
    v_mul_f32 v240, v240, v12
    v_mul_f32 v241, v241, v12
    v_mul_f32 v242, v242, v12
    v_mul_f32 v243, v243, v12
    v_cvt_pk_bf16_f32 v176, v240, v241
    v_cvt_pk_bf16_f32 v177, v242, v243
    ds_write_b64 v24, v[176:177]
    buffer_store_dwordx4 v[44:47], v189, s[28:31], s84 offen offset:0 sc1
    v_mul_f32 v244, v244, v12
    v_mul_f32 v245, v245, v12
    v_mul_f32 v246, v246, v12
    v_mul_f32 v247, v247, v12
    v_cvt_pk_bf16_f32 v178, v244, v245
    v_cvt_pk_bf16_f32 v179, v246, v247
    ds_write_b64 v25, v[178:179]
    v_mul_f32 v248, v248, v12
    v_mul_f32 v249, v249, v12
    v_mul_f32 v250, v250, v12
    v_mul_f32 v251, v251, v12
    v_cvt_pk_bf16_f32 v180, v248, v249
    v_cvt_pk_bf16_f32 v181, v250, v251
    ds_write_b64 v26, v[180:181]
    v_mul_f32 v252, v252, v12
    v_mul_f32 v253, v253, v12
    v_mul_f32 v254, v254, v12
    v_mul_f32 v255, v255, v12
    v_cvt_pk_bf16_f32 v182, v252, v253
    v_cvt_pk_bf16_f32 v183, v254, v255
    ds_write_b64 v27, v[182:183]
    ds_read_b128 v[48:51], v188 offset:0
    ds_read_b128 v[52:55], v188 offset:1024
    ds_read_b128 v[56:59], v188 offset:2048
    ds_read_b128 v[60:63], v188 offset:3072
    s_waitcnt lgkmcnt(3)
    buffer_store_dwordx4 v[48:51], v189, s[28:31], s69 offen offset:128 sc1
    s_waitcnt lgkmcnt(2)
    buffer_store_dwordx4 v[52:55], v189, s[28:31], s83 offen offset:128 sc1
    s_waitcnt lgkmcnt(1)
    buffer_store_dwordx4 v[56:59], v189, s[28:31], s82 offen offset:128 sc1
    s_waitcnt lgkmcnt(0)
    buffer_store_dwordx4 v[60:63], v189, s[28:31], s84 offen offset:128 sc1
    s_endpgm
L_tail_1_0:
    s_waitcnt lgkmcnt(12)
    v_mfma_f32_32x32x16_bf16 v[192:207], v[96:99], v[168:171], v[192:207]
    ds_read_b64_tr_b16 v[64:65], v8 offset:16384
    ds_read_b64_tr_b16 v[66:67], v8 offset:18432
    v_add_f32 v12, v12, v13
    v_cndmask_b32 v128, v15, v128, s[32:33]
    v_cndmask_b32 v129, v15, v129, s[34:35]
    v_exp_f32 v176, v128
    v_cndmask_b32 v130, v15, v130, s[36:37]
    v_exp_f32 v177, v129
    v_cndmask_b32 v131, v15, v131, s[38:39]
    v_mfma_f32_32x32x16_bf16 v[208:223], v[100:103], v[168:171], v[208:223]
    ds_read_b64_tr_b16 v[68:69], v9 offset:16384
    ds_read_b64_tr_b16 v[70:71], v9 offset:18432
    v_exp_f32 v178, v130
    v_add_f32 v13, v176, v177
    v_cvt_pk_bf16_f32 v160, v176, v177
    v_cndmask_b32 v132, v15, v132, s[40:41]
    v_exp_f32 v179, v131
    v_add_f32 v13, v13, v178
    v_cndmask_b32 v133, v15, v133, s[42:43]
    v_mfma_f32_32x32x16_bf16 v[224:239], v[104:107], v[168:171], v[224:239]
    ds_read_b64_tr_b16 v[72:73], v10 offset:16384
    ds_read_b64_tr_b16 v[74:75], v10 offset:18432
    v_exp_f32 v180, v132
    v_add_f32 v13, v13, v179
    v_cvt_pk_bf16_f32 v161, v178, v179
    v_cndmask_b32 v134, v15, v134, s[44:45]
    v_exp_f32 v181, v133
    v_add_f32 v13, v13, v180
    v_cndmask_b32 v135, v15, v135, s[46:47]
    v_mfma_f32_32x32x16_bf16 v[240:255], v[108:111], v[168:171], v[240:255]
    ds_read_b64_tr_b16 v[76:77], v11 offset:16384
    ds_read_b64_tr_b16 v[78:79], v11 offset:18432
    v_exp_f32 v182, v134
    v_add_f32 v13, v13, v181
    v_cvt_pk_bf16_f32 v162, v180, v181
    v_cndmask_b32 v136, v15, v136, s[48:49]
    v_exp_f32 v183, v135
    v_add_f32 v13, v13, v182
    v_cndmask_b32 v137, v15, v137, s[50:51]
    s_waitcnt lgkmcnt(8)
    v_mfma_f32_32x32x16_bf16 v[192:207], v[112:115], v[172:175], v[192:207]
    ds_write_b32 v2, v0
    ds_read_b32 v3, v190
    ds_read_b64_tr_b16 v[80:81], v8 offset:20480
    ds_read_b64_tr_b16 v[82:83], v8 offset:22528
    v_exp_f32 v176, v136
    v_add_f32 v13, v13, v183
    v_cvt_pk_bf16_f32 v163, v182, v183
    v_cndmask_b32 v138, v15, v138, s[52:53]
    v_exp_f32 v177, v137
    v_add_f32 v13, v13, v176
    v_mfma_f32_32x32x16_bf16 v[208:223], v[116:119], v[172:175], v[208:223]
    ds_read_b64_tr_b16 v[84:85], v9 offset:20480
    ds_read_b64_tr_b16 v[86:87], v9 offset:22528
    v_cndmask_b32 v139, v15, v139, s[54:55]
    v_exp_f32 v178, v138
    v_add_f32 v13, v13, v177
    v_cvt_pk_bf16_f32 v164, v176, v177
    v_cndmask_b32 v140, v15, v140, s[56:57]
    v_exp_f32 v179, v139
    v_add_f32 v13, v13, v178
    v_cndmask_b32 v141, v15, v141, s[58:59]
    v_mfma_f32_32x32x16_bf16 v[224:239], v[120:123], v[172:175], v[224:239]
    ds_read_b64_tr_b16 v[88:89], v10 offset:20480
    ds_read_b64_tr_b16 v[90:91], v10 offset:22528
    v_exp_f32 v180, v140
    v_add_f32 v13, v13, v179
    v_cvt_pk_bf16_f32 v165, v178, v179
    v_cndmask_b32 v142, v15, v142, s[60:61]
    v_exp_f32 v181, v141
    v_add_f32 v13, v13, v180
    v_cndmask_b32 v143, v15, v143, s[62:63]
    v_mfma_f32_32x32x16_bf16 v[240:255], v[124:127], v[172:175], v[240:255]
    ds_read_b64_tr_b16 v[92:93], v11 offset:20480
    ds_read_b64_tr_b16 v[94:95], v11 offset:22528
    v_exp_f32 v182, v142
    v_add_f32 v13, v13, v181
    v_cvt_pk_bf16_f32 v166, v180, v181
    v_exp_f32 v183, v143
    v_add_f32 v13, v13, v182
    v_add_f32 v13, v13, v183
    v_cvt_pk_bf16_f32 v167, v182, v183
    v_cmp_lt_f32 vcc, s3, v13
    s_cbranch_vccnz L_rare_T10
L_back_T10:
    v_add_f32 v12, v12, v13
    s_waitcnt lgkmcnt(0)
    v_cmp_gt_i32 vcc, s15, v3
    v_mov_b32 v14, v12
    v_mfma_f32_32x32x16_bf16 v[192:207], v[64:67], v[160:163], v[192:207]
    v_mfma_f32_32x32x16_bf16 v[192:207], v[80:83], v[164:167], v[192:207]
    s_nop 0
    v_permlane32_swap_b32 v12, v14
    s_cbranch_vccnz L_stg_T10
L_stgback_T10:
    v_mfma_f32_32x32x16_bf16 v[208:223], v[68:71], v[160:163], v[208:223]
    v_add_f32 v12, v12, v14
    v_rcp_f32 v12, v12
    v_mfma_f32_32x32x16_bf16 v[208:223], v[84:87], v[164:167], v[208:223]
    s_add_u32 s83, s69, 0x8000
    s_add_u32 s82, s69, 0x10000
    s_add_u32 s84, s69, 0x18000
    v_xor_b32 v24, 64, v184
    v_xor_b32 v25, 64, v185
    v_xor_b32 v26, 64, v186
    v_xor_b32 v27, 64, v187
    v_mfma_f32_32x32x16_bf16 v[224:239], v[72:75], v[160:163], v[224:239]
    v_mul_f32 v192, v192, v12
    v_mul_f32 v193, v193, v12
    v_mul_f32 v194, v194, v12
    v_mul_f32 v195, v195, v12
    v_cvt_pk_bf16_f32 v176, v192, v193
    v_cvt_pk_bf16_f32 v177, v194, v195
    v_mfma_f32_32x32x16_bf16 v[224:239], v[88:91], v[164:167], v[224:239]
    ds_write_b64 v184, v[176:177]
    v_mul_f32 v196, v196, v12
    v_mul_f32 v197, v197, v12
    v_mul_f32 v198, v198, v12
    v_mul_f32 v199, v199, v12
    v_cvt_pk_bf16_f32 v178, v196, v197
    v_mfma_f32_32x32x16_bf16 v[240:255], v[76:79], v[160:163], v[240:255]
    v_cvt_pk_bf16_f32 v179, v198, v199
    ds_write_b64 v185, v[178:179]
    v_mul_f32 v200, v200, v12
    v_mul_f32 v201, v201, v12
    v_mul_f32 v202, v202, v12
    v_mul_f32 v203, v203, v12
    v_mfma_f32_32x32x16_bf16 v[240:255], v[92:95], v[164:167], v[240:255]
    v_cvt_pk_bf16_f32 v180, v200, v201
    v_cvt_pk_bf16_f32 v181, v202, v203
    ds_write_b64 v186, v[180:181]
    v_mul_f32 v204, v204, v12
    v_mul_f32 v205, v205, v12
    v_mul_f32 v206, v206, v12
    v_mul_f32 v207, v207, v12
    v_cvt_pk_bf16_f32 v182, v204, v205
    v_cvt_pk_bf16_f32 v183, v206, v207
    ds_write_b64 v187, v[182:183]
    v_mul_f32 v208, v208, v12
    v_mul_f32 v209, v209, v12
    v_mul_f32 v210, v210, v12
    v_mul_f32 v211, v211, v12
    v_cvt_pk_bf16_f32 v176, v208, v209
    v_cvt_pk_bf16_f32 v177, v210, v211
    ds_write_b64 v24, v[176:177]
    v_mul_f32 v212, v212, v12
    v_mul_f32 v213, v213, v12
    v_mul_f32 v214, v214, v12
    v_mul_f32 v215, v215, v12
    v_cvt_pk_bf16_f32 v178, v212, v213
    v_cvt_pk_bf16_f32 v179, v214, v215
    ds_write_b64 v25, v[178:179]
    v_mul_f32 v216, v216, v12
    v_mul_f32 v217, v217, v12
    v_mul_f32 v218, v218, v12
    v_mul_f32 v219, v219, v12
    v_cvt_pk_bf16_f32 v180, v216, v217
    v_cvt_pk_bf16_f32 v181, v218, v219
    ds_write_b64 v26, v[180:181]
    v_mul_f32 v220, v220, v12
    v_mul_f32 v221, v221, v12
    v_mul_f32 v222, v222, v12
    v_mul_f32 v223, v223, v12
    v_cvt_pk_bf16_f32 v182, v220, v221
    v_cvt_pk_bf16_f32 v183, v222, v223
    ds_write_b64 v27, v[182:183]
    ds_read_b128 v[32:35], v188 offset:0
    ds_read_b128 v[36:39], v188 offset:1024
    ds_read_b128 v[40:43], v188 offset:2048
    ds_read_b128 v[44:47], v188 offset:3072
    v_mul_f32 v224, v224, v12
    v_mul_f32 v225, v225, v12
    v_mul_f32 v226, v226, v12
    v_mul_f32 v227, v227, v12
    v_cvt_pk_bf16_f32 v176, v224, v225
    v_cvt_pk_bf16_f32 v177, v226, v227
    ds_write_b64 v184, v[176:177]
    v_mul_f32 v228, v228, v12
    v_mul_f32 v229, v229, v12
    v_mul_f32 v230, v230, v12
    v_mul_f32 v231, v231, v12
    v_cvt_pk_bf16_f32 v178, v228, v229
    v_cvt_pk_bf16_f32 v179, v230, v231
    ds_write_b64 v185, v[178:179]
    s_waitcnt lgkmcnt(2)
    buffer_store_dwordx4 v[32:35], v189, s[28:31], s69 offen offset:0 sc1
    v_mul_f32 v232, v232, v12
    v_mul_f32 v233, v233, v12
    v_mul_f32 v234, v234, v12
    v_mul_f32 v235, v235, v12
    v_cvt_pk_bf16_f32 v180, v232, v233
    v_cvt_pk_bf16_f32 v181, v234, v235
    ds_write_b64 v186, v[180:181]
    buffer_store_dwordx4 v[36:39], v189, s[28:31], s83 offen offset:0 sc1
    v_mul_f32 v236, v236, v12
    v_mul_f32 v237, v237, v12
    v_mul_f32 v238, v238, v12
    v_mul_f32 v239, v239, v12
    v_cvt_pk_bf16_f32 v182, v236, v237
    v_cvt_pk_bf16_f32 v183, v238, v239
    ds_write_b64 v187, v[182:183]
    buffer_store_dwordx4 v[40:43], v189, s[28:31], s82 offen offset:0 sc1
    v_mul_f32 v240, v240, v12
    v_mul_f32 v241, v241, v12
    v_mul_f32 v242, v242, v12
    v_mul_f32 v243, v243, v12
    v_cvt_pk_bf16_f32 v176, v240, v241
    v_cvt_pk_bf16_f32 v177, v242, v243
    ds_write_b64 v24, v[176:177]
    buffer_store_dwordx4 v[44:47], v189, s[28:31], s84 offen offset:0 sc1
    v_mul_f32 v244, v244, v12
    v_mul_f32 v245, v245, v12
    v_mul_f32 v246, v246, v12
    v_mul_f32 v247, v247, v12
    v_cvt_pk_bf16_f32 v178, v244, v245
    v_cvt_pk_bf16_f32 v179, v246, v247
    ds_write_b64 v25, v[178:179]
    v_mul_f32 v248, v248, v12
    v_mul_f32 v249, v249, v12
    v_mul_f32 v250, v250, v12
    v_mul_f32 v251, v251, v12
    v_cvt_pk_bf16_f32 v180, v248, v249
    v_cvt_pk_bf16_f32 v181, v250, v251
    ds_write_b64 v26, v[180:181]
    v_mul_f32 v252, v252, v12
    v_mul_f32 v253, v253, v12
    v_mul_f32 v254, v254, v12
    v_mul_f32 v255, v255, v12
    v_cvt_pk_bf16_f32 v182, v252, v253
    v_cvt_pk_bf16_f32 v183, v254, v255
    ds_write_b64 v27, v[182:183]
    ds_read_b128 v[48:51], v188 offset:0
    ds_read_b128 v[52:55], v188 offset:1024
    ds_read_b128 v[56:59], v188 offset:2048
    ds_read_b128 v[60:63], v188 offset:3072
    s_waitcnt lgkmcnt(3)
    buffer_store_dwordx4 v[48:51], v189, s[28:31], s69 offen offset:128 sc1
    s_waitcnt lgkmcnt(2)
    buffer_store_dwordx4 v[52:55], v189, s[28:31], s83 offen offset:128 sc1
    s_waitcnt lgkmcnt(1)
    buffer_store_dwordx4 v[56:59], v189, s[28:31], s82 offen offset:128 sc1
    s_waitcnt lgkmcnt(0)
    buffer_store_dwordx4 v[60:63], v189, s[28:31], s84 offen offset:128 sc1
    s_endpgm
L_tail_2_0:
    s_waitcnt lgkmcnt(12)
    v_mfma_f32_32x32x16_bf16 v[192:207], v[96:99], v[168:171], v[192:207]
    ds_read_b64_tr_b16 v[64:65], v8 offset:16384
    ds_read_b64_tr_b16 v[66:67], v8 offset:18432
    v_add_f32 v12, v12, v13
    v_cndmask_b32 v128, v15, v128, s[32:33]
    v_cndmask_b32 v129, v15, v129, s[34:35]
    v_exp_f32 v176, v128
    v_cndmask_b32 v130, v15, v130, s[36:37]
    v_exp_f32 v177, v129
    v_cndmask_b32 v131, v15, v131, s[38:39]
    v_mfma_f32_32x32x16_bf16 v[208:223], v[100:103], v[168:171], v[208:223]
    ds_read_b64_tr_b16 v[68:69], v9 offset:16384
    ds_read_b64_tr_b16 v[70:71], v9 offset:18432
    v_exp_f32 v178, v130
    v_add_f32 v13, v176, v177
    v_cvt_pk_bf16_f32 v160, v176, v177
    v_cndmask_b32 v132, v15, v132, s[40:41]
    v_exp_f32 v179, v131
    v_add_f32 v13, v13, v178
    v_cndmask_b32 v133, v15, v133, s[42:43]
    v_mfma_f32_32x32x16_bf16 v[224:239], v[104:107], v[168:171], v[224:239]
    ds_read_b64_tr_b16 v[72:73], v10 offset:16384
    ds_read_b64_tr_b16 v[74:75], v10 offset:18432
    v_exp_f32 v180, v132
    v_add_f32 v13, v13, v179
    v_cvt_pk_bf16_f32 v161, v178, v179
    v_cndmask_b32 v134, v15, v134, s[44:45]
    v_exp_f32 v181, v133
    v_add_f32 v13, v13, v180
    v_cndmask_b32 v135, v15, v135, s[46:47]
    v_mfma_f32_32x32x16_bf16 v[240:255], v[108:111], v[168:171], v[240:255]
    ds_read_b64_tr_b16 v[76:77], v11 offset:16384
    ds_read_b64_tr_b16 v[78:79], v11 offset:18432
    v_exp_f32 v182, v134
    v_add_f32 v13, v13, v181
    v_cvt_pk_bf16_f32 v162, v180, v181
    v_cndmask_b32 v136, v15, v136, s[48:49]
    v_exp_f32 v183, v135
    v_add_f32 v13, v13, v182
    v_cndmask_b32 v137, v15, v137, s[50:51]
    s_waitcnt lgkmcnt(8)
    v_mfma_f32_32x32x16_bf16 v[192:207], v[112:115], v[172:175], v[192:207]
    ds_write_b32 v2, v0
    ds_read_b32 v3, v190
    ds_read_b64_tr_b16 v[80:81], v8 offset:20480
    ds_read_b64_tr_b16 v[82:83], v8 offset:22528
    v_exp_f32 v176, v136
    v_add_f32 v13, v13, v183
    v_cvt_pk_bf16_f32 v163, v182, v183
    v_cndmask_b32 v138, v15, v138, s[52:53]
    v_exp_f32 v177, v137
    v_add_f32 v13, v13, v176
    v_mfma_f32_32x32x16_bf16 v[208:223], v[116:119], v[172:175], v[208:223]
    ds_read_b64_tr_b16 v[84:85], v9 offset:20480
    ds_read_b64_tr_b16 v[86:87], v9 offset:22528
    v_cndmask_b32 v139, v15, v139, s[54:55]
    v_exp_f32 v178, v138
    v_add_f32 v13, v13, v177
    v_cvt_pk_bf16_f32 v164, v176, v177
    v_cndmask_b32 v140, v15, v140, s[56:57]
    v_exp_f32 v179, v139
    v_add_f32 v13, v13, v178
    v_cndmask_b32 v141, v15, v141, s[58:59]
    v_mfma_f32_32x32x16_bf16 v[224:239], v[120:123], v[172:175], v[224:239]
    ds_read_b64_tr_b16 v[88:89], v10 offset:20480
    ds_read_b64_tr_b16 v[90:91], v10 offset:22528
    v_exp_f32 v180, v140
    v_add_f32 v13, v13, v179
    v_cvt_pk_bf16_f32 v165, v178, v179
    v_cndmask_b32 v142, v15, v142, s[60:61]
    v_exp_f32 v181, v141
    v_add_f32 v13, v13, v180
    v_cndmask_b32 v143, v15, v143, s[62:63]
    v_mfma_f32_32x32x16_bf16 v[240:255], v[124:127], v[172:175], v[240:255]
    ds_read_b64_tr_b16 v[92:93], v11 offset:20480
    ds_read_b64_tr_b16 v[94:95], v11 offset:22528
    v_exp_f32 v182, v142
    v_add_f32 v13, v13, v181
    v_cvt_pk_bf16_f32 v166, v180, v181
    v_exp_f32 v183, v143
    v_add_f32 v13, v13, v182
    v_add_f32 v13, v13, v183
    v_cvt_pk_bf16_f32 v167, v182, v183
    v_cmp_lt_f32 vcc, s3, v13
    s_cbranch_vccnz L_rare_T20
L_back_T20:
    v_add_f32 v12, v12, v13
    s_waitcnt lgkmcnt(0)
    v_cmp_gt_i32 vcc, s15, v3
    v_mfma_f32_32x32x16_bf16 v[192:207], v[64:67], v[160:163], v[192:207]
    v_mfma_f32_32x32x16_bf16 v[192:207], v[80:83], v[164:167], v[192:207]
    v_mfma_f32_32x32x16_bf16 v[208:223], v[68:71], v[160:163], v[208:223]
    v_mfma_f32_32x32x16_bf16 v[208:223], v[84:87], v[164:167], v[208:223]
    v_mfma_f32_32x32x16_bf16 v[224:239], v[72:75], v[160:163], v[224:239]
    v_mfma_f32_32x32x16_bf16 v[224:239], v[88:91], v[164:167], v[224:239]
    v_mfma_f32_32x32x16_bf16 v[240:255], v[76:79], v[160:163], v[240:255]
    v_mfma_f32_32x32x16_bf16 v[240:255], v[92:95], v[164:167], v[240:255]
    s_cbranch_vccnz L_stg_T20
L_stgback_T20:
    s_branch L_merge
L_merge:
    v_mov_b32 v15, v12
    v_mbcnt_lo_u32_b32 v14, -1, 0
    v_mbcnt_hi_u32_b32 v14, -1, v14
    s_and_b32 s77, s77, 0xffffff
    v_permlane32_swap_b32 v12, v15
    v_lshl_add_u32 v4, v14, 4, s77
    s_cmp_eq_u32 s77, 81920
    s_cselect_b32 s82, 33280, 0
    v_add_f32 v12, v12, v15
    s_add_u32 s82, s82, 99584
    v_bfe_u32 v5, v14, 1, 4
    v_mul_u32_u24 v5, 1040, v5
    v_and_b32 v14, 1, v14
    v_lshl_add_u32 v5, v14, 3, v5
    v_add_u32 v5, s82, v5
    s_cmp_eq_u32 s78, 0
    s_cbranch_scc1 L_merge_out
    v_mov_b32 v0, s78
L_merge_wait:
    s_cselect_b32 s64, 1, 0
    s_sub_u32 s67, s67, 1
    s_cbranch_scc1 L_end
    s_cmp_lg_u32 s64, 0
    s_sleep 1
    ds_read_b32 v3, v0 offset:0
    s_waitcnt lgkmcnt(0)
    v_cmp_gt_f32 vcc, 0, v3
    s_cbranch_vccnz L_merge_wait
    ds_read_b64 v[176:177], v5
    ds_read_b128 v[64:67], v4 offset:0
    ds_read_b128 v[68:71], v4 offset:1040
    ds_read_b128 v[72:75], v4 offset:2080
    ds_read_b128 v[76:79], v4 offset:3120
    ds_read_b128 v[80:83], v4 offset:4160
    ds_read_b128 v[84:87], v4 offset:5200
    ds_read_b128 v[88:91], v4 offset:6240
    ds_read_b128 v[92:95], v4 offset:7280
    ds_read_b128 v[96:99], v4 offset:8320
    ds_read_b128 v[100:103], v4 offset:9360
    ds_read_b128 v[104:107], v4 offset:10400
    ds_read_b128 v[108:111], v4 offset:11440
    s_waitcnt lgkmcnt(12)
    v_cmp_neq_f32 vcc, v16, v176
    ds_read_b128 v[112:115], v4 offset:12480
    ds_read_b128 v[116:119], v4 offset:13520
    ds_read_b128 v[120:123], v4 offset:14560
    ds_read_b128 v[124:127], v4 offset:15600
    s_cbranch_vccnz L_merge_slow
L_merge_add:
    v_add_f32 v12, v12, v177
    s_cmp_lg_u32 s79, 0
    s_waitcnt lgkmcnt(12)
    v_add_f32 v192, v192, v64
    v_add_f32 v193, v193, v65
    v_add_f32 v194, v194, v66
    v_add_f32 v195, v195, v67
    v_add_f32 v196, v196, v68
    v_add_f32 v197, v197, v69
    v_add_f32 v198, v198, v70
    v_add_f32 v199, v199, v71
    v_add_f32 v200, v200, v72
    v_add_f32 v201, v201, v73
    v_add_f32 v202, v202, v74
    v_add_f32 v203, v203, v75
    v_add_f32 v204, v204, v76
    v_add_f32 v205, v205, v77
    v_add_f32 v206, v206, v78
    v_add_f32 v207, v207, v79
    s_waitcnt lgkmcnt(8)
    v_add_f32 v208, v208, v80
    v_add_f32 v209, v209, v81
    v_add_f32 v210, v210, v82
    v_add_f32 v211, v211, v83
    v_add_f32 v212, v212, v84
    v_add_f32 v213, v213, v85
    v_add_f32 v214, v214, v86
    v_add_f32 v215, v215, v87
    v_add_f32 v216, v216, v88
    v_add_f32 v217, v217, v89
    v_add_f32 v218, v218, v90
    v_add_f32 v219, v219, v91
    v_add_f32 v220, v220, v92
    v_add_f32 v221, v221, v93
    v_add_f32 v222, v222, v94
    v_add_f32 v223, v223, v95
    s_waitcnt lgkmcnt(4)
    v_add_f32 v224, v224, v96
    v_add_f32 v225, v225, v97
    v_add_f32 v226, v226, v98
    v_add_f32 v227, v227, v99
    v_add_f32 v228, v228, v100
    v_add_f32 v229, v229, v101
    v_add_f32 v230, v230, v102
    v_add_f32 v231, v231, v103
    v_add_f32 v232, v232, v104
    v_add_f32 v233, v233, v105
    v_add_f32 v234, v234, v106
    v_add_f32 v235, v235, v107
    v_add_f32 v236, v236, v108
    v_add_f32 v237, v237, v109
    v_add_f32 v238, v238, v110
    v_add_f32 v239, v239, v111
    s_waitcnt lgkmcnt(0)
    v_add_f32 v240, v240, v112
    v_add_f32 v241, v241, v113
    v_add_f32 v242, v242, v114
    v_add_f32 v243, v243, v115
    v_add_f32 v244, v244, v116
    v_add_f32 v245, v245, v117
    v_add_f32 v246, v246, v118
    v_add_f32 v247, v247, v119
    v_add_f32 v248, v248, v120
    v_add_f32 v249, v249, v121
    v_add_f32 v250, v250, v122
    v_add_f32 v251, v251, v123
    v_add_f32 v252, v252, v124
    v_add_f32 v253, v253, v125
    v_add_f32 v254, v254, v126
    v_add_f32 v255, v255, v127
    s_cbranch_scc1 L_merge_out
L_store:
    v_rcp_f32 v12, v12
    s_add_u32 s83, s69, 0x8000
    s_add_u32 s82, s69, 0x10000
    s_add_u32 s84, s69, 0x18000
    v_xor_b32 v24, 64, v184
    v_xor_b32 v25, 64, v185
    v_xor_b32 v26, 64, v186
    v_xor_b32 v27, 64, v187
    v_mul_f32 v192, v192, v12
    v_mul_f32 v193, v193, v12
    v_mul_f32 v194, v194, v12
    v_mul_f32 v195, v195, v12
    v_cvt_pk_bf16_f32 v176, v192, v193
    v_cvt_pk_bf16_f32 v177, v194, v195
    ds_write_b64 v184, v[176:177]
    v_mul_f32 v196, v196, v12
    v_mul_f32 v197, v197, v12
    v_mul_f32 v198, v198, v12
    v_mul_f32 v199, v199, v12
    v_cvt_pk_bf16_f32 v178, v196, v197
    v_cvt_pk_bf16_f32 v179, v198, v199
    ds_write_b64 v185, v[178:179]
    v_mul_f32 v200, v200, v12
    v_mul_f32 v201, v201, v12
    v_mul_f32 v202, v202, v12
    v_mul_f32 v203, v203, v12
    v_cvt_pk_bf16_f32 v180, v200, v201
    v_cvt_pk_bf16_f32 v181, v202, v203
    ds_write_b64 v186, v[180:181]
    v_mul_f32 v204, v204, v12
    v_mul_f32 v205, v205, v12
    v_mul_f32 v206, v206, v12
    v_mul_f32 v207, v207, v12
    v_cvt_pk_bf16_f32 v182, v204, v205
    v_cvt_pk_bf16_f32 v183, v206, v207
    ds_write_b64 v187, v[182:183]
    v_mul_f32 v208, v208, v12
    v_mul_f32 v209, v209, v12
    v_mul_f32 v210, v210, v12
    v_mul_f32 v211, v211, v12
    v_cvt_pk_bf16_f32 v176, v208, v209
    v_cvt_pk_bf16_f32 v177, v210, v211
    ds_write_b64 v24, v[176:177]
    v_mul_f32 v212, v212, v12
    v_mul_f32 v213, v213, v12
    v_mul_f32 v214, v214, v12
    v_mul_f32 v215, v215, v12
    v_cvt_pk_bf16_f32 v178, v212, v213
    v_cvt_pk_bf16_f32 v179, v214, v215
    ds_write_b64 v25, v[178:179]
    v_mul_f32 v216, v216, v12
    v_mul_f32 v217, v217, v12
    v_mul_f32 v218, v218, v12
    v_mul_f32 v219, v219, v12
    v_cvt_pk_bf16_f32 v180, v216, v217
    v_cvt_pk_bf16_f32 v181, v218, v219
    ds_write_b64 v26, v[180:181]
    v_mul_f32 v220, v220, v12
    v_mul_f32 v221, v221, v12
    v_mul_f32 v222, v222, v12
    v_mul_f32 v223, v223, v12
    v_cvt_pk_bf16_f32 v182, v220, v221
    v_cvt_pk_bf16_f32 v183, v222, v223
    ds_write_b64 v27, v[182:183]
    ds_read_b128 v[32:35], v188 offset:0
    ds_read_b128 v[36:39], v188 offset:1024
    ds_read_b128 v[40:43], v188 offset:2048
    ds_read_b128 v[44:47], v188 offset:3072
    v_mul_f32 v224, v224, v12
    v_mul_f32 v225, v225, v12
    v_mul_f32 v226, v226, v12
    v_mul_f32 v227, v227, v12
    v_cvt_pk_bf16_f32 v176, v224, v225
    v_cvt_pk_bf16_f32 v177, v226, v227
    ds_write_b64 v184, v[176:177]
    v_mul_f32 v228, v228, v12
    v_mul_f32 v229, v229, v12
    v_mul_f32 v230, v230, v12
    v_mul_f32 v231, v231, v12
    v_cvt_pk_bf16_f32 v178, v228, v229
    v_cvt_pk_bf16_f32 v179, v230, v231
    ds_write_b64 v185, v[178:179]
    s_waitcnt lgkmcnt(2)
    buffer_store_dwordx4 v[32:35], v189, s[28:31], s69 offen offset:0 sc1
    v_mul_f32 v232, v232, v12
    v_mul_f32 v233, v233, v12
    v_mul_f32 v234, v234, v12
    v_mul_f32 v235, v235, v12
    v_cvt_pk_bf16_f32 v180, v232, v233
    v_cvt_pk_bf16_f32 v181, v234, v235
    ds_write_b64 v186, v[180:181]
    buffer_store_dwordx4 v[36:39], v189, s[28:31], s83 offen offset:0 sc1
    v_mul_f32 v236, v236, v12
    v_mul_f32 v237, v237, v12
    v_mul_f32 v238, v238, v12
    v_mul_f32 v239, v239, v12
    v_cvt_pk_bf16_f32 v182, v236, v237
    v_cvt_pk_bf16_f32 v183, v238, v239
    ds_write_b64 v187, v[182:183]
    buffer_store_dwordx4 v[40:43], v189, s[28:31], s82 offen offset:0 sc1
    v_mul_f32 v240, v240, v12
    v_mul_f32 v241, v241, v12
    v_mul_f32 v242, v242, v12
    v_mul_f32 v243, v243, v12
    v_cvt_pk_bf16_f32 v176, v240, v241
    v_cvt_pk_bf16_f32 v177, v242, v243
    ds_write_b64 v24, v[176:177]
    buffer_store_dwordx4 v[44:47], v189, s[28:31], s84 offen offset:0 sc1
    v_mul_f32 v244, v244, v12
    v_mul_f32 v245, v245, v12
    v_mul_f32 v246, v246, v12
    v_mul_f32 v247, v247, v12
    v_cvt_pk_bf16_f32 v178, v244, v245
    v_cvt_pk_bf16_f32 v179, v246, v247
    ds_write_b64 v25, v[178:179]
    v_mul_f32 v248, v248, v12
    v_mul_f32 v249, v249, v12
    v_mul_f32 v250, v250, v12
    v_mul_f32 v251, v251, v12
    v_cvt_pk_bf16_f32 v180, v248, v249
    v_cvt_pk_bf16_f32 v181, v250, v251
    ds_write_b64 v26, v[180:181]
    v_mul_f32 v252, v252, v12
    v_mul_f32 v253, v253, v12
    v_mul_f32 v254, v254, v12
    v_mul_f32 v255, v255, v12
    v_cvt_pk_bf16_f32 v182, v252, v253
    v_cvt_pk_bf16_f32 v183, v254, v255
    ds_write_b64 v27, v[182:183]
    ds_read_b128 v[48:51], v188 offset:0
    ds_read_b128 v[52:55], v188 offset:1024
    ds_read_b128 v[56:59], v188 offset:2048
    ds_read_b128 v[60:63], v188 offset:3072
    s_waitcnt lgkmcnt(3)
    buffer_store_dwordx4 v[48:51], v189, s[28:31], s69 offen offset:128 sc1
    s_waitcnt lgkmcnt(2)
    buffer_store_dwordx4 v[52:55], v189, s[28:31], s83 offen offset:128 sc1
    s_waitcnt lgkmcnt(1)
    buffer_store_dwordx4 v[56:59], v189, s[28:31], s82 offen offset:128 sc1
    s_waitcnt lgkmcnt(0)
    buffer_store_dwordx4 v[60:63], v189, s[28:31], s84 offen offset:128 sc1
    s_endpgm
L_merge_slow:
    v_min_f32 v178, v16, v176
    v_sub_f32 v180, v178, v16
    v_sub_f32 v182, v178, v176
    v_exp_f32 v180, v180
    v_exp_f32 v182, v182
    v_mov_b32 v16, v178
    v_mul_f32 v12, v12, v180
    v_mul_f32 v177, v177, v182
    s_waitcnt lgkmcnt(0)
    v_mul_f32 v192, v192, v180
    v_mul_f32 v64, v64, v182
    v_mul_f32 v193, v193, v180
    v_mul_f32 v65, v65, v182
    v_mul_f32 v194, v194, v180
    v_mul_f32 v66, v66, v182
    v_mul_f32 v195, v195, v180
    v_mul_f32 v67, v67, v182
    v_mul_f32 v196, v196, v180
    v_mul_f32 v68, v68, v182
    v_mul_f32 v197, v197, v180
    v_mul_f32 v69, v69, v182
    v_mul_f32 v198, v198, v180
    v_mul_f32 v70, v70, v182
    v_mul_f32 v199, v199, v180
    v_mul_f32 v71, v71, v182
    v_mul_f32 v200, v200, v180
    v_mul_f32 v72, v72, v182
    v_mul_f32 v201, v201, v180
    v_mul_f32 v73, v73, v182
    v_mul_f32 v202, v202, v180
    v_mul_f32 v74, v74, v182
    v_mul_f32 v203, v203, v180
    v_mul_f32 v75, v75, v182
    v_mul_f32 v204, v204, v180
    v_mul_f32 v76, v76, v182
    v_mul_f32 v205, v205, v180
    v_mul_f32 v77, v77, v182
    v_mul_f32 v206, v206, v180
    v_mul_f32 v78, v78, v182
    v_mul_f32 v207, v207, v180
    v_mul_f32 v79, v79, v182
    v_mul_f32 v208, v208, v180
    v_mul_f32 v80, v80, v182
    v_mul_f32 v209, v209, v180
    v_mul_f32 v81, v81, v182
    v_mul_f32 v210, v210, v180
    v_mul_f32 v82, v82, v182
    v_mul_f32 v211, v211, v180
    v_mul_f32 v83, v83, v182
    v_mul_f32 v212, v212, v180
    v_mul_f32 v84, v84, v182
    v_mul_f32 v213, v213, v180
    v_mul_f32 v85, v85, v182
    v_mul_f32 v214, v214, v180
    v_mul_f32 v86, v86, v182
    v_mul_f32 v215, v215, v180
    v_mul_f32 v87, v87, v182
    v_mul_f32 v216, v216, v180
    v_mul_f32 v88, v88, v182
    v_mul_f32 v217, v217, v180
    v_mul_f32 v89, v89, v182
    v_mul_f32 v218, v218, v180
    v_mul_f32 v90, v90, v182
    v_mul_f32 v219, v219, v180
    v_mul_f32 v91, v91, v182
    v_mul_f32 v220, v220, v180
    v_mul_f32 v92, v92, v182
    v_mul_f32 v221, v221, v180
    v_mul_f32 v93, v93, v182
    v_mul_f32 v222, v222, v180
    v_mul_f32 v94, v94, v182
    v_mul_f32 v223, v223, v180
    v_mul_f32 v95, v95, v182
    v_mul_f32 v224, v224, v180
    v_mul_f32 v96, v96, v182
    v_mul_f32 v225, v225, v180
    v_mul_f32 v97, v97, v182
    v_mul_f32 v226, v226, v180
    v_mul_f32 v98, v98, v182
    v_mul_f32 v227, v227, v180
    v_mul_f32 v99, v99, v182
    v_mul_f32 v228, v228, v180
    v_mul_f32 v100, v100, v182
    v_mul_f32 v229, v229, v180
    v_mul_f32 v101, v101, v182
    v_mul_f32 v230, v230, v180
    v_mul_f32 v102, v102, v182
    v_mul_f32 v231, v231, v180
    v_mul_f32 v103, v103, v182
    v_mul_f32 v232, v232, v180
    v_mul_f32 v104, v104, v182
    v_mul_f32 v233, v233, v180
    v_mul_f32 v105, v105, v182
    v_mul_f32 v234, v234, v180
    v_mul_f32 v106, v106, v182
    v_mul_f32 v235, v235, v180
    v_mul_f32 v107, v107, v182
    v_mul_f32 v236, v236, v180
    v_mul_f32 v108, v108, v182
    v_mul_f32 v237, v237, v180
    v_mul_f32 v109, v109, v182
    v_mul_f32 v238, v238, v180
    v_mul_f32 v110, v110, v182
    v_mul_f32 v239, v239, v180
    v_mul_f32 v111, v111, v182
    v_mul_f32 v240, v240, v180
    v_mul_f32 v112, v112, v182
    v_mul_f32 v241, v241, v180
    v_mul_f32 v113, v113, v182
    v_mul_f32 v242, v242, v180
    v_mul_f32 v114, v114, v182
    v_mul_f32 v243, v243, v180
    v_mul_f32 v115, v115, v182
    v_mul_f32 v244, v244, v180
    v_mul_f32 v116, v116, v182
    v_mul_f32 v245, v245, v180
    v_mul_f32 v117, v117, v182
    v_mul_f32 v246, v246, v180
    v_mul_f32 v118, v118, v182
    v_mul_f32 v247, v247, v180
    v_mul_f32 v119, v119, v182
    v_mul_f32 v248, v248, v180
    v_mul_f32 v120, v120, v182
    v_mul_f32 v249, v249, v180
    v_mul_f32 v121, v121, v182
    v_mul_f32 v250, v250, v180
    v_mul_f32 v122, v122, v182
    v_mul_f32 v251, v251, v180
    v_mul_f32 v123, v123, v182
    v_mul_f32 v252, v252, v180
    v_mul_f32 v124, v124, v182
    v_mul_f32 v253, v253, v180
    v_mul_f32 v125, v125, v182
    v_mul_f32 v254, v254, v180
    v_mul_f32 v126, v126, v182
    v_mul_f32 v255, v255, v180
    v_mul_f32 v127, v127, v182
    s_branch L_merge_add
L_merge_out:
    v_mov_b32 v176, v16
    v_mov_b32 v177, v12
    v_mov_b32 v0, s79
    v_mov_b32 v14, 1.0
    ds_write_b64 v5, v[176:177]
    ds_write_b128 v4, v[192:195] offset:0
    ds_write_b128 v4, v[196:199] offset:1040
    ds_write_b128 v4, v[200:203] offset:2080
    ds_write_b128 v4, v[204:207] offset:3120
    ds_write_b128 v4, v[208:211] offset:4160
    ds_write_b128 v4, v[212:215] offset:5200
    ds_write_b128 v4, v[216:219] offset:6240
    ds_write_b128 v4, v[220:223] offset:7280
    ds_write_b128 v4, v[224:227] offset:8320
    ds_write_b128 v4, v[228:231] offset:9360
    ds_write_b128 v4, v[232:235] offset:10400
    ds_write_b128 v4, v[236:239] offset:11440
    ds_write_b128 v4, v[240:243] offset:12480
    ds_write_b128 v4, v[244:247] offset:13520
    ds_write_b128 v4, v[248:251] offset:14560
    ds_write_b128 v4, v[252:255] offset:15600
    ds_write_b32 v0, v14
    s_waitcnt lgkmcnt(0)
    s_endpgm
L_idle:
    s_cmp_lt_u32 s18, 1638400
    s_cbranch_scc1 L_idle2
    s_add_u32 s82, s14, 1183744
    s_add_u32 s16, s4, s82
    s_addc_u32 s17, s5, 0
    s_mov_b32 s18, 942336
    s_bfe_u32 s82, s86, 0x10015
    s_lshl_b32 s82, s82, 18
    s_add_u32 s82, s82, 0x80000
    s_add_u32 s83, s82, 0x20000
    v_lshrrev_b32 v14, 1, v1
    v_and_b32 v15, 1, v1
    v_lshlrev_b32 v15, 7, v15
    v_lshl_add_u32 v14, v14, 12, v15
    buffer_load_dword v32, v14, s[16:19], s82 offen
    buffer_load_dword v33, v14, s[16:19], s83 offen
L_idle2:
    s_mul_i32 s82, s80, 1040
    s_add_u32 s82, s82, 116224
    v_mov_b32 v2, s82
    v_mov_b32 v14, 0x7fffffff
    ds_write_b32 v2, v14
    ds_write_b32 v2, v14 offset:4
    s_waitcnt lgkmcnt(0)
    s_endpgm
L_loaders:
    s_cmp_eq_u32 s81, 4
    s_cbranch_scc1 L_prog_4
    s_cmp_eq_u32 s81, 5
    s_cbranch_scc1 L_prog_5
    s_cmp_eq_u32 s81, 6
    s_cbranch_scc1 L_prog_6
    s_cmp_eq_u32 s81, 7
    s_cbranch_scc1 L_prog_7
    s_cmp_eq_u32 s81, 8
    s_cbranch_scc1 L_prog_8
L_prog_3:
    s_setprio 1
    s_add_u32 m0, s84, 106880
    s_mov_b32 s83, 0x60000
    buffer_load_dwordx4 v64, s[20:23], s83 offen lds
    s_add_u32 m0, s84, 111040
    s_nop 0
    buffer_load_dwordx4 v65, s[20:23], s83 offen lds
    s_add_u32 m0, s85, 8192
    s_mov_b32 s83, 0x20000
    buffer_load_dwordx4 v64, s[24:27], s83 offen lds
    s_add_u32 m0, s85, 12288
    s_nop 0
    buffer_load_dwordx4 v65, s[24:27], s83 offen lds
    s_mov_b32 s30, s65
    s_mov_b32 s31, 0x20000
    s_add_u32 s28, s12, s11
    s_addc_u32 s29, s13, 0
    v_and_b32 v14, 3, v1
    v_lshl_add_u32 v0, v14, 2, s73
    v_bfe_u32 v15, v1, 2, 3
    v_mul_u32_u24 v15, 1040, v15
    v_lshl_add_u32 v15, v14, 8, v15
    v_lshrrev_b32 v12, 5, v1
    v_lshl_add_u32 v15, v12, 4, v15
    v_xor_b32 v4, 0, v14
    v_lshl_add_u32 v4, v4, 6, v15
    v_add_u32 v176, s70, v4
    v_add_u32 v4, s71, v4
    v_xor_b32 v5, 1, v14
    v_lshl_add_u32 v5, v5, 6, v15
    v_add_u32 v177, s70, v5
    v_add_u32 v5, s71, v5
    v_xor_b32 v6, 2, v14
    v_lshl_add_u32 v6, v6, 6, v15
    v_add_u32 v178, s70, v6
    v_add_u32 v6, s71, v6
    v_xor_b32 v7, 3, v14
    v_lshl_add_u32 v7, v7, 6, v15
    v_add_u32 v179, s70, v7
    v_add_u32 v7, s71, v7
    v_lshrrev_b32 v15, 3, v1
    v_and_b32 v14, 7, v1
    v_lshlrev_b32 v13, 4, v14
    v_lshl_add_u32 v189, v15, 12, v13
    v_xor_b32 v15, v15, v1
    v_lshl_add_u32 v188, v15, 4, s76
    v_and_b32 v15, 31, v1
    v_lshl_add_u32 v15, v15, 7, s76
    v_lshl_add_u32 v15, v12, 3, v15
    v_xor_b32 v184, 0, v14
    v_lshl_add_u32 v184, v184, 4, v15
    v_xor_b32 v185, 1, v14
    v_lshl_add_u32 v185, v185, 4, v15
    v_xor_b32 v186, 2, v14
    v_lshl_add_u32 v186, v186, 4, v15
    v_xor_b32 v187, 3, v14
    v_lshl_add_u32 v187, v187, 4, v15
    v_bfe_u32 v14, v1, 2, 2
    v_lshl_add_u32 v15, v12, 2, v14
    v_lshl_add_u32 v15, v15, 8, s72
    v_bfe_u32 v13, v1, 4, 1
    v_lshl_add_u32 v15, v13, 5, v15
    v_and_b32 v13, 3, v1
    v_lshl_add_u32 v15, v13, 3, v15
    v_xor_b32 v8, 0, v14
    v_lshl_add_u32 v8, v8, 6, v15
    v_xor_b32 v9, 1, v14
    v_lshl_add_u32 v9, v9, 6, v15
    v_xor_b32 v10, 2, v14
    v_lshl_add_u32 v10, v10, 6, v15
    v_xor_b32 v11, 3, v14
    v_lshl_add_u32 v11, v11, 6, v15
    s_bfe_u32 s82, s68, 0x30008
    s_bfe_u32 s83, s68, 0x3000b
    v_and_b32 v190, 7, v1
    v_max_u32 v190, s82, v190
    v_min_u32 v190, s83, v190
    v_mul_u32_u24 v190, 1040, v190
    v_add_u32 v190, 116224, v190
    v_lshlrev_b32 v14, 2, v12
    v_sub_u32 v14, s75, v14
    v_cmp_lt_i32 s[32:33], 0, v14
    v_cmp_lt_i32 s[34:35], 1, v14
    v_cmp_lt_i32 s[36:37], 2, v14
    v_cmp_lt_i32 s[38:39], 3, v14
    v_cmp_lt_i32 s[40:41], 8, v14
    v_cmp_lt_i32 s[42:43], 9, v14
    v_cmp_lt_i32 s[44:45], 10, v14
    v_cmp_lt_i32 s[46:47], 11, v14
    v_cmp_lt_i32 s[48:49], 16, v14
    v_cmp_lt_i32 s[50:51], 17, v14
    v_cmp_lt_i32 s[52:53], 18, v14
    v_cmp_lt_i32 s[54:55], 19, v14
    v_cmp_lt_i32 s[56:57], 24, v14
    v_cmp_lt_i32 s[58:59], 25, v14
    v_cmp_lt_i32 s[60:61], 26, v14
    v_cmp_lt_i32 s[62:63], 27, v14
    v_mov_b64 v[192:193], 0
    v_mov_b64 v[194:195], 0
    v_mov_b64 v[196:197], 0
    v_mov_b64 v[198:199], 0
    v_mov_b64 v[200:201], 0
    v_mov_b64 v[202:203], 0
    v_mov_b64 v[204:205], 0
    v_mov_b64 v[206:207], 0
    v_mov_b64 v[208:209], 0
    v_mov_b64 v[210:211], 0
    v_mov_b64 v[212:213], 0
    v_mov_b64 v[214:215], 0
    v_mov_b64 v[216:217], 0
    v_mov_b64 v[218:219], 0
    v_mov_b64 v[220:221], 0
    v_mov_b64 v[222:223], 0
    v_mov_b64 v[224:225], 0
    v_mov_b64 v[226:227], 0
    v_mov_b64 v[228:229], 0
    v_mov_b64 v[230:231], 0
    v_mov_b64 v[232:233], 0
    v_mov_b64 v[234:235], 0
    v_mov_b64 v[236:237], 0
    v_mov_b64 v[238:239], 0
    v_mov_b64 v[240:241], 0
    v_mov_b64 v[242:243], 0
    v_mov_b64 v[244:245], 0
    v_mov_b64 v[246:247], 0
    v_mov_b64 v[248:249], 0
    v_mov_b64 v[250:251], 0
    v_mov_b64 v[252:253], 0
    v_mov_b64 v[254:255], 0
    v_mov_b64 v[16:17], 0
    v_mov_b64 v[18:19], 0
    v_mov_b64 v[20:21], 0
    v_mov_b64 v[22:23], 0
    v_mov_b64 v[24:25], 0
    v_mov_b64 v[26:27], 0
    v_mov_b64 v[28:29], 0
    v_mov_b64 v[30:31], 0
    v_mov_b32 v12, 0
    v_mov_b32 v15, 0xff800000
    v_mov_b32 v191, 1
    s_mov_b32 s98, 0x38800000
    s_mov_b32 s3, 0x46800000
    s_bitcmp1_b32 s68, 7
    s_cselect_b32 s86, 6, 0
    s_cselect_b32 s87, 8, 0
    s_mov_b32 s99, 16640
    s_mov_b32 s10, 16384
    s_mov_b32 s81, 2
    s_sub_u32 s14, s74, 1
    s_mov_b32 s15, s66
    s_mul_i32 s82, s80, 1040
    s_add_u32 s82, s82, 116224
    v_mov_b32 v2, s82
    s_waitcnt vmcnt(8)
    ds_read_b128 v[32:35], v176 offset:0
    ds_read_b128 v[36:39], v176 offset:32
    ds_read_b128 v[40:43], v177 offset:0
    ds_read_b128 v[44:47], v177 offset:32
    ds_read_b128 v[48:51], v178 offset:0
    ds_read_b128 v[52:55], v178 offset:32
    ds_read_b128 v[56:59], v179 offset:0
    ds_read_b128 v[60:63], v179 offset:32
    s_waitcnt lgkmcnt(0)
    ds_write_b32 v2, v12
    s_add_u32 m0, s84, 115200
    s_mov_b32 s83, 0x80000
    buffer_load_dwordx4 v64, s[20:23], s83 offen lds
    s_add_u32 m0, s84, 119360
    s_nop 0
    buffer_load_dwordx4 v65, s[20:23], s83 offen lds
    s_add_u32 m0, s85, 16384
    s_mov_b32 s83, 0x40000
    buffer_load_dwordx4 v64, s[24:27], s83 offen lds
    s_add_u32 m0, s85, 20480
    s_nop 0
    buffer_load_dwordx4 v65, s[24:27], s83 offen lds
    v_lshlrev_b32 v144, 16, v32
    v_and_b32 v145, 0xffff0000, v32
    v_lshlrev_b32 v146, 16, v33
    v_and_b32 v147, 0xffff0000, v33
    v_lshlrev_b32 v148, 16, v34
    v_and_b32 v149, 0xffff0000, v34
    v_lshlrev_b32 v150, 16, v35
    v_and_b32 v151, 0xffff0000, v35
    v_mul_f32 v144, 0x3e0293ee, v144
    v_mul_f32 v145, 0x3e0293ee, v145
    v_mul_f32 v146, 0x3e0293ee, v146
    v_mul_f32 v147, 0x3e0293ee, v147
    v_mul_f32 v148, 0x3e0293ee, v148
    v_mul_f32 v149, 0x3e0293ee, v149
    v_mul_f32 v150, 0x3e0293ee, v150
    v_mul_f32 v151, 0x3e0293ee, v151
    v_cvt_pk_bf16_f32 v32, v144, v145
    v_cvt_pk_bf16_f32 v33, v146, v147
    v_cvt_pk_bf16_f32 v34, v148, v149
    v_cvt_pk_bf16_f32 v35, v150, v151
    v_lshlrev_b32 v152, 16, v36
    v_and_b32 v153, 0xffff0000, v36
    v_lshlrev_b32 v154, 16, v37
    v_and_b32 v155, 0xffff0000, v37
    v_lshlrev_b32 v156, 16, v38
    v_and_b32 v157, 0xffff0000, v38
    v_lshlrev_b32 v158, 16, v39
    v_and_b32 v159, 0xffff0000, v39
    v_mul_f32 v152, 0x3e0293ee, v152
    v_mul_f32 v153, 0x3e0293ee, v153
    v_mul_f32 v154, 0x3e0293ee, v154
    v_mul_f32 v155, 0x3e0293ee, v155
    v_mul_f32 v156, 0x3e0293ee, v156
    v_mul_f32 v157, 0x3e0293ee, v157
    v_mul_f32 v158, 0x3e0293ee, v158
    v_mul_f32 v159, 0x3e0293ee, v159
    v_cvt_pk_bf16_f32 v36, v152, v153
    v_cvt_pk_bf16_f32 v37, v154, v155
    v_cvt_pk_bf16_f32 v38, v156, v157
    v_cvt_pk_bf16_f32 v39, v158, v159
    v_lshlrev_b32 v144, 16, v40
    v_and_b32 v145, 0xffff0000, v40
    v_lshlrev_b32 v146, 16, v41
    v_and_b32 v147, 0xffff0000, v41
    v_lshlrev_b32 v148, 16, v42
    v_and_b32 v149, 0xffff0000, v42
    v_lshlrev_b32 v150, 16, v43
    v_and_b32 v151, 0xffff0000, v43
    v_mul_f32 v144, 0x3e0293ee, v144
    v_mul_f32 v145, 0x3e0293ee, v145
    v_mul_f32 v146, 0x3e0293ee, v146
    v_mul_f32 v147, 0x3e0293ee, v147
    v_mul_f32 v148, 0x3e0293ee, v148
    v_mul_f32 v149, 0x3e0293ee, v149
    v_mul_f32 v150, 0x3e0293ee, v150
    v_mul_f32 v151, 0x3e0293ee, v151
    v_cvt_pk_bf16_f32 v40, v144, v145
    v_cvt_pk_bf16_f32 v41, v146, v147
    v_cvt_pk_bf16_f32 v42, v148, v149
    v_cvt_pk_bf16_f32 v43, v150, v151
    v_lshlrev_b32 v152, 16, v44
    v_and_b32 v153, 0xffff0000, v44
    v_lshlrev_b32 v154, 16, v45
    v_and_b32 v155, 0xffff0000, v45
    v_lshlrev_b32 v156, 16, v46
    v_and_b32 v157, 0xffff0000, v46
    v_lshlrev_b32 v158, 16, v47
    v_and_b32 v159, 0xffff0000, v47
    v_mul_f32 v152, 0x3e0293ee, v152
    v_mul_f32 v153, 0x3e0293ee, v153
    v_mul_f32 v154, 0x3e0293ee, v154
    v_mul_f32 v155, 0x3e0293ee, v155
    v_mul_f32 v156, 0x3e0293ee, v156
    v_mul_f32 v157, 0x3e0293ee, v157
    v_mul_f32 v158, 0x3e0293ee, v158
    v_mul_f32 v159, 0x3e0293ee, v159
    v_cvt_pk_bf16_f32 v44, v152, v153
    v_cvt_pk_bf16_f32 v45, v154, v155
    v_cvt_pk_bf16_f32 v46, v156, v157
    v_cvt_pk_bf16_f32 v47, v158, v159
    s_waitcnt vmcnt(8)
    ds_write_b32 v66, v67 offset:1040
    v_lshlrev_b32 v144, 16, v48
    v_and_b32 v145, 0xffff0000, v48
    v_lshlrev_b32 v146, 16, v49
    v_and_b32 v147, 0xffff0000, v49
    v_lshlrev_b32 v148, 16, v50
    v_and_b32 v149, 0xffff0000, v50
    v_lshlrev_b32 v150, 16, v51
    v_and_b32 v151, 0xffff0000, v51
    v_mul_f32 v144, 0x3e0293ee, v144
    v_mul_f32 v145, 0x3e0293ee, v145
    v_mul_f32 v146, 0x3e0293ee, v146
    v_mul_f32 v147, 0x3e0293ee, v147
    v_mul_f32 v148, 0x3e0293ee, v148
    v_mul_f32 v149, 0x3e0293ee, v149
    v_mul_f32 v150, 0x3e0293ee, v150
    v_mul_f32 v151, 0x3e0293ee, v151
    v_cvt_pk_bf16_f32 v48, v144, v145
    v_cvt_pk_bf16_f32 v49, v146, v147
    v_cvt_pk_bf16_f32 v50, v148, v149
    v_cvt_pk_bf16_f32 v51, v150, v151
    v_lshlrev_b32 v152, 16, v52
    v_and_b32 v153, 0xffff0000, v52
    v_lshlrev_b32 v154, 16, v53
    v_and_b32 v155, 0xffff0000, v53
    v_lshlrev_b32 v156, 16, v54
    v_and_b32 v157, 0xffff0000, v54
    v_lshlrev_b32 v158, 16, v55
    v_and_b32 v159, 0xffff0000, v55
    v_mul_f32 v152, 0x3e0293ee, v152
    v_mul_f32 v153, 0x3e0293ee, v153
    v_mul_f32 v154, 0x3e0293ee, v154
    v_mul_f32 v155, 0x3e0293ee, v155
    v_mul_f32 v156, 0x3e0293ee, v156
    v_mul_f32 v157, 0x3e0293ee, v157
    v_mul_f32 v158, 0x3e0293ee, v158
    v_mul_f32 v159, 0x3e0293ee, v159
    v_cvt_pk_bf16_f32 v52, v152, v153
    v_cvt_pk_bf16_f32 v53, v154, v155
    v_cvt_pk_bf16_f32 v54, v156, v157
    v_cvt_pk_bf16_f32 v55, v158, v159
    v_lshlrev_b32 v144, 16, v56
    v_and_b32 v145, 0xffff0000, v56
    v_lshlrev_b32 v146, 16, v57
    v_and_b32 v147, 0xffff0000, v57
    v_lshlrev_b32 v148, 16, v58
    v_and_b32 v149, 0xffff0000, v58
    v_lshlrev_b32 v150, 16, v59
    v_and_b32 v151, 0xffff0000, v59
    v_mul_f32 v144, 0x3e0293ee, v144
    v_mul_f32 v145, 0x3e0293ee, v145
    v_mul_f32 v146, 0x3e0293ee, v146
    v_mul_f32 v147, 0x3e0293ee, v147
    v_mul_f32 v148, 0x3e0293ee, v148
    v_mul_f32 v149, 0x3e0293ee, v149
    v_mul_f32 v150, 0x3e0293ee, v150
    v_mul_f32 v151, 0x3e0293ee, v151
    v_cvt_pk_bf16_f32 v56, v144, v145
    v_cvt_pk_bf16_f32 v57, v146, v147
    v_cvt_pk_bf16_f32 v58, v148, v149
    v_cvt_pk_bf16_f32 v59, v150, v151
    v_lshlrev_b32 v152, 16, v60
    v_and_b32 v153, 0xffff0000, v60
    v_lshlrev_b32 v154, 16, v61
    v_and_b32 v155, 0xffff0000, v61
    v_lshlrev_b32 v156, 16, v62
    v_and_b32 v157, 0xffff0000, v62
    v_lshlrev_b32 v158, 16, v63
    v_and_b32 v159, 0xffff0000, v63
    v_mul_f32 v152, 0x3e0293ee, v152
    v_mul_f32 v153, 0x3e0293ee, v153
    v_mul_f32 v154, 0x3e0293ee, v154
    v_mul_f32 v155, 0x3e0293ee, v155
    v_mul_f32 v156, 0x3e0293ee, v156
    v_mul_f32 v157, 0x3e0293ee, v157
    v_mul_f32 v158, 0x3e0293ee, v158
    v_mul_f32 v159, 0x3e0293ee, v159
    v_cvt_pk_bf16_f32 v60, v152, v153
    v_cvt_pk_bf16_f32 v61, v154, v155
    v_cvt_pk_bf16_f32 v62, v156, v157
    v_cvt_pk_bf16_f32 v63, v158, v159
    v_and_b32 v68, 7, v1
    v_max_u32 v68, 0, v68
    v_min_u32 v68, 7, v68
    v_mul_u32_u24 v68, 1040, v68
    v_add_u32 v68, 116224, v68
    s_mov_b32 s82, 0
L_pw_MD_3_0:
    ds_read_b32 v69, v68 offset:0
    s_waitcnt lgkmcnt(0)
    v_cmp_gt_i32 vcc, s82, v69
    s_cbranch_vccz L_pw_MD_3_0_ok
    s_sleep 1
    s_cselect_b32 s64, 1, 0
    s_sub_u32 s67, s67, 1
    s_cbranch_scc1 L_end
    s_cmp_lg_u32 s64, 0
    s_branch L_pw_MD_3_0
L_pw_MD_3_0_ok:
    s_add_u32 m0, s84, 123520
    s_mov_b32 s83, 0xa0000
    buffer_load_dwordx4 v64, s[20:23], s83 offen lds
    s_add_u32 m0, s84, 127680
    s_nop 0
    buffer_load_dwordx4 v65, s[20:23], s83 offen lds
    s_add_u32 m0, s85, 24576
    s_mov_b32 s83, 0x60000
    buffer_load_dwordx4 v64, s[24:27], s83 offen lds
    s_add_u32 m0, s85, 28672
    s_nop 0
    buffer_load_dwordx4 v65, s[24:27], s83 offen lds
    s_waitcnt vmcnt(8)
    ds_write_b32 v66, v67 offset:2080
    v_mov_b32 v15, v64
    v_readfirstlane_b32 s70, v66
    s_mov_b32 s71, s84
    s_mov_b32 s72, s85
    s_branch L_spin_h
L_md_loop:
    s_add_u32 s20, s6, s11
    s_addc_u32 s21, s7, 0
    s_mov_b32 s22, s65
    s_mov_b32 s23, 0x20000
    s_add_u32 s24, s8, s11
    s_addc_u32 s25, s9, 0
    s_mov_b32 s26, s65
    s_mov_b32 s27, 0x20000
    v_mov_b32 v191, 0x46800000
    s_waitcnt vmcnt(4)
    v_mov_b32 v14, s70
    ds_write_b32 v14, v191 offset:3120
    s_waitcnt lgkmcnt(12)
    v_mfma_f32_32x32x16_bf16 v[128:143], v[64:67], v[32:35], v[16:31]
    ds_read_b128 v[64:67], v4 offset:24960
    v_add_f32 v12, v12, v13
    v_exp_f32 v176, v144
    v_exp_f32 v177, v145
    v_mfma_f32_32x32x16_bf16 v[192:207], v[96:99], v[160:163], v[192:207]
    ds_read_b64_tr_b16 v[96:97], v8 offset:8192
    ds_read_b64_tr_b16 v[98:99], v8 offset:10240
    s_add_u32 m0, s71, 131840
    s_mov_b32 s83, 0xc0000
    buffer_load_dwordx4 v15, s[20:23], s83 offen lds
    v_exp_f32 v178, v146
    v_add_f32 v13, v176, v177
    v_cvt_pk_bf16_f32 v168, v176, v177
    v_mfma_f32_32x32x16_bf16 v[128:143], v[68:71], v[36:39], v[128:143]
    ds_read_b128 v[68:71], v4 offset:24992
    v_exp_f32 v179, v147
    v_add_f32 v13, v13, v178
    v_exp_f32 v180, v148
    v_mfma_f32_32x32x16_bf16 v[208:223], v[100:103], v[160:163], v[208:223]
    ds_read_b64_tr_b16 v[100:101], v9 offset:8192
    ds_read_b64_tr_b16 v[102:103], v9 offset:10240
    v_add_f32 v13, v13, v179
    v_cvt_pk_bf16_f32 v169, v178, v179
    v_exp_f32 v181, v149
    v_mfma_f32_32x32x16_bf16 v[128:143], v[72:75], v[40:43], v[128:143]
    ds_read_b128 v[72:75], v5 offset:24960
    ds_read_b32 v3, v0 offset:3120
    s_add_u32 m0, s71, 136000
    s_mov_b32 s83, 0xd0000
    buffer_load_dwordx4 v15, s[20:23], s83 offen lds
    v_add_f32 v13, v13, v180
    v_exp_f32 v182, v150
    v_add_f32 v13, v13, v181
    v_mfma_f32_32x32x16_bf16 v[224:239], v[104:107], v[160:163], v[224:239]
    ds_read_b64_tr_b16 v[104:105], v10 offset:8192
    ds_read_b64_tr_b16 v[106:107], v10 offset:10240
    v_cvt_pk_bf16_f32 v170, v180, v181
    v_exp_f32 v183, v151
    v_add_f32 v13, v13, v182
    v_mfma_f32_32x32x16_bf16 v[128:143], v[76:79], v[44:47], v[128:143]
    ds_read_b128 v[76:79], v5 offset:24992
    v_exp_f32 v176, v152
    v_add_f32 v13, v13, v183
    v_cvt_pk_bf16_f32 v171, v182, v183
    v_add_u32 v4, s99, v4
    v_mfma_f32_32x32x16_bf16 v[240:255], v[108:111], v[160:163], v[240:255]
    ds_read_b64_tr_b16 v[108:109], v11 offset:8192
    ds_read_b64_tr_b16 v[110:111], v11 offset:10240
    s_add_u32 m0, s72, 32768
    s_mov_b32 s83, 0x80000
    buffer_load_dwordx4 v15, s[24:27], s83 offen lds
    v_exp_f32 v177, v153
    v_add_f32 v13, v13, v176
    s_waitcnt lgkmcnt(5)
    v_mfma_f32_32x32x16_bf16 v[128:143], v[80:83], v[48:51], v[128:143]
    ds_read_b128 v[80:83], v6 offset:24960
    v_exp_f32 v178, v154
    v_add_f32 v13, v13, v177
    v_cvt_pk_bf16_f32 v172, v176, v177
    v_add_u32 v5, s99, v5
    v_mfma_f32_32x32x16_bf16 v[192:207], v[112:115], v[164:167], v[192:207]
    ds_read_b64_tr_b16 v[112:113], v8 offset:12288
    ds_read_b64_tr_b16 v[114:115], v8 offset:14336
    v_exp_f32 v179, v155
    v_add_f32 v13, v13, v178
    v_mfma_f32_32x32x16_bf16 v[128:143], v[84:87], v[52:55], v[128:143]
    ds_read_b128 v[84:87], v6 offset:24992
    s_add_u32 m0, s72, 36864
    s_mov_b32 s83, 0x90000
    buffer_load_dwordx4 v15, s[24:27], s83 offen lds
    v_exp_f32 v180, v156
    v_add_f32 v13, v13, v179
    v_cvt_pk_bf16_f32 v173, v178, v179
    v_add_u32 v6, s99, v6
    v_mfma_f32_32x32x16_bf16 v[208:223], v[116:119], v[164:167], v[208:223]
    ds_read_b64_tr_b16 v[116:117], v9 offset:12288
    ds_read_b64_tr_b16 v[118:119], v9 offset:14336
    v_exp_f32 v181, v157
    v_add_f32 v13, v13, v180
    v_mfma_f32_32x32x16_bf16 v[128:143], v[88:91], v[56:59], v[128:143]
    ds_read_b128 v[88:91], v7 offset:24960
    v_exp_f32 v182, v158
    v_add_f32 v13, v13, v181
    v_cvt_pk_bf16_f32 v174, v180, v181
    v_mfma_f32_32x32x16_bf16 v[224:239], v[120:123], v[164:167], v[224:239]
    ds_read_b64_tr_b16 v[120:121], v10 offset:12288
    ds_read_b64_tr_b16 v[122:123], v10 offset:14336
    v_exp_f32 v183, v159
    v_add_f32 v13, v13, v182
    v_add_f32 v13, v13, v183
    v_mfma_f32_32x32x16_bf16 v[128:143], v[92:95], v[60:63], v[128:143]
    ds_read_b128 v[92:95], v7 offset:24992
    v_cvt_pk_bf16_f32 v175, v182, v183
    v_cmp_lt_f32 vcc, v3, v13
    v_add_u32 v7, s99, v7
    v_mfma_f32_32x32x16_bf16 v[240:255], v[124:127], v[164:167], v[240:255]
    ds_read_b64_tr_b16 v[124:125], v11 offset:12288
    ds_read_b64_tr_b16 v[126:127], v11 offset:14336
    s_cbranch_vccnz L_rare_Amd1
L_back_Amd1:
    s_waitcnt vmcnt(4)
    v_mov_b32 v14, s70
    ds_write_b32 v14, v191 offset:4160
    s_waitcnt lgkmcnt(12)
    v_mfma_f32_32x32x16_bf16 v[144:159], v[64:67], v[32:35], v[16:31]
    ds_read_b128 v[64:67], v4 offset:16640
    v_add_f32 v12, v12, v13
    v_exp_f32 v176, v128
    v_exp_f32 v177, v129
    v_mfma_f32_32x32x16_bf16 v[192:207], v[96:99], v[168:171], v[192:207]
    ds_read_b64_tr_b16 v[96:97], v8 offset:16384
    ds_read_b64_tr_b16 v[98:99], v8 offset:18432
    s_add_u32 m0, s71, 140160
    s_mov_b32 s83, 0xe0000
    buffer_load_dwordx4 v15, s[20:23], s83 offen lds
    v_exp_f32 v178, v130
    v_add_f32 v13, v176, v177
    v_cvt_pk_bf16_f32 v160, v176, v177
    v_mfma_f32_32x32x16_bf16 v[144:159], v[68:71], v[36:39], v[144:159]
    ds_read_b128 v[68:71], v4 offset:16672
    v_exp_f32 v179, v131
    v_add_f32 v13, v13, v178
    v_exp_f32 v180, v132
    v_mfma_f32_32x32x16_bf16 v[208:223], v[100:103], v[168:171], v[208:223]
    ds_read_b64_tr_b16 v[100:101], v9 offset:16384
    ds_read_b64_tr_b16 v[102:103], v9 offset:18432
    v_add_f32 v13, v13, v179
    v_cvt_pk_bf16_f32 v161, v178, v179
    v_exp_f32 v181, v133
    v_mfma_f32_32x32x16_bf16 v[144:159], v[72:75], v[40:43], v[144:159]
    ds_read_b128 v[72:75], v5 offset:16640
    ds_read_b32 v3, v0 offset:4160
    s_add_u32 m0, s71, 144320
    s_mov_b32 s83, 0xf0000
    buffer_load_dwordx4 v15, s[20:23], s83 offen lds
    v_add_f32 v13, v13, v180
    v_exp_f32 v182, v134
    v_add_f32 v13, v13, v181
    v_mfma_f32_32x32x16_bf16 v[224:239], v[104:107], v[168:171], v[224:239]
    ds_read_b64_tr_b16 v[104:105], v10 offset:16384
    ds_read_b64_tr_b16 v[106:107], v10 offset:18432
    v_cvt_pk_bf16_f32 v162, v180, v181
    v_exp_f32 v183, v135
    v_add_f32 v13, v13, v182
    v_mfma_f32_32x32x16_bf16 v[144:159], v[76:79], v[44:47], v[144:159]
    ds_read_b128 v[76:79], v5 offset:16672
    v_exp_f32 v176, v136
    v_add_f32 v13, v13, v183
    v_cvt_pk_bf16_f32 v163, v182, v183
    v_mfma_f32_32x32x16_bf16 v[240:255], v[108:111], v[168:171], v[240:255]
    ds_read_b64_tr_b16 v[108:109], v11 offset:16384
    ds_read_b64_tr_b16 v[110:111], v11 offset:18432
    s_add_u32 m0, s72, 40960
    s_mov_b32 s83, 0xa0000
    buffer_load_dwordx4 v15, s[24:27], s83 offen lds
    v_exp_f32 v177, v137
    v_add_f32 v13, v13, v176
    s_waitcnt lgkmcnt(5)
    v_mfma_f32_32x32x16_bf16 v[144:159], v[80:83], v[48:51], v[144:159]
    ds_read_b128 v[80:83], v6 offset:16640
    ds_write_b32 v2, v0
    v_exp_f32 v178, v138
    v_add_f32 v13, v13, v177
    v_cvt_pk_bf16_f32 v164, v176, v177
    v_mfma_f32_32x32x16_bf16 v[192:207], v[112:115], v[172:175], v[192:207]
    ds_read_b64_tr_b16 v[112:113], v8 offset:20480
    ds_read_b64_tr_b16 v[114:115], v8 offset:22528
    v_exp_f32 v179, v139
    v_add_f32 v13, v13, v178
    v_add_u32 v0, 2080, v0
    v_mfma_f32_32x32x16_bf16 v[144:159], v[84:87], v[52:55], v[144:159]
    ds_read_b128 v[84:87], v6 offset:16672
    s_add_u32 m0, s72, 45056
    s_mov_b32 s83, 0xb0000
    buffer_load_dwordx4 v15, s[24:27], s83 offen lds
    v_exp_f32 v180, v140
    v_add_f32 v13, v13, v179
    v_cvt_pk_bf16_f32 v165, v178, v179
    v_add_u32 v8, s10, v8
    v_mfma_f32_32x32x16_bf16 v[208:223], v[116:119], v[172:175], v[208:223]
    ds_read_b64_tr_b16 v[116:117], v9 offset:20480
    ds_read_b64_tr_b16 v[118:119], v9 offset:22528
    v_exp_f32 v181, v141
    v_add_f32 v13, v13, v180
    v_add_u32 v9, s10, v9
    v_mfma_f32_32x32x16_bf16 v[144:159], v[88:91], v[56:59], v[144:159]
    ds_read_b128 v[88:91], v7 offset:16640
    v_exp_f32 v182, v142
    v_add_f32 v13, v13, v181
    v_cvt_pk_bf16_f32 v166, v180, v181
    v_mfma_f32_32x32x16_bf16 v[224:239], v[120:123], v[172:175], v[224:239]
    ds_read_b64_tr_b16 v[120:121], v10 offset:20480
    ds_read_b64_tr_b16 v[122:123], v10 offset:22528
    v_exp_f32 v183, v143
    v_add_f32 v13, v13, v182
    v_add_f32 v13, v13, v183
    v_mfma_f32_32x32x16_bf16 v[144:159], v[92:95], v[60:63], v[144:159]
    ds_read_b128 v[92:95], v7 offset:16672
    v_cvt_pk_bf16_f32 v167, v182, v183
    v_cmp_lt_f32 vcc, v3, v13
    v_add_u32 v10, s10, v10
    v_mfma_f32_32x32x16_bf16 v[240:255], v[124:127], v[172:175], v[240:255]
    ds_read_b64_tr_b16 v[124:125], v11 offset:20480
    ds_read_b64_tr_b16 v[126:127], v11 offset:22528
    v_add_u32 v11, s10, v11
    s_cbranch_vccnz L_rare_Bmd2
L_back_Bmd2:
    s_waitcnt vmcnt(4)
    v_mov_b32 v14, s70
    ds_write_b32 v14, v191 offset:5200
    s_waitcnt lgkmcnt(12)
    v_mfma_f32_32x32x16_bf16 v[128:143], v[64:67], v[32:35], v[16:31]
    ds_read_b128 v[64:67], v4 offset:24960
    v_add_f32 v12, v12, v13
    v_exp_f32 v176, v144
    v_exp_f32 v177, v145
    v_mfma_f32_32x32x16_bf16 v[192:207], v[96:99], v[160:163], v[192:207]
    ds_read_b64_tr_b16 v[96:97], v8 offset:8192
    ds_read_b64_tr_b16 v[98:99], v8 offset:10240
    s_add_u32 m0, s72, 49152
    s_mov_b32 s83, 0xc0000
    buffer_load_dwordx4 v15, s[24:27], s83 offen lds
    v_exp_f32 v178, v146
    v_add_f32 v13, v176, v177
    v_cvt_pk_bf16_f32 v168, v176, v177
    v_mfma_f32_32x32x16_bf16 v[128:143], v[68:71], v[36:39], v[128:143]
    ds_read_b128 v[68:71], v4 offset:24992
    v_exp_f32 v179, v147
    v_add_f32 v13, v13, v178
    v_exp_f32 v180, v148
    v_mfma_f32_32x32x16_bf16 v[208:223], v[100:103], v[160:163], v[208:223]
    ds_read_b64_tr_b16 v[100:101], v9 offset:8192
    ds_read_b64_tr_b16 v[102:103], v9 offset:10240
    v_add_f32 v13, v13, v179
    v_cvt_pk_bf16_f32 v169, v178, v179
    v_exp_f32 v181, v149
    v_mfma_f32_32x32x16_bf16 v[128:143], v[72:75], v[40:43], v[128:143]
    ds_read_b128 v[72:75], v5 offset:24960
    ds_read_b32 v3, v0 offset:3120
    s_add_u32 m0, s72, 53248
    s_mov_b32 s83, 0xd0000
    buffer_load_dwordx4 v15, s[24:27], s83 offen lds
    v_add_f32 v13, v13, v180
    v_exp_f32 v182, v150
    v_add_f32 v13, v13, v181
    v_mfma_f32_32x32x16_bf16 v[224:239], v[104:107], v[160:163], v[224:239]
    ds_read_b64_tr_b16 v[104:105], v10 offset:8192
    ds_read_b64_tr_b16 v[106:107], v10 offset:10240
    v_cvt_pk_bf16_f32 v170, v180, v181
    v_exp_f32 v183, v151
    v_add_f32 v13, v13, v182
    v_mfma_f32_32x32x16_bf16 v[128:143], v[76:79], v[44:47], v[128:143]
    ds_read_b128 v[76:79], v5 offset:24992
    v_exp_f32 v176, v152
    v_add_f32 v13, v13, v183
    v_cvt_pk_bf16_f32 v171, v182, v183
    v_add_u32 v4, s99, v4
    v_mfma_f32_32x32x16_bf16 v[240:255], v[108:111], v[160:163], v[240:255]
    ds_read_b64_tr_b16 v[108:109], v11 offset:8192
    ds_read_b64_tr_b16 v[110:111], v11 offset:10240
    v_exp_f32 v177, v153
    v_add_f32 v13, v13, v176
    s_waitcnt lgkmcnt(5)
    v_mfma_f32_32x32x16_bf16 v[128:143], v[80:83], v[48:51], v[128:143]
    ds_read_b128 v[80:83], v6 offset:24960
    v_exp_f32 v178, v154
    v_add_f32 v13, v13, v177
    v_cvt_pk_bf16_f32 v172, v176, v177
    v_add_u32 v5, s99, v5
    v_mfma_f32_32x32x16_bf16 v[192:207], v[112:115], v[164:167], v[192:207]
    ds_read_b64_tr_b16 v[112:113], v8 offset:12288
    ds_read_b64_tr_b16 v[114:115], v8 offset:14336
    v_exp_f32 v179, v155
    v_add_f32 v13, v13, v178
    v_mfma_f32_32x32x16_bf16 v[128:143], v[84:87], v[52:55], v[128:143]
    ds_read_b128 v[84:87], v6 offset:24992
    v_exp_f32 v180, v156
    v_add_f32 v13, v13, v179
    v_cvt_pk_bf16_f32 v173, v178, v179
    v_add_u32 v6, s99, v6
    v_mfma_f32_32x32x16_bf16 v[208:223], v[116:119], v[164:167], v[208:223]
    ds_read_b64_tr_b16 v[116:117], v9 offset:12288
    ds_read_b64_tr_b16 v[118:119], v9 offset:14336
    v_exp_f32 v181, v157
    v_add_f32 v13, v13, v180
    v_mfma_f32_32x32x16_bf16 v[128:143], v[88:91], v[56:59], v[128:143]
    ds_read_b128 v[88:91], v7 offset:24960
    v_exp_f32 v182, v158
    v_add_f32 v13, v13, v181
    v_cvt_pk_bf16_f32 v174, v180, v181
    v_mfma_f32_32x32x16_bf16 v[224:239], v[120:123], v[164:167], v[224:239]
    ds_read_b64_tr_b16 v[120:121], v10 offset:12288
    ds_read_b64_tr_b16 v[122:123], v10 offset:14336
    v_exp_f32 v183, v159
    v_add_f32 v13, v13, v182
    v_add_f32 v13, v13, v183
    v_mfma_f32_32x32x16_bf16 v[128:143], v[92:95], v[60:63], v[128:143]
    ds_read_b128 v[92:95], v7 offset:24992
    v_cvt_pk_bf16_f32 v175, v182, v183
    v_cmp_lt_f32 vcc, v3, v13
    v_add_u32 v7, s99, v7
    v_mfma_f32_32x32x16_bf16 v[240:255], v[124:127], v[164:167], v[240:255]
    ds_read_b64_tr_b16 v[124:125], v11 offset:12288
    ds_read_b64_tr_b16 v[126:127], v11 offset:14336
    s_cbranch_vccnz L_rare_Amd3
L_back_Amd3:
    s_waitcnt vmcnt(2)
    v_mov_b32 v14, s70
    ds_write_b32 v14, v191 offset:6240
    s_waitcnt lgkmcnt(12)
    v_mfma_f32_32x32x16_bf16 v[144:159], v[64:67], v[32:35], v[16:31]
    ds_read_b128 v[64:67], v4 offset:16640
    v_add_f32 v12, v12, v13
    v_exp_f32 v176, v128
    v_exp_f32 v177, v129
    v_mfma_f32_32x32x16_bf16 v[192:207], v[96:99], v[168:171], v[192:207]
    ds_read_b64_tr_b16 v[96:97], v8 offset:16384
    ds_read_b64_tr_b16 v[98:99], v8 offset:18432
    s_add_u32 m0, s72, 57344
    s_mov_b32 s83, 0xe0000
    buffer_load_dwordx4 v15, s[24:27], s83 offen lds
    v_exp_f32 v178, v130
    v_add_f32 v13, v176, v177
    v_cvt_pk_bf16_f32 v160, v176, v177
    v_mfma_f32_32x32x16_bf16 v[144:159], v[68:71], v[36:39], v[144:159]
    ds_read_b128 v[68:71], v4 offset:16672
    v_exp_f32 v179, v131
    v_add_f32 v13, v13, v178
    v_exp_f32 v180, v132
    v_mfma_f32_32x32x16_bf16 v[208:223], v[100:103], v[168:171], v[208:223]
    ds_read_b64_tr_b16 v[100:101], v9 offset:16384
    ds_read_b64_tr_b16 v[102:103], v9 offset:18432
    v_add_f32 v13, v13, v179
    v_cvt_pk_bf16_f32 v161, v178, v179
    v_exp_f32 v181, v133
    v_mfma_f32_32x32x16_bf16 v[144:159], v[72:75], v[40:43], v[144:159]
    ds_read_b128 v[72:75], v5 offset:16640
    ds_read_b32 v3, v0 offset:4160
    s_add_u32 m0, s72, 61440
    s_mov_b32 s83, 0xf0000
    buffer_load_dwordx4 v15, s[24:27], s83 offen lds
    v_add_f32 v13, v13, v180
    v_exp_f32 v182, v134
    v_add_f32 v13, v13, v181
    v_mfma_f32_32x32x16_bf16 v[224:239], v[104:107], v[168:171], v[224:239]
    ds_read_b64_tr_b16 v[104:105], v10 offset:16384
    ds_read_b64_tr_b16 v[106:107], v10 offset:18432
    v_cvt_pk_bf16_f32 v162, v180, v181
    v_exp_f32 v183, v135
    v_add_f32 v13, v13, v182
    v_mfma_f32_32x32x16_bf16 v[144:159], v[76:79], v[44:47], v[144:159]
    ds_read_b128 v[76:79], v5 offset:16672
    v_exp_f32 v176, v136
    v_add_f32 v13, v13, v183
    v_cvt_pk_bf16_f32 v163, v182, v183
    v_mfma_f32_32x32x16_bf16 v[240:255], v[108:111], v[168:171], v[240:255]
    ds_read_b64_tr_b16 v[108:109], v11 offset:16384
    ds_read_b64_tr_b16 v[110:111], v11 offset:18432
    v_exp_f32 v177, v137
    v_add_f32 v13, v13, v176
    s_waitcnt lgkmcnt(5)
    v_mfma_f32_32x32x16_bf16 v[144:159], v[80:83], v[48:51], v[144:159]
    ds_read_b128 v[80:83], v6 offset:16640
    ds_write_b32 v2, v0
    v_exp_f32 v178, v138
    v_add_f32 v13, v13, v177
    v_cvt_pk_bf16_f32 v164, v176, v177
    v_mfma_f32_32x32x16_bf16 v[192:207], v[112:115], v[172:175], v[192:207]
    ds_read_b64_tr_b16 v[112:113], v8 offset:20480
    ds_read_b64_tr_b16 v[114:115], v8 offset:22528
    v_exp_f32 v179, v139
    v_add_f32 v13, v13, v178
    v_add_u32 v0, 2080, v0
    v_mfma_f32_32x32x16_bf16 v[144:159], v[84:87], v[52:55], v[144:159]
    ds_read_b128 v[84:87], v6 offset:16672
    v_exp_f32 v180, v140
    v_add_f32 v13, v13, v179
    v_cvt_pk_bf16_f32 v165, v178, v179
    v_add_u32 v8, s10, v8
    v_mfma_f32_32x32x16_bf16 v[208:223], v[116:119], v[172:175], v[208:223]
    ds_read_b64_tr_b16 v[116:117], v9 offset:20480
    ds_read_b64_tr_b16 v[118:119], v9 offset:22528
    v_exp_f32 v181, v141
    v_add_f32 v13, v13, v180
    v_add_u32 v9, s10, v9
    v_mfma_f32_32x32x16_bf16 v[144:159], v[88:91], v[56:59], v[144:159]
    ds_read_b128 v[88:91], v7 offset:16640
    v_exp_f32 v182, v142
    v_add_f32 v13, v13, v181
    v_cvt_pk_bf16_f32 v166, v180, v181
    v_mfma_f32_32x32x16_bf16 v[224:239], v[120:123], v[172:175], v[224:239]
    ds_read_b64_tr_b16 v[120:121], v10 offset:20480
    ds_read_b64_tr_b16 v[122:123], v10 offset:22528
    v_exp_f32 v183, v143
    v_add_f32 v13, v13, v182
    v_add_f32 v13, v13, v183
    v_mfma_f32_32x32x16_bf16 v[144:159], v[92:95], v[60:63], v[144:159]
    ds_read_b128 v[92:95], v7 offset:16672
    v_cvt_pk_bf16_f32 v167, v182, v183
    v_cmp_lt_f32 vcc, v3, v13
    v_add_u32 v10, s10, v10
    v_mfma_f32_32x32x16_bf16 v[240:255], v[124:127], v[172:175], v[240:255]
    ds_read_b64_tr_b16 v[124:125], v11 offset:20480
    ds_read_b64_tr_b16 v[126:127], v11 offset:22528
    v_add_u32 v11, s10, v11
    s_cbranch_vccnz L_rare_Bmd4
L_back_Bmd4:
    s_waitcnt vmcnt(2)
    v_mov_b32 v14, s70
    ds_write_b32 v14, v191 offset:7280
    s_waitcnt lgkmcnt(12)
    v_mfma_f32_32x32x16_bf16 v[128:143], v[64:67], v[32:35], v[16:31]
    ds_read_b128 v[64:67], v4 offset:24960
    v_add_f32 v12, v12, v13
    v_exp_f32 v176, v144
    v_exp_f32 v177, v145
    v_mfma_f32_32x32x16_bf16 v[192:207], v[96:99], v[160:163], v[192:207]
    ds_read_b64_tr_b16 v[96:97], v8 offset:8192
    ds_read_b64_tr_b16 v[98:99], v8 offset:10240
    v_exp_f32 v178, v146
    v_add_f32 v13, v176, v177
    v_cvt_pk_bf16_f32 v168, v176, v177
    v_mfma_f32_32x32x16_bf16 v[128:143], v[68:71], v[36:39], v[128:143]
    ds_read_b128 v[68:71], v4 offset:24992
    v_exp_f32 v179, v147
    v_add_f32 v13, v13, v178
    v_exp_f32 v180, v148
    v_mfma_f32_32x32x16_bf16 v[208:223], v[100:103], v[160:163], v[208:223]
    ds_read_b64_tr_b16 v[100:101], v9 offset:8192
    ds_read_b64_tr_b16 v[102:103], v9 offset:10240
    v_add_f32 v13, v13, v179
    v_cvt_pk_bf16_f32 v169, v178, v179
    v_exp_f32 v181, v149
    v_mfma_f32_32x32x16_bf16 v[128:143], v[72:75], v[40:43], v[128:143]
    ds_read_b128 v[72:75], v5 offset:24960
    ds_read_b32 v3, v0 offset:3120
    v_add_f32 v13, v13, v180
    v_exp_f32 v182, v150
    v_add_f32 v13, v13, v181
    v_mfma_f32_32x32x16_bf16 v[224:239], v[104:107], v[160:163], v[224:239]
    ds_read_b64_tr_b16 v[104:105], v10 offset:8192
    ds_read_b64_tr_b16 v[106:107], v10 offset:10240
    v_cvt_pk_bf16_f32 v170, v180, v181
    v_exp_f32 v183, v151
    v_add_f32 v13, v13, v182
    v_mfma_f32_32x32x16_bf16 v[128:143], v[76:79], v[44:47], v[128:143]
    ds_read_b128 v[76:79], v5 offset:24992
    v_exp_f32 v176, v152
    v_add_f32 v13, v13, v183
    v_cvt_pk_bf16_f32 v171, v182, v183
    v_add_u32 v4, s99, v4
    v_mfma_f32_32x32x16_bf16 v[240:255], v[108:111], v[160:163], v[240:255]
    ds_read_b64_tr_b16 v[108:109], v11 offset:8192
    ds_read_b64_tr_b16 v[110:111], v11 offset:10240
    v_exp_f32 v177, v153
    v_add_f32 v13, v13, v176
    s_waitcnt lgkmcnt(5)
    v_mfma_f32_32x32x16_bf16 v[128:143], v[80:83], v[48:51], v[128:143]
    ds_read_b128 v[80:83], v6 offset:24960
    v_exp_f32 v178, v154
    v_add_f32 v13, v13, v177
    v_cvt_pk_bf16_f32 v172, v176, v177
    v_add_u32 v5, s99, v5
    v_mfma_f32_32x32x16_bf16 v[192:207], v[112:115], v[164:167], v[192:207]
    ds_read_b64_tr_b16 v[112:113], v8 offset:12288
    ds_read_b64_tr_b16 v[114:115], v8 offset:14336
    v_exp_f32 v179, v155
    v_add_f32 v13, v13, v178
    v_mfma_f32_32x32x16_bf16 v[128:143], v[84:87], v[52:55], v[128:143]
    ds_read_b128 v[84:87], v6 offset:24992
    v_exp_f32 v180, v156
    v_add_f32 v13, v13, v179
    v_cvt_pk_bf16_f32 v173, v178, v179
    v_add_u32 v6, s99, v6
    v_mfma_f32_32x32x16_bf16 v[208:223], v[116:119], v[164:167], v[208:223]
    ds_read_b64_tr_b16 v[116:117], v9 offset:12288
    ds_read_b64_tr_b16 v[118:119], v9 offset:14336
    v_exp_f32 v181, v157
    v_add_f32 v13, v13, v180
    v_mfma_f32_32x32x16_bf16 v[128:143], v[88:91], v[56:59], v[128:143]
    ds_read_b128 v[88:91], v7 offset:24960
    v_exp_f32 v182, v158
    v_add_f32 v13, v13, v181
    v_cvt_pk_bf16_f32 v174, v180, v181
    v_mfma_f32_32x32x16_bf16 v[224:239], v[120:123], v[164:167], v[224:239]
    ds_read_b64_tr_b16 v[120:121], v10 offset:12288
    ds_read_b64_tr_b16 v[122:123], v10 offset:14336
    v_exp_f32 v183, v159
    v_add_f32 v13, v13, v182
    v_add_f32 v13, v13, v183
    v_mfma_f32_32x32x16_bf16 v[128:143], v[92:95], v[60:63], v[128:143]
    ds_read_b128 v[92:95], v7 offset:24992
    v_cvt_pk_bf16_f32 v175, v182, v183
    v_cmp_lt_f32 vcc, v3, v13
    v_add_u32 v7, s99, v7
    v_mfma_f32_32x32x16_bf16 v[240:255], v[124:127], v[164:167], v[240:255]
    ds_read_b64_tr_b16 v[124:125], v11 offset:12288
    ds_read_b64_tr_b16 v[126:127], v11 offset:14336
    s_cbranch_vccnz L_rare_Amd5
L_back_Amd5:
    s_waitcnt vmcnt(0)
    v_mov_b32 v14, s70
    ds_write_b32 v14, v191 offset:8320
    s_waitcnt lgkmcnt(12)
    v_mfma_f32_32x32x16_bf16 v[144:159], v[64:67], v[32:35], v[16:31]
    ds_read_b128 v[64:67], v4 offset:16640
    v_add_f32 v12, v12, v13
    v_exp_f32 v176, v128
    v_exp_f32 v177, v129
    v_mfma_f32_32x32x16_bf16 v[192:207], v[96:99], v[168:171], v[192:207]
    ds_read_b64_tr_b16 v[96:97], v8 offset:16384
    ds_read_b64_tr_b16 v[98:99], v8 offset:18432
    v_exp_f32 v178, v130
    v_add_f32 v13, v176, v177
    v_cvt_pk_bf16_f32 v160, v176, v177
    v_mfma_f32_32x32x16_bf16 v[144:159], v[68:71], v[36:39], v[144:159]
    ds_read_b128 v[68:71], v4 offset:16672
    v_exp_f32 v179, v131
    v_add_f32 v13, v13, v178
    v_exp_f32 v180, v132
    v_mfma_f32_32x32x16_bf16 v[208:223], v[100:103], v[168:171], v[208:223]
    ds_read_b64_tr_b16 v[100:101], v9 offset:16384
    ds_read_b64_tr_b16 v[102:103], v9 offset:18432
    v_add_f32 v13, v13, v179
    v_cvt_pk_bf16_f32 v161, v178, v179
    v_exp_f32 v181, v133
    v_mfma_f32_32x32x16_bf16 v[144:159], v[72:75], v[40:43], v[144:159]
    ds_read_b128 v[72:75], v5 offset:16640
    ds_read_b32 v3, v0 offset:4160
    v_add_f32 v13, v13, v180
    v_exp_f32 v182, v134
    v_add_f32 v13, v13, v181
    v_mfma_f32_32x32x16_bf16 v[224:239], v[104:107], v[168:171], v[224:239]
    ds_read_b64_tr_b16 v[104:105], v10 offset:16384
    ds_read_b64_tr_b16 v[106:107], v10 offset:18432
    v_cvt_pk_bf16_f32 v162, v180, v181
    v_exp_f32 v183, v135
    v_add_f32 v13, v13, v182
    v_mfma_f32_32x32x16_bf16 v[144:159], v[76:79], v[44:47], v[144:159]
    ds_read_b128 v[76:79], v5 offset:16672
    v_exp_f32 v176, v136
    v_add_f32 v13, v13, v183
    v_cvt_pk_bf16_f32 v163, v182, v183
    v_mfma_f32_32x32x16_bf16 v[240:255], v[108:111], v[168:171], v[240:255]
    ds_read_b64_tr_b16 v[108:109], v11 offset:16384
    ds_read_b64_tr_b16 v[110:111], v11 offset:18432
    v_exp_f32 v177, v137
    v_add_f32 v13, v13, v176
    s_waitcnt lgkmcnt(5)
    v_mfma_f32_32x32x16_bf16 v[144:159], v[80:83], v[48:51], v[144:159]
    ds_read_b128 v[80:83], v6 offset:16640
    ds_write_b32 v2, v0
    v_exp_f32 v178, v138
    v_add_f32 v13, v13, v177
    v_cvt_pk_bf16_f32 v164, v176, v177
    v_mfma_f32_32x32x16_bf16 v[192:207], v[112:115], v[172:175], v[192:207]
    ds_read_b64_tr_b16 v[112:113], v8 offset:20480
    ds_read_b64_tr_b16 v[114:115], v8 offset:22528
    v_exp_f32 v179, v139
    v_add_f32 v13, v13, v178
    v_add_u32 v0, 2080, v0
    v_mfma_f32_32x32x16_bf16 v[144:159], v[84:87], v[52:55], v[144:159]
    ds_read_b128 v[84:87], v6 offset:16672
    v_exp_f32 v180, v140
    v_add_f32 v13, v13, v179
    v_cvt_pk_bf16_f32 v165, v178, v179
    v_add_u32 v8, s10, v8
    v_mfma_f32_32x32x16_bf16 v[208:223], v[116:119], v[172:175], v[208:223]
    ds_read_b64_tr_b16 v[116:117], v9 offset:20480
    ds_read_b64_tr_b16 v[118:119], v9 offset:22528
    v_exp_f32 v181, v141
    v_add_f32 v13, v13, v180
    v_add_u32 v9, s10, v9
    v_mfma_f32_32x32x16_bf16 v[144:159], v[88:91], v[56:59], v[144:159]
    ds_read_b128 v[88:91], v7 offset:16640
    v_exp_f32 v182, v142
    v_add_f32 v13, v13, v181
    v_cvt_pk_bf16_f32 v166, v180, v181
    v_mfma_f32_32x32x16_bf16 v[224:239], v[120:123], v[172:175], v[224:239]
    ds_read_b64_tr_b16 v[120:121], v10 offset:20480
    ds_read_b64_tr_b16 v[122:123], v10 offset:22528
    v_exp_f32 v183, v143
    v_add_f32 v13, v13, v182
    v_add_f32 v13, v13, v183
    v_mfma_f32_32x32x16_bf16 v[144:159], v[92:95], v[60:63], v[144:159]
    ds_read_b128 v[92:95], v7 offset:16672
    v_cvt_pk_bf16_f32 v167, v182, v183
    v_cmp_lt_f32 vcc, v3, v13
    v_add_u32 v10, s10, v10
    v_mfma_f32_32x32x16_bf16 v[240:255], v[124:127], v[172:175], v[240:255]
    ds_read_b64_tr_b16 v[124:125], v11 offset:20480
    ds_read_b64_tr_b16 v[126:127], v11 offset:22528
    v_add_u32 v11, s10, v11
    s_cbranch_vccnz L_rare_Bmd6
L_back_Bmd6:
    v_mov_b32 v15, 0xff800000
    s_branch L_tail_odd
L_prog_4:
    s_setprio 2
    s_waitcnt vmcnt(0)
    ds_write_b32 v66, v67 offset:1040
    s_add_u32 m0, s84, 106880
    s_mov_b32 s83, 0x60000
    buffer_load_dwordx4 v64, s[20:23], s83 offen lds
    s_add_u32 m0, s84, 111040
    s_nop 0
    buffer_load_dwordx4 v65, s[20:23], s83 offen lds
    s_add_u32 m0, s85, 8192
    s_mov_b32 s83, 0x20000
    buffer_load_dwordx4 v64, s[24:27], s83 offen lds
    s_add_u32 m0, s85, 12288
    s_nop 0
    buffer_load_dwordx4 v65, s[24:27], s83 offen lds
    s_add_u32 m0, s84, 115200
    s_mov_b32 s83, 0x80000
    buffer_load_dwordx4 v64, s[20:23], s83 offen lds
    s_add_u32 m0, s84, 119360
    s_nop 0
    buffer_load_dwordx4 v65, s[20:23], s83 offen lds
    s_add_u32 m0, s85, 16384
    s_mov_b32 s83, 0x40000
    buffer_load_dwordx4 v64, s[24:27], s83 offen lds
    s_add_u32 m0, s85, 20480
    s_nop 0
    buffer_load_dwordx4 v65, s[24:27], s83 offen lds
    s_add_u32 m0, s84, 123520
    s_mov_b32 s83, 0xa0000
    buffer_load_dwordx4 v64, s[20:23], s83 offen lds
    s_add_u32 m0, s84, 127680
    s_nop 0
    buffer_load_dwordx4 v65, s[20:23], s83 offen lds
    s_add_u32 m0, s85, 24576
    s_mov_b32 s83, 0x60000
    buffer_load_dwordx4 v64, s[24:27], s83 offen lds
    s_add_u32 m0, s85, 28672
    s_nop 0
    buffer_load_dwordx4 v65, s[24:27], s83 offen lds
    s_add_u32 m0, s84, 131840
    s_mov_b32 s83, 0xc0000
    buffer_load_dwordx4 v64, s[20:23], s83 offen lds
    s_add_u32 m0, s84, 136000
    s_nop 0
    buffer_load_dwordx4 v65, s[20:23], s83 offen lds
    s_add_u32 m0, s85, 32768
    s_mov_b32 s83, 0x80000
    buffer_load_dwordx4 v64, s[24:27], s83 offen lds
    s_add_u32 m0, s85, 36864
    s_nop 0
    buffer_load_dwordx4 v65, s[24:27], s83 offen lds
    s_waitcnt vmcnt(12)
    ds_write_b32 v66, v67 offset:2080
    v_and_b32 v68, 7, v1
    v_max_u32 v68, 0, v68
    v_min_u32 v68, 3, v68
    v_mul_u32_u24 v68, 1040, v68
    v_add_u32 v68, 116224, v68
    s_mov_b32 s82, 0
L_pw_L4_14_4_0:
    ds_read_b32 v69, v68 offset:0
    s_waitcnt lgkmcnt(0)
    v_cmp_gt_i32 vcc, s82, v69
    s_cbranch_vccz L_pw_L4_14_4_0_ok
    s_sleep 1
    s_cselect_b32 s64, 1, 0
    s_sub_u32 s67, s67, 1
    s_cbranch_scc1 L_end
    s_cmp_lg_u32 s64, 0
    s_branch L_pw_L4_14_4_0
L_pw_L4_14_4_0_ok:
    s_add_u32 m0, s84, 140160
    s_mov_b32 s83, 0xe0000
    buffer_load_dwordx4 v64, s[20:23], s83 offen lds
    s_add_u32 m0, s84, 144320
    s_nop 0
    buffer_load_dwordx4 v65, s[20:23], s83 offen lds
    s_add_u32 m0, s85, 40960
    s_mov_b32 s83, 0xa0000
    buffer_load_dwordx4 v64, s[24:27], s83 offen lds
    s_add_u32 m0, s85, 45056
    s_nop 0
    buffer_load_dwordx4 v65, s[24:27], s83 offen lds
    s_waitcnt vmcnt(12)
    ds_write_b32 v66, v67 offset:3120
    v_and_b32 v68, 7, v1
    v_max_u32 v68, 0, v68
    v_min_u32 v68, 3, v68
    v_mul_u32_u24 v68, 1040, v68
    v_add_u32 v68, 116224, v68
    s_mov_b32 s82, 1
L_pw_L4_14_4_1:
    ds_read_b32 v69, v68 offset:0
    s_waitcnt lgkmcnt(0)
    v_cmp_gt_i32 vcc, s82, v69
    s_cbranch_vccz L_pw_L4_14_4_1_ok
    s_sleep 1
    s_cselect_b32 s64, 1, 0
    s_sub_u32 s67, s67, 1
    s_cbranch_scc1 L_end
    s_cmp_lg_u32 s64, 0
    s_branch L_pw_L4_14_4_1
L_pw_L4_14_4_1_ok:
    s_add_u32 m0, s84, 81920
    s_mov_b32 s83, 0x100000
    buffer_load_dwordx4 v64, s[20:23], s83 offen lds
    s_add_u32 m0, s84, 86080
    s_nop 0
    buffer_load_dwordx4 v65, s[20:23], s83 offen lds
    s_add_u32 m0, s85, 49152
    s_mov_b32 s83, 0xc0000
    buffer_load_dwordx4 v64, s[24:27], s83 offen lds
    s_add_u32 m0, s85, 53248
    s_nop 0
    buffer_load_dwordx4 v65, s[24:27], s83 offen lds
    s_waitcnt vmcnt(12)
    ds_write_b32 v66, v67 offset:4160
    s_add_u32 m0, s84, 90240
    s_mov_b32 s83, 0x120000
    buffer_load_dwordx4 v64, s[20:23], s83 offen lds
    s_add_u32 m0, s84, 94400
    s_nop 0
    buffer_load_dwordx4 v65, s[20:23], s83 offen lds
    s_add_u32 m0, s85, 57344
    s_mov_b32 s83, 0xe0000
    buffer_load_dwordx4 v64, s[24:27], s83 offen lds
    s_add_u32 m0, s85, 61440
    s_nop 0
    buffer_load_dwordx4 v65, s[24:27], s83 offen lds
    s_waitcnt vmcnt(12)
    ds_write_b32 v66, v67 offset:5200
    v_and_b32 v68, 7, v1
    v_max_u32 v68, 0, v68
    v_min_u32 v68, 3, v68
    v_mul_u32_u24 v68, 1040, v68
    v_add_u32 v68, 116224, v68
    s_mov_b32 s82, 82944
L_pw_L4_14_4_2:
    ds_read_b32 v69, v68 offset:4
    s_waitcnt lgkmcnt(0)
    v_cmp_gt_i32 vcc, s82, v69
    s_cbranch_vccz L_pw_L4_14_4_2_ok
    s_sleep 1
    s_cselect_b32 s64, 1, 0
    s_sub_u32 s67, s67, 1
    s_cbranch_scc1 L_end
    s_cmp_lg_u32 s64, 0
    s_branch L_pw_L4_14_4_2
L_pw_L4_14_4_2_ok:
    s_add_u32 m0, s84, 98560
    s_mov_b32 s83, 0x140000
    buffer_load_dwordx4 v64, s[20:23], s83 offen lds
    s_add_u32 m0, s84, 102720
    s_nop 0
    buffer_load_dwordx4 v65, s[20:23], s83 offen lds
    s_add_u32 m0, s85, 65536
    s_mov_b32 s83, 0x100000
    buffer_load_dwordx4 v64, s[24:27], s83 offen lds
    s_add_u32 m0, s85, 69632
    s_nop 0
    buffer_load_dwordx4 v65, s[24:27], s83 offen lds
    s_waitcnt vmcnt(12)
    ds_write_b32 v66, v67 offset:6240
    v_and_b32 v68, 7, v1
    v_max_u32 v68, 0, v68
    v_min_u32 v68, 3, v68
    v_mul_u32_u24 v68, 1040, v68
    v_add_u32 v68, 116224, v68
    s_mov_b32 s82, 82944
L_pw_L4_14_4_3:
    ds_read_b32 v69, v68 offset:0
    s_waitcnt lgkmcnt(0)
    v_cmp_gt_i32 vcc, s82, v69
    s_cbranch_vccz L_pw_L4_14_4_3_ok
    s_sleep 1
    s_cselect_b32 s64, 1, 0
    s_sub_u32 s67, s67, 1
    s_cbranch_scc1 L_end
    s_cmp_lg_u32 s64, 0
    s_branch L_pw_L4_14_4_3
L_pw_L4_14_4_3_ok:
    s_add_u32 m0, s84, 106880
    s_mov_b32 s83, 0x160000
    buffer_load_dwordx4 v64, s[20:23], s83 offen lds
    s_add_u32 m0, s84, 111040
    s_nop 0
    buffer_load_dwordx4 v65, s[20:23], s83 offen lds
    s_add_u32 m0, s85, 8192
    s_mov_b32 s83, 0x120000
    buffer_load_dwordx4 v64, s[24:27], s83 offen lds
    s_add_u32 m0, s85, 12288
    s_nop 0
    buffer_load_dwordx4 v65, s[24:27], s83 offen lds
    s_waitcnt vmcnt(12)
    ds_write_b32 v66, v67 offset:7280
    v_and_b32 v68, 7, v1
    v_max_u32 v68, 0, v68
    v_min_u32 v68, 3, v68
    v_mul_u32_u24 v68, 1040, v68
    v_add_u32 v68, 116224, v68
    s_mov_b32 s82, 85024
L_pw_L4_14_4_4:
    ds_read_b32 v69, v68 offset:4
    s_waitcnt lgkmcnt(0)
    v_cmp_gt_i32 vcc, s82, v69
    s_cbranch_vccz L_pw_L4_14_4_4_ok
    s_sleep 1
    s_cselect_b32 s64, 1, 0
    s_sub_u32 s67, s67, 1
    s_cbranch_scc1 L_end
    s_cmp_lg_u32 s64, 0
    s_branch L_pw_L4_14_4_4
L_pw_L4_14_4_4_ok:
    s_add_u32 m0, s84, 115200
    s_mov_b32 s83, 0x180000
    buffer_load_dwordx4 v64, s[20:23], s83 offen lds
    s_add_u32 m0, s84, 119360
    s_nop 0
    buffer_load_dwordx4 v65, s[20:23], s83 offen lds
    s_add_u32 m0, s85, 16384
    s_mov_b32 s83, 0x140000
    buffer_load_dwordx4 v64, s[24:27], s83 offen lds
    s_add_u32 m0, s85, 20480
    s_nop 0
    buffer_load_dwordx4 v65, s[24:27], s83 offen lds
    s_waitcnt vmcnt(12)
    ds_write_b32 v66, v67 offset:8320
    v_and_b32 v68, 7, v1
    v_max_u32 v68, 0, v68
    v_min_u32 v68, 3, v68
    v_mul_u32_u24 v68, 1040, v68
    v_add_u32 v68, 116224, v68
    s_mov_b32 s82, 85024
L_pw_L4_14_4_5:
    ds_read_b32 v69, v68 offset:0
    s_waitcnt lgkmcnt(0)
    v_cmp_gt_i32 vcc, s82, v69
    s_cbranch_vccz L_pw_L4_14_4_5_ok
    s_sleep 1
    s_cselect_b32 s64, 1, 0
    s_sub_u32 s67, s67, 1
    s_cbranch_scc1 L_end
    s_cmp_lg_u32 s64, 0
    s_branch L_pw_L4_14_4_5
L_pw_L4_14_4_5_ok:
    s_add_u32 m0, s84, 123520
    s_mov_b32 s83, 0x1a0000
    buffer_load_dwordx4 v64, s[20:23], s83 offen lds
    s_add_u32 m0, s84, 127680
    s_nop 0
    buffer_load_dwordx4 v65, s[20:23], s83 offen lds
    s_add_u32 m0, s85, 24576
    s_mov_b32 s83, 0x160000
    buffer_load_dwordx4 v64, s[24:27], s83 offen lds
    s_add_u32 m0, s85, 28672
    s_nop 0
    buffer_load_dwordx4 v65, s[24:27], s83 offen lds
    s_waitcnt vmcnt(12)
    ds_write_b32 v66, v67 offset:9360
    v_and_b32 v68, 7, v1
    v_max_u32 v68, 0, v68
    v_min_u32 v68, 3, v68
    v_mul_u32_u24 v68, 1040, v68
    v_add_u32 v68, 116224, v68
    s_mov_b32 s82, 87104
L_pw_L4_14_4_6:
    ds_read_b32 v69, v68 offset:4
    s_waitcnt lgkmcnt(0)
    v_cmp_gt_i32 vcc, s82, v69
    s_cbranch_vccz L_pw_L4_14_4_6_ok
    s_sleep 1
    s_cselect_b32 s64, 1, 0
    s_sub_u32 s67, s67, 1
    s_cbranch_scc1 L_end
    s_cmp_lg_u32 s64, 0
    s_branch L_pw_L4_14_4_6
L_pw_L4_14_4_6_ok:
    s_add_u32 m0, s85, 32768
    s_mov_b32 s83, 0x180000
    buffer_load_dwordx4 v64, s[24:27], s83 offen lds
    s_add_u32 m0, s85, 36864
    s_nop 0
    buffer_load_dwordx4 v65, s[24:27], s83 offen lds
    s_waitcnt vmcnt(10)
    ds_write_b32 v66, v67 offset:10400
    v_and_b32 v68, 7, v1
    v_max_u32 v68, 0, v68
    v_min_u32 v68, 3, v68
    v_mul_u32_u24 v68, 1040, v68
    v_add_u32 v68, 116224, v68
    s_mov_b32 s82, 87104
L_pw_L4_14_4_7:
    ds_read_b32 v69, v68 offset:0
    s_waitcnt lgkmcnt(0)
    v_cmp_gt_i32 vcc, s82, v69
    s_cbranch_vccz L_pw_L4_14_4_7_ok
    s_sleep 1
    s_cselect_b32 s64, 1, 0
    s_sub_u32 s67, s67, 1
    s_cbranch_scc1 L_end
    s_cmp_lg_u32 s64, 0
    s_branch L_pw_L4_14_4_7
L_pw_L4_14_4_7_ok:
    s_add_u32 m0, s85, 40960
    s_mov_b32 s83, 0x1a0000
    buffer_load_dwordx4 v64, s[24:27], s83 offen lds
    s_add_u32 m0, s85, 45056
    s_nop 0
    buffer_load_dwordx4 v65, s[24:27], s83 offen lds
    s_waitcnt vmcnt(8)
    ds_write_b32 v66, v67 offset:11440
    s_waitcnt vmcnt(4)
    ds_write_b32 v66, v67 offset:12480
    s_waitcnt vmcnt(2)
    ds_write_b32 v66, v67 offset:13520
    s_waitcnt vmcnt(0)
    ds_write_b32 v66, v67 offset:14560
    s_waitcnt lgkmcnt(0)
    s_endpgm
L_prog_5:
    s_setprio 2
    v_mov_b32 v64, v70
    s_mov_b32 m0, 106880
    s_mov_b32 s83, 0x60000
    buffer_load_dwordx4 v64, s[20:23], s83 offen lds
    s_mov_b32 m0, 107920
    s_mov_b32 s83, 0x64000
    buffer_load_dwordx4 v64, s[20:23], s83 offen lds
    s_mov_b32 m0, 108960
    s_mov_b32 s83, 0x68000
    buffer_load_dwordx4 v64, s[20:23], s83 offen lds
    s_mov_b32 m0, 110000
    s_mov_b32 s83, 0x6c000
    buffer_load_dwordx4 v64, s[20:23], s83 offen lds
    s_mov_b32 m0, 111040
    s_mov_b32 s83, 0x70000
    buffer_load_dwordx4 v64, s[20:23], s83 offen lds
    s_mov_b32 m0, 112080
    s_mov_b32 s83, 0x74000
    buffer_load_dwordx4 v64, s[20:23], s83 offen lds
    s_mov_b32 m0, 113120
    s_mov_b32 s83, 0x78000
    buffer_load_dwordx4 v64, s[20:23], s83 offen lds
    s_mov_b32 m0, 114160
    s_mov_b32 s83, 0x7c000
    buffer_load_dwordx4 v64, s[20:23], s83 offen lds
    s_mov_b32 m0, 8192
    s_mov_b32 s83, 0x20000
    buffer_load_dwordx4 v64, s[24:27], s83 offen lds
    s_mov_b32 m0, 9216
    s_mov_b32 s83, 0x24000
    buffer_load_dwordx4 v64, s[24:27], s83 offen lds
    s_mov_b32 m0, 10240
    s_mov_b32 s83, 0x28000
    buffer_load_dwordx4 v64, s[24:27], s83 offen lds
    s_mov_b32 m0, 11264
    s_mov_b32 s83, 0x2c000
    buffer_load_dwordx4 v64, s[24:27], s83 offen lds
    s_mov_b32 m0, 12288
    s_mov_b32 s83, 0x30000
    buffer_load_dwordx4 v64, s[24:27], s83 offen lds
    s_mov_b32 m0, 13312
    s_mov_b32 s83, 0x34000
    buffer_load_dwordx4 v64, s[24:27], s83 offen lds
    s_mov_b32 m0, 14336
    s_mov_b32 s83, 0x38000
    buffer_load_dwordx4 v64, s[24:27], s83 offen lds
    s_mov_b32 m0, 15360
    s_mov_b32 s83, 0x3c000
    buffer_load_dwordx4 v64, s[24:27], s83 offen lds
    s_mov_b32 m0, 115200
    s_mov_b32 s83, 0x80000
    buffer_load_dwordx4 v64, s[20:23], s83 offen lds
    s_mov_b32 m0, 116240
    s_mov_b32 s83, 0x84000
    buffer_load_dwordx4 v64, s[20:23], s83 offen lds
    s_mov_b32 m0, 117280
    s_mov_b32 s83, 0x88000
    buffer_load_dwordx4 v64, s[20:23], s83 offen lds
    s_mov_b32 m0, 118320
    s_mov_b32 s83, 0x8c000
    buffer_load_dwordx4 v64, s[20:23], s83 offen lds
    s_mov_b32 m0, 119360
    s_mov_b32 s83, 0x90000
    buffer_load_dwordx4 v64, s[20:23], s83 offen lds
    s_mov_b32 m0, 120400
    s_mov_b32 s83, 0x94000
    buffer_load_dwordx4 v64, s[20:23], s83 offen lds
    s_mov_b32 m0, 121440
    s_mov_b32 s83, 0x98000
    buffer_load_dwordx4 v64, s[20:23], s83 offen lds
    s_mov_b32 m0, 122480
    s_mov_b32 s83, 0x9c000
    buffer_load_dwordx4 v64, s[20:23], s83 offen lds
    s_mov_b32 m0, 16384
    s_mov_b32 s83, 0x40000
    buffer_load_dwordx4 v64, s[24:27], s83 offen lds
    s_mov_b32 m0, 17408
    s_mov_b32 s83, 0x44000
    buffer_load_dwordx4 v64, s[24:27], s83 offen lds
    s_mov_b32 m0, 18432
    s_mov_b32 s83, 0x48000
    buffer_load_dwordx4 v64, s[24:27], s83 offen lds
    s_mov_b32 m0, 19456
    s_mov_b32 s83, 0x4c000
    buffer_load_dwordx4 v64, s[24:27], s83 offen lds
    s_mov_b32 m0, 20480
    s_mov_b32 s83, 0x50000
    buffer_load_dwordx4 v64, s[24:27], s83 offen lds
    s_mov_b32 m0, 21504
    s_mov_b32 s83, 0x54000
    buffer_load_dwordx4 v64, s[24:27], s83 offen lds
    s_mov_b32 m0, 22528
    s_mov_b32 s83, 0x58000
    buffer_load_dwordx4 v64, s[24:27], s83 offen lds
    s_mov_b32 m0, 23552
    s_mov_b32 s83, 0x5c000
    buffer_load_dwordx4 v64, s[24:27], s83 offen lds
    s_waitcnt vmcnt(32)
    ds_write_b32 v66, v67 offset:1040
    v_and_b32 v66, 3, v1
    v_lshlrev_b32 v66, 2, v66
    v_add_u32 v66, 82944, v66
    v_and_b32 v68, 7, v1
    v_max_u32 v68, 0, v68
    v_min_u32 v68, 2, v68
    v_mul_u32_u24 v68, 1040, v68
    v_add_u32 v68, 116224, v68
    s_mov_b32 s82, 0
L_pw_L1_10_5_0:
    ds_read_b32 v69, v68 offset:0
    s_waitcnt lgkmcnt(0)
    v_cmp_gt_i32 vcc, s82, v69
    s_cbranch_vccz L_pw_L1_10_5_0_ok
    s_sleep 1
    s_cselect_b32 s64, 1, 0
    s_sub_u32 s67, s67, 1
    s_cbranch_scc1 L_end
    s_cmp_lg_u32 s64, 0
    s_branch L_pw_L1_10_5_0
L_pw_L1_10_5_0_ok:
    s_mov_b32 m0, 123520
    s_mov_b32 s83, 0xa0000
    buffer_load_dwordx4 v64, s[20:23], s83 offen lds
    s_mov_b32 m0, 124560
    s_mov_b32 s83, 0xa4000
    buffer_load_dwordx4 v64, s[20:23], s83 offen lds
    s_mov_b32 m0, 125600
    s_mov_b32 s83, 0xa8000
    buffer_load_dwordx4 v64, s[20:23], s83 offen lds
    s_mov_b32 m0, 126640
    s_mov_b32 s83, 0xac000
    buffer_load_dwordx4 v64, s[20:23], s83 offen lds
    s_mov_b32 m0, 127680
    s_mov_b32 s83, 0xb0000
    buffer_load_dwordx4 v64, s[20:23], s83 offen lds
    s_mov_b32 m0, 128720
    s_mov_b32 s83, 0xb4000
    buffer_load_dwordx4 v64, s[20:23], s83 offen lds
    s_mov_b32 m0, 129760
    s_mov_b32 s83, 0xb8000
    buffer_load_dwordx4 v64, s[20:23], s83 offen lds
    s_mov_b32 m0, 130800
    s_mov_b32 s83, 0xbc000
    buffer_load_dwordx4 v64, s[20:23], s83 offen lds
    s_mov_b32 m0, 24576
    s_mov_b32 s83, 0x60000
    buffer_load_dwordx4 v64, s[24:27], s83 offen lds
    s_mov_b32 m0, 25600
    s_mov_b32 s83, 0x64000
    buffer_load_dwordx4 v64, s[24:27], s83 offen lds
    s_mov_b32 m0, 26624
    s_mov_b32 s83, 0x68000
    buffer_load_dwordx4 v64, s[24:27], s83 offen lds
    s_mov_b32 m0, 27648
    s_mov_b32 s83, 0x6c000
    buffer_load_dwordx4 v64, s[24:27], s83 offen lds
    s_mov_b32 m0, 28672
    s_mov_b32 s83, 0x70000
    buffer_load_dwordx4 v64, s[24:27], s83 offen lds
    s_mov_b32 m0, 29696
    s_mov_b32 s83, 0x74000
    buffer_load_dwordx4 v64, s[24:27], s83 offen lds
    s_mov_b32 m0, 30720
    s_mov_b32 s83, 0x78000
    buffer_load_dwordx4 v64, s[24:27], s83 offen lds
    s_mov_b32 m0, 31744
    s_mov_b32 s83, 0x7c000
    buffer_load_dwordx4 v64, s[24:27], s83 offen lds
    s_waitcnt vmcnt(32)
    ds_write_b32 v66, v67 offset:2080
    s_mov_b32 m0, 131840
    s_mov_b32 s83, 0xc0000
    buffer_load_dwordx4 v64, s[20:23], s83 offen lds
    s_mov_b32 m0, 132880
    s_mov_b32 s83, 0xc4000
    buffer_load_dwordx4 v64, s[20:23], s83 offen lds
    s_mov_b32 m0, 133920
    s_mov_b32 s83, 0xc8000
    buffer_load_dwordx4 v64, s[20:23], s83 offen lds
    s_mov_b32 m0, 134960
    s_mov_b32 s83, 0xcc000
    buffer_load_dwordx4 v64, s[20:23], s83 offen lds
    s_mov_b32 m0, 136000
    s_mov_b32 s83, 0xd0000
    buffer_load_dwordx4 v64, s[20:23], s83 offen lds
    s_mov_b32 m0, 137040
    s_mov_b32 s83, 0xd4000
    buffer_load_dwordx4 v64, s[20:23], s83 offen lds
    s_mov_b32 m0, 138080
    s_mov_b32 s83, 0xd8000
    buffer_load_dwordx4 v64, s[20:23], s83 offen lds
    s_mov_b32 m0, 139120
    s_mov_b32 s83, 0xdc000
    buffer_load_dwordx4 v64, s[20:23], s83 offen lds
    s_mov_b32 m0, 32768
    s_mov_b32 s83, 0x80000
    buffer_load_dwordx4 v64, s[24:27], s83 offen lds
    s_mov_b32 m0, 33792
    s_mov_b32 s83, 0x84000
    buffer_load_dwordx4 v64, s[24:27], s83 offen lds
    s_mov_b32 m0, 34816
    s_mov_b32 s83, 0x88000
    buffer_load_dwordx4 v64, s[24:27], s83 offen lds
    s_mov_b32 m0, 35840
    s_mov_b32 s83, 0x8c000
    buffer_load_dwordx4 v64, s[24:27], s83 offen lds
    s_mov_b32 m0, 36864
    s_mov_b32 s83, 0x90000
    buffer_load_dwordx4 v64, s[24:27], s83 offen lds
    s_mov_b32 m0, 37888
    s_mov_b32 s83, 0x94000
    buffer_load_dwordx4 v64, s[24:27], s83 offen lds
    s_mov_b32 m0, 38912
    s_mov_b32 s83, 0x98000
    buffer_load_dwordx4 v64, s[24:27], s83 offen lds
    s_mov_b32 m0, 39936
    s_mov_b32 s83, 0x9c000
    buffer_load_dwordx4 v64, s[24:27], s83 offen lds
    s_waitcnt vmcnt(32)
    ds_write_b32 v66, v67 offset:3120
    s_mov_b32 m0, 140160
    s_mov_b32 s83, 0xe0000
    buffer_load_dwordx4 v64, s[20:23], s83 offen lds
    s_mov_b32 m0, 141200
    s_mov_b32 s83, 0xe4000
    buffer_load_dwordx4 v64, s[20:23], s83 offen lds
    s_mov_b32 m0, 142240
    s_mov_b32 s83, 0xe8000
    buffer_load_dwordx4 v64, s[20:23], s83 offen lds
    s_mov_b32 m0, 143280
    s_mov_b32 s83, 0xec000
    buffer_load_dwordx4 v64, s[20:23], s83 offen lds
    s_mov_b32 m0, 144320
    s_mov_b32 s83, 0xf0000
    buffer_load_dwordx4 v64, s[20:23], s83 offen lds
    s_mov_b32 m0, 145360
    s_mov_b32 s83, 0xf4000
    buffer_load_dwordx4 v64, s[20:23], s83 offen lds
    s_mov_b32 m0, 146400
    s_mov_b32 s83, 0xf8000
    buffer_load_dwordx4 v64, s[20:23], s83 offen lds
    s_mov_b32 m0, 147440
    s_mov_b32 s83, 0xfc000
    buffer_load_dwordx4 v64, s[20:23], s83 offen lds
    s_mov_b32 m0, 40960
    s_mov_b32 s83, 0xa0000
    buffer_load_dwordx4 v64, s[24:27], s83 offen lds
    s_mov_b32 m0, 41984
    s_mov_b32 s83, 0xa4000
    buffer_load_dwordx4 v64, s[24:27], s83 offen lds
    s_mov_b32 m0, 43008
    s_mov_b32 s83, 0xa8000
    buffer_load_dwordx4 v64, s[24:27], s83 offen lds
    s_mov_b32 m0, 44032
    s_mov_b32 s83, 0xac000
    buffer_load_dwordx4 v64, s[24:27], s83 offen lds
    s_mov_b32 m0, 45056
    s_mov_b32 s83, 0xb0000
    buffer_load_dwordx4 v64, s[24:27], s83 offen lds
    s_mov_b32 m0, 46080
    s_mov_b32 s83, 0xb4000
    buffer_load_dwordx4 v64, s[24:27], s83 offen lds
    s_mov_b32 m0, 47104
    s_mov_b32 s83, 0xb8000
    buffer_load_dwordx4 v64, s[24:27], s83 offen lds
    s_mov_b32 m0, 48128
    s_mov_b32 s83, 0xbc000
    buffer_load_dwordx4 v64, s[24:27], s83 offen lds
    s_waitcnt vmcnt(32)
    ds_write_b32 v66, v67 offset:4160
    v_and_b32 v68, 7, v1
    v_max_u32 v68, 0, v68
    v_min_u32 v68, 3, v68
    v_mul_u32_u24 v68, 1040, v68
    v_add_u32 v68, 116224, v68
    s_mov_b32 s82, 0
L_pw_L1_10_5_1:
    ds_read_b32 v69, v68 offset:0
    s_waitcnt lgkmcnt(0)
    v_cmp_gt_i32 vcc, s82, v69
    s_cbranch_vccz L_pw_L1_10_5_1_ok
    s_sleep 1
    s_cselect_b32 s64, 1, 0
    s_sub_u32 s67, s67, 1
    s_cbranch_scc1 L_end
    s_cmp_lg_u32 s64, 0
    s_branch L_pw_L1_10_5_1
L_pw_L1_10_5_1_ok:
    s_mov_b32 m0, 148480
    s_mov_b32 s83, 0x100000
    buffer_load_dwordx4 v64, s[20:23], s83 offen lds
    s_mov_b32 m0, 149520
    s_mov_b32 s83, 0x104000
    buffer_load_dwordx4 v64, s[20:23], s83 offen lds
    s_mov_b32 m0, 150560
    s_mov_b32 s83, 0x108000
    buffer_load_dwordx4 v64, s[20:23], s83 offen lds
    s_mov_b32 m0, 151600
    s_mov_b32 s83, 0x10c000
    buffer_load_dwordx4 v64, s[20:23], s83 offen lds
    s_mov_b32 m0, 152640
    s_mov_b32 s83, 0x110000
    buffer_load_dwordx4 v64, s[20:23], s83 offen lds
    s_mov_b32 m0, 153680
    s_mov_b32 s83, 0x114000
    buffer_load_dwordx4 v64, s[20:23], s83 offen lds
    s_mov_b32 m0, 154720
    s_mov_b32 s83, 0x118000
    buffer_load_dwordx4 v64, s[20:23], s83 offen lds
    s_mov_b32 m0, 155760
    s_mov_b32 s83, 0x11c000
    buffer_load_dwordx4 v64, s[20:23], s83 offen lds
    s_mov_b32 m0, 49152
    s_mov_b32 s83, 0xc0000
    buffer_load_dwordx4 v64, s[24:27], s83 offen lds
    s_mov_b32 m0, 50176
    s_mov_b32 s83, 0xc4000
    buffer_load_dwordx4 v64, s[24:27], s83 offen lds
    s_mov_b32 m0, 51200
    s_mov_b32 s83, 0xc8000
    buffer_load_dwordx4 v64, s[24:27], s83 offen lds
    s_mov_b32 m0, 52224
    s_mov_b32 s83, 0xcc000
    buffer_load_dwordx4 v64, s[24:27], s83 offen lds
    s_mov_b32 m0, 53248
    s_mov_b32 s83, 0xd0000
    buffer_load_dwordx4 v64, s[24:27], s83 offen lds
    s_mov_b32 m0, 54272
    s_mov_b32 s83, 0xd4000
    buffer_load_dwordx4 v64, s[24:27], s83 offen lds
    s_mov_b32 m0, 55296
    s_mov_b32 s83, 0xd8000
    buffer_load_dwordx4 v64, s[24:27], s83 offen lds
    s_mov_b32 m0, 56320
    s_mov_b32 s83, 0xdc000
    buffer_load_dwordx4 v64, s[24:27], s83 offen lds
    s_waitcnt vmcnt(32)
    ds_write_b32 v66, v67 offset:5200
    s_mov_b32 m0, 156800
    s_mov_b32 s83, 0x120000
    buffer_load_dwordx4 v64, s[20:23], s83 offen lds
    s_mov_b32 m0, 157840
    s_mov_b32 s83, 0x124000
    buffer_load_dwordx4 v64, s[20:23], s83 offen lds
    s_mov_b32 m0, 158880
    s_mov_b32 s83, 0x128000
    buffer_load_dwordx4 v64, s[20:23], s83 offen lds
    s_mov_b32 m0, 159920
    s_mov_b32 s83, 0x12c000
    buffer_load_dwordx4 v64, s[20:23], s83 offen lds
    s_mov_b32 m0, 160960
    s_mov_b32 s83, 0x130000
    buffer_load_dwordx4 v64, s[20:23], s83 offen lds
    s_mov_b32 m0, 162000
    s_mov_b32 s83, 0x134000
    buffer_load_dwordx4 v64, s[20:23], s83 offen lds
    s_mov_b32 m0, 163040
    s_mov_b32 s83, 0x138000
    buffer_load_dwordx4 v64, s[20:23], s83 offen lds
    s_mov_b32 m0, 164080
    s_mov_b32 s83, 0x13c000
    buffer_load_dwordx4 v64, s[20:23], s83 offen lds
    s_mov_b32 m0, 57344
    s_mov_b32 s83, 0xe0000
    buffer_load_dwordx4 v64, s[24:27], s83 offen lds
    s_mov_b32 m0, 58368
    s_mov_b32 s83, 0xe4000
    buffer_load_dwordx4 v64, s[24:27], s83 offen lds
    s_mov_b32 m0, 59392
    s_mov_b32 s83, 0xe8000
    buffer_load_dwordx4 v64, s[24:27], s83 offen lds
    s_mov_b32 m0, 60416
    s_mov_b32 s83, 0xec000
    buffer_load_dwordx4 v64, s[24:27], s83 offen lds
    s_mov_b32 m0, 61440
    s_mov_b32 s83, 0xf0000
    buffer_load_dwordx4 v64, s[24:27], s83 offen lds
    s_mov_b32 m0, 62464
    s_mov_b32 s83, 0xf4000
    buffer_load_dwordx4 v64, s[24:27], s83 offen lds
    s_mov_b32 m0, 63488
    s_mov_b32 s83, 0xf8000
    buffer_load_dwordx4 v64, s[24:27], s83 offen lds
    s_mov_b32 m0, 64512
    s_mov_b32 s83, 0xfc000
    buffer_load_dwordx4 v64, s[24:27], s83 offen lds
    s_waitcnt vmcnt(32)
    ds_write_b32 v66, v67 offset:6240
    v_and_b32 v68, 7, v1
    v_max_u32 v68, 4, v68
    v_min_u32 v68, 6, v68
    v_mul_u32_u24 v68, 1040, v68
    v_add_u32 v68, 116224, v68
    s_mov_b32 s82, 0
L_pw_L1_10_5_2:
    ds_read_b32 v69, v68 offset:0
    s_waitcnt lgkmcnt(0)
    v_cmp_gt_i32 vcc, s82, v69
    s_cbranch_vccz L_pw_L1_10_5_2_ok
    s_sleep 1
    s_cselect_b32 s64, 1, 0
    s_sub_u32 s67, s67, 1
    s_cbranch_scc1 L_end
    s_cmp_lg_u32 s64, 0
    s_branch L_pw_L1_10_5_2
L_pw_L1_10_5_2_ok:
    s_mov_b32 m0, 65536
    s_mov_b32 s83, 0x100000
    buffer_load_dwordx4 v64, s[24:27], s83 offen lds
    s_mov_b32 m0, 66560
    s_mov_b32 s83, 0x104000
    buffer_load_dwordx4 v64, s[24:27], s83 offen lds
    s_mov_b32 m0, 67584
    s_mov_b32 s83, 0x108000
    buffer_load_dwordx4 v64, s[24:27], s83 offen lds
    s_mov_b32 m0, 68608
    s_mov_b32 s83, 0x10c000
    buffer_load_dwordx4 v64, s[24:27], s83 offen lds
    s_mov_b32 m0, 69632
    s_mov_b32 s83, 0x110000
    buffer_load_dwordx4 v64, s[24:27], s83 offen lds
    s_mov_b32 m0, 70656
    s_mov_b32 s83, 0x114000
    buffer_load_dwordx4 v64, s[24:27], s83 offen lds
    s_mov_b32 m0, 71680
    s_mov_b32 s83, 0x118000
    buffer_load_dwordx4 v64, s[24:27], s83 offen lds
    s_mov_b32 m0, 72704
    s_mov_b32 s83, 0x11c000
    buffer_load_dwordx4 v64, s[24:27], s83 offen lds
    s_waitcnt vmcnt(24)
    ds_write_b32 v66, v67 offset:7280
    s_mov_b32 m0, 73728
    s_mov_b32 s83, 0x120000
    buffer_load_dwordx4 v64, s[24:27], s83 offen lds
    s_mov_b32 m0, 74752
    s_mov_b32 s83, 0x124000
    buffer_load_dwordx4 v64, s[24:27], s83 offen lds
    s_mov_b32 m0, 75776
    s_mov_b32 s83, 0x128000
    buffer_load_dwordx4 v64, s[24:27], s83 offen lds
    s_mov_b32 m0, 76800
    s_mov_b32 s83, 0x12c000
    buffer_load_dwordx4 v64, s[24:27], s83 offen lds
    s_mov_b32 m0, 77824
    s_mov_b32 s83, 0x130000
    buffer_load_dwordx4 v64, s[24:27], s83 offen lds
    s_mov_b32 m0, 78848
    s_mov_b32 s83, 0x134000
    buffer_load_dwordx4 v64, s[24:27], s83 offen lds
    s_mov_b32 m0, 79872
    s_mov_b32 s83, 0x138000
    buffer_load_dwordx4 v64, s[24:27], s83 offen lds
    s_mov_b32 m0, 80896
    s_mov_b32 s83, 0x13c000
    buffer_load_dwordx4 v64, s[24:27], s83 offen lds
    s_waitcnt vmcnt(16)
    ds_write_b32 v66, v67 offset:8320
    s_waitcnt vmcnt(8)
    ds_write_b32 v66, v67 offset:9360
    s_waitcnt vmcnt(0)
    ds_write_b32 v66, v67 offset:10400
    s_waitcnt lgkmcnt(0)
    s_endpgm
L_prog_6:
    s_setprio 2
    v_mov_b32 v64, v70
    s_mov_b32 m0, 106880
    s_mov_b32 s83, 0x60000
    buffer_load_dwordx4 v64, s[20:23], s83 offen lds
    s_mov_b32 m0, 107920
    s_mov_b32 s83, 0x64000
    buffer_load_dwordx4 v64, s[20:23], s83 offen lds
    s_mov_b32 m0, 108960
    s_mov_b32 s83, 0x68000
    buffer_load_dwordx4 v64, s[20:23], s83 offen lds
    s_mov_b32 m0, 110000
    s_mov_b32 s83, 0x6c000
    buffer_load_dwordx4 v64, s[20:23], s83 offen lds
    s_mov_b32 m0, 111040
    s_mov_b32 s83, 0x70000
    buffer_load_dwordx4 v64, s[20:23], s83 offen lds
    s_mov_b32 m0, 112080
    s_mov_b32 s83, 0x74000
    buffer_load_dwordx4 v64, s[20:23], s83 offen lds
    s_mov_b32 m0, 113120
    s_mov_b32 s83, 0x78000
    buffer_load_dwordx4 v64, s[20:23], s83 offen lds
    s_mov_b32 m0, 114160
    s_mov_b32 s83, 0x7c000
    buffer_load_dwordx4 v64, s[20:23], s83 offen lds
    s_mov_b32 m0, 8192
    s_mov_b32 s83, 0x20000
    buffer_load_dwordx4 v64, s[24:27], s83 offen lds
    s_mov_b32 m0, 9216
    s_mov_b32 s83, 0x24000
    buffer_load_dwordx4 v64, s[24:27], s83 offen lds
    s_mov_b32 m0, 10240
    s_mov_b32 s83, 0x28000
    buffer_load_dwordx4 v64, s[24:27], s83 offen lds
    s_mov_b32 m0, 11264
    s_mov_b32 s83, 0x2c000
    buffer_load_dwordx4 v64, s[24:27], s83 offen lds
    s_mov_b32 m0, 12288
    s_mov_b32 s83, 0x30000
    buffer_load_dwordx4 v64, s[24:27], s83 offen lds
    s_mov_b32 m0, 13312
    s_mov_b32 s83, 0x34000
    buffer_load_dwordx4 v64, s[24:27], s83 offen lds
    s_mov_b32 m0, 14336
    s_mov_b32 s83, 0x38000
    buffer_load_dwordx4 v64, s[24:27], s83 offen lds
    s_mov_b32 m0, 15360
    s_mov_b32 s83, 0x3c000
    buffer_load_dwordx4 v64, s[24:27], s83 offen lds
    s_mov_b32 m0, 115200
    s_mov_b32 s83, 0x80000
    buffer_load_dwordx4 v64, s[20:23], s83 offen lds
    s_mov_b32 m0, 116240
    s_mov_b32 s83, 0x84000
    buffer_load_dwordx4 v64, s[20:23], s83 offen lds
    s_mov_b32 m0, 117280
    s_mov_b32 s83, 0x88000
    buffer_load_dwordx4 v64, s[20:23], s83 offen lds
    s_mov_b32 m0, 118320
    s_mov_b32 s83, 0x8c000
    buffer_load_dwordx4 v64, s[20:23], s83 offen lds
    s_mov_b32 m0, 119360
    s_mov_b32 s83, 0x90000
    buffer_load_dwordx4 v64, s[20:23], s83 offen lds
    s_mov_b32 m0, 120400
    s_mov_b32 s83, 0x94000
    buffer_load_dwordx4 v64, s[20:23], s83 offen lds
    s_mov_b32 m0, 121440
    s_mov_b32 s83, 0x98000
    buffer_load_dwordx4 v64, s[20:23], s83 offen lds
    s_mov_b32 m0, 122480
    s_mov_b32 s83, 0x9c000
    buffer_load_dwordx4 v64, s[20:23], s83 offen lds
    s_mov_b32 m0, 16384
    s_mov_b32 s83, 0x40000
    buffer_load_dwordx4 v64, s[24:27], s83 offen lds
    s_mov_b32 m0, 17408
    s_mov_b32 s83, 0x44000
    buffer_load_dwordx4 v64, s[24:27], s83 offen lds
    s_mov_b32 m0, 18432
    s_mov_b32 s83, 0x48000
    buffer_load_dwordx4 v64, s[24:27], s83 offen lds
    s_mov_b32 m0, 19456
    s_mov_b32 s83, 0x4c000
    buffer_load_dwordx4 v64, s[24:27], s83 offen lds
    s_mov_b32 m0, 20480
    s_mov_b32 s83, 0x50000
    buffer_load_dwordx4 v64, s[24:27], s83 offen lds
    s_mov_b32 m0, 21504
    s_mov_b32 s83, 0x54000
    buffer_load_dwordx4 v64, s[24:27], s83 offen lds
    s_mov_b32 m0, 22528
    s_mov_b32 s83, 0x58000
    buffer_load_dwordx4 v64, s[24:27], s83 offen lds
    s_mov_b32 m0, 23552
    s_mov_b32 s83, 0x5c000
    buffer_load_dwordx4 v64, s[24:27], s83 offen lds
    s_waitcnt vmcnt(32)
    ds_write_b32 v66, v67 offset:1040
    v_and_b32 v66, 3, v1
    v_lshlrev_b32 v66, 2, v66
    v_add_u32 v66, 82944, v66
    v_and_b32 v68, 7, v1
    v_max_u32 v68, 0, v68
    v_min_u32 v68, 2, v68
    v_mul_u32_u24 v68, 1040, v68
    v_add_u32 v68, 116224, v68
    s_mov_b32 s82, 0
L_pw_L1_9_6_0:
    ds_read_b32 v69, v68 offset:0
    s_waitcnt lgkmcnt(0)
    v_cmp_gt_i32 vcc, s82, v69
    s_cbranch_vccz L_pw_L1_9_6_0_ok
    s_sleep 1
    s_cselect_b32 s64, 1, 0
    s_sub_u32 s67, s67, 1
    s_cbranch_scc1 L_end
    s_cmp_lg_u32 s64, 0
    s_branch L_pw_L1_9_6_0
L_pw_L1_9_6_0_ok:
    s_mov_b32 m0, 123520
    s_mov_b32 s83, 0xa0000
    buffer_load_dwordx4 v64, s[20:23], s83 offen lds
    s_mov_b32 m0, 124560
    s_mov_b32 s83, 0xa4000
    buffer_load_dwordx4 v64, s[20:23], s83 offen lds
    s_mov_b32 m0, 125600
    s_mov_b32 s83, 0xa8000
    buffer_load_dwordx4 v64, s[20:23], s83 offen lds
    s_mov_b32 m0, 126640
    s_mov_b32 s83, 0xac000
    buffer_load_dwordx4 v64, s[20:23], s83 offen lds
    s_mov_b32 m0, 127680
    s_mov_b32 s83, 0xb0000
    buffer_load_dwordx4 v64, s[20:23], s83 offen lds
    s_mov_b32 m0, 128720
    s_mov_b32 s83, 0xb4000
    buffer_load_dwordx4 v64, s[20:23], s83 offen lds
    s_mov_b32 m0, 129760
    s_mov_b32 s83, 0xb8000
    buffer_load_dwordx4 v64, s[20:23], s83 offen lds
    s_mov_b32 m0, 130800
    s_mov_b32 s83, 0xbc000
    buffer_load_dwordx4 v64, s[20:23], s83 offen lds
    s_mov_b32 m0, 24576
    s_mov_b32 s83, 0x60000
    buffer_load_dwordx4 v64, s[24:27], s83 offen lds
    s_mov_b32 m0, 25600
    s_mov_b32 s83, 0x64000
    buffer_load_dwordx4 v64, s[24:27], s83 offen lds
    s_mov_b32 m0, 26624
    s_mov_b32 s83, 0x68000
    buffer_load_dwordx4 v64, s[24:27], s83 offen lds
    s_mov_b32 m0, 27648
    s_mov_b32 s83, 0x6c000
    buffer_load_dwordx4 v64, s[24:27], s83 offen lds
    s_mov_b32 m0, 28672
    s_mov_b32 s83, 0x70000
    buffer_load_dwordx4 v64, s[24:27], s83 offen lds
    s_mov_b32 m0, 29696
    s_mov_b32 s83, 0x74000
    buffer_load_dwordx4 v64, s[24:27], s83 offen lds
    s_mov_b32 m0, 30720
    s_mov_b32 s83, 0x78000
    buffer_load_dwordx4 v64, s[24:27], s83 offen lds
    s_mov_b32 m0, 31744
    s_mov_b32 s83, 0x7c000
    buffer_load_dwordx4 v64, s[24:27], s83 offen lds
    s_mov_b32 s30, s65
    s_mov_b32 s31, 0x20000
    s_add_u32 s28, s12, s11
    s_addc_u32 s29, s13, 0
    v_and_b32 v14, 3, v1
    v_lshl_add_u32 v0, v14, 2, s73
    v_bfe_u32 v15, v1, 2, 3
    v_mul_u32_u24 v15, 1040, v15
    v_lshl_add_u32 v15, v14, 8, v15
    v_lshrrev_b32 v12, 5, v1
    v_lshl_add_u32 v15, v12, 4, v15
    v_xor_b32 v4, 0, v14
    v_lshl_add_u32 v4, v4, 6, v15
    v_add_u32 v176, s70, v4
    v_add_u32 v4, s71, v4
    v_xor_b32 v5, 1, v14
    v_lshl_add_u32 v5, v5, 6, v15
    v_add_u32 v177, s70, v5
    v_add_u32 v5, s71, v5
    v_xor_b32 v6, 2, v14
    v_lshl_add_u32 v6, v6, 6, v15
    v_add_u32 v178, s70, v6
    v_add_u32 v6, s71, v6
    v_xor_b32 v7, 3, v14
    v_lshl_add_u32 v7, v7, 6, v15
    v_add_u32 v179, s70, v7
    v_add_u32 v7, s71, v7
    v_lshrrev_b32 v15, 3, v1
    v_and_b32 v14, 7, v1
    v_lshlrev_b32 v13, 4, v14
    v_lshl_add_u32 v189, v15, 12, v13
    v_xor_b32 v15, v15, v1
    v_lshl_add_u32 v188, v15, 4, s76
    v_and_b32 v15, 31, v1
    v_lshl_add_u32 v15, v15, 7, s76
    v_lshl_add_u32 v15, v12, 3, v15
    v_xor_b32 v184, 0, v14
    v_lshl_add_u32 v184, v184, 4, v15
    v_xor_b32 v185, 1, v14
    v_lshl_add_u32 v185, v185, 4, v15
    v_xor_b32 v186, 2, v14
    v_lshl_add_u32 v186, v186, 4, v15
    v_xor_b32 v187, 3, v14
    v_lshl_add_u32 v187, v187, 4, v15
    v_bfe_u32 v14, v1, 2, 2
    v_lshl_add_u32 v15, v12, 2, v14
    v_lshl_add_u32 v15, v15, 8, s72
    v_bfe_u32 v13, v1, 4, 1
    v_lshl_add_u32 v15, v13, 5, v15
    v_and_b32 v13, 3, v1
    v_lshl_add_u32 v15, v13, 3, v15
    v_xor_b32 v8, 0, v14
    v_lshl_add_u32 v8, v8, 6, v15
    v_xor_b32 v9, 1, v14
    v_lshl_add_u32 v9, v9, 6, v15
    v_xor_b32 v10, 2, v14
    v_lshl_add_u32 v10, v10, 6, v15
    v_xor_b32 v11, 3, v14
    v_lshl_add_u32 v11, v11, 6, v15
    s_waitcnt vmcnt(32)
    ds_write_b32 v66, v67 offset:2080
    s_mov_b32 m0, 131840
    s_mov_b32 s83, 0xc0000
    buffer_load_dwordx4 v64, s[20:23], s83 offen lds
    s_mov_b32 m0, 132880
    s_mov_b32 s83, 0xc4000
    buffer_load_dwordx4 v64, s[20:23], s83 offen lds
    s_mov_b32 m0, 133920
    s_mov_b32 s83, 0xc8000
    buffer_load_dwordx4 v64, s[20:23], s83 offen lds
    s_mov_b32 m0, 134960
    s_mov_b32 s83, 0xcc000
    buffer_load_dwordx4 v64, s[20:23], s83 offen lds
    s_mov_b32 m0, 136000
    s_mov_b32 s83, 0xd0000
    buffer_load_dwordx4 v64, s[20:23], s83 offen lds
    s_mov_b32 m0, 137040
    s_mov_b32 s83, 0xd4000
    buffer_load_dwordx4 v64, s[20:23], s83 offen lds
    s_mov_b32 m0, 138080
    s_mov_b32 s83, 0xd8000
    buffer_load_dwordx4 v64, s[20:23], s83 offen lds
    s_mov_b32 m0, 139120
    s_mov_b32 s83, 0xdc000
    buffer_load_dwordx4 v64, s[20:23], s83 offen lds
    s_mov_b32 m0, 32768
    s_mov_b32 s83, 0x80000
    buffer_load_dwordx4 v64, s[24:27], s83 offen lds
    s_mov_b32 m0, 33792
    s_mov_b32 s83, 0x84000
    buffer_load_dwordx4 v64, s[24:27], s83 offen lds
    s_mov_b32 m0, 34816
    s_mov_b32 s83, 0x88000
    buffer_load_dwordx4 v64, s[24:27], s83 offen lds
    s_mov_b32 m0, 35840
    s_mov_b32 s83, 0x8c000
    buffer_load_dwordx4 v64, s[24:27], s83 offen lds
    s_mov_b32 m0, 36864
    s_mov_b32 s83, 0x90000
    buffer_load_dwordx4 v64, s[24:27], s83 offen lds
    s_mov_b32 m0, 37888
    s_mov_b32 s83, 0x94000
    buffer_load_dwordx4 v64, s[24:27], s83 offen lds
    s_mov_b32 m0, 38912
    s_mov_b32 s83, 0x98000
    buffer_load_dwordx4 v64, s[24:27], s83 offen lds
    s_mov_b32 m0, 39936
    s_mov_b32 s83, 0x9c000
    buffer_load_dwordx4 v64, s[24:27], s83 offen lds
    s_bfe_u32 s82, s68, 0x30008
    s_bfe_u32 s83, s68, 0x3000b
    v_and_b32 v190, 7, v1
    v_max_u32 v190, s82, v190
    v_min_u32 v190, s83, v190
    v_mul_u32_u24 v190, 1040, v190
    v_add_u32 v190, 116224, v190
    v_lshlrev_b32 v14, 2, v12
    v_sub_u32 v14, s75, v14
    v_cmp_lt_i32 s[32:33], 0, v14
    v_cmp_lt_i32 s[34:35], 1, v14
    v_cmp_lt_i32 s[36:37], 2, v14
    v_cmp_lt_i32 s[38:39], 3, v14
    v_cmp_lt_i32 s[40:41], 8, v14
    v_cmp_lt_i32 s[42:43], 9, v14
    v_cmp_lt_i32 s[44:45], 10, v14
    v_cmp_lt_i32 s[46:47], 11, v14
    v_cmp_lt_i32 s[48:49], 16, v14
    v_cmp_lt_i32 s[50:51], 17, v14
    v_cmp_lt_i32 s[52:53], 18, v14
    v_cmp_lt_i32 s[54:55], 19, v14
    v_cmp_lt_i32 s[56:57], 24, v14
    v_cmp_lt_i32 s[58:59], 25, v14
    v_cmp_lt_i32 s[60:61], 26, v14
    v_cmp_lt_i32 s[62:63], 27, v14
    v_mov_b64 v[192:193], 0
    v_mov_b64 v[194:195], 0
    v_mov_b64 v[196:197], 0
    v_mov_b64 v[198:199], 0
    v_mov_b64 v[200:201], 0
    v_mov_b64 v[202:203], 0
    v_mov_b64 v[204:205], 0
    v_mov_b64 v[206:207], 0
    v_mov_b64 v[208:209], 0
    v_mov_b64 v[210:211], 0
    v_mov_b64 v[212:213], 0
    v_mov_b64 v[214:215], 0
    v_mov_b64 v[216:217], 0
    v_mov_b64 v[218:219], 0
    v_mov_b64 v[220:221], 0
    v_mov_b64 v[222:223], 0
    v_mov_b64 v[224:225], 0
    v_mov_b64 v[226:227], 0
    v_mov_b64 v[228:229], 0
    v_mov_b64 v[230:231], 0
    v_mov_b64 v[232:233], 0
    v_mov_b64 v[234:235], 0
    v_mov_b64 v[236:237], 0
    v_mov_b64 v[238:239], 0
    v_mov_b64 v[240:241], 0
    v_mov_b64 v[242:243], 0
    v_mov_b64 v[244:245], 0
    v_mov_b64 v[246:247], 0
    v_mov_b64 v[248:249], 0
    v_mov_b64 v[250:251], 0
    v_mov_b64 v[252:253], 0
    v_mov_b64 v[254:255], 0
    v_mov_b64 v[16:17], 0
    v_mov_b64 v[18:19], 0
    v_mov_b64 v[20:21], 0
    v_mov_b64 v[22:23], 0
    v_mov_b64 v[24:25], 0
    v_mov_b64 v[26:27], 0
    v_mov_b64 v[28:29], 0
    v_mov_b64 v[30:31], 0
    v_mov_b32 v12, 0
    v_mov_b32 v15, 0xff800000
    v_mov_b32 v191, 1
    s_mov_b32 s98, 0x38800000
    s_mov_b32 s3, 0x46800000
    s_bitcmp1_b32 s68, 7
    s_cselect_b32 s86, 6, 0
    s_cselect_b32 s87, 8, 0
    s_mov_b32 s99, 16640
    s_mov_b32 s10, 16384
    s_mov_b32 s81, 2
    s_sub_u32 s14, s74, 1
    s_mov_b32 s15, s66
    s_mul_i32 s82, s80, 1040
    s_add_u32 s82, s82, 116224
    v_mov_b32 v2, s82
    s_waitcnt vmcnt(32)
    ds_write_b32 v66, v67 offset:3120
    v_and_b32 v68, 7, v1
    v_max_u32 v68, 5, v68
    v_min_u32 v68, 5, v68
    v_mul_u32_u24 v68, 1040, v68
    v_add_u32 v68, 116224, v68
    s_mov_b32 s82, 0
L_pw_L1_9_6_1:
    ds_read_b32 v69, v68 offset:0
    s_waitcnt lgkmcnt(0)
    v_cmp_gt_i32 vcc, s82, v69
    s_cbranch_vccz L_pw_L1_9_6_1_ok
    s_sleep 1
    s_cselect_b32 s64, 1, 0
    s_sub_u32 s67, s67, 1
    s_cbranch_scc1 L_end
    s_cmp_lg_u32 s64, 0
    s_branch L_pw_L1_9_6_1
L_pw_L1_9_6_1_ok:
    ds_read_b128 v[32:35], v176 offset:0
    ds_read_b128 v[36:39], v176 offset:32
    ds_read_b128 v[40:43], v177 offset:0
    ds_read_b128 v[44:47], v177 offset:32
    ds_read_b128 v[48:51], v178 offset:0
    ds_read_b128 v[52:55], v178 offset:32
    ds_read_b128 v[56:59], v179 offset:0
    ds_read_b128 v[60:63], v179 offset:32
    s_waitcnt lgkmcnt(0)
    ds_write_b32 v2, v12
    s_mov_b32 m0, 140160
    s_mov_b32 s83, 0xe0000
    buffer_load_dwordx4 v64, s[20:23], s83 offen lds
    s_mov_b32 m0, 141200
    s_mov_b32 s83, 0xe4000
    buffer_load_dwordx4 v64, s[20:23], s83 offen lds
    s_mov_b32 m0, 142240
    s_mov_b32 s83, 0xe8000
    buffer_load_dwordx4 v64, s[20:23], s83 offen lds
    s_mov_b32 m0, 143280
    s_mov_b32 s83, 0xec000
    buffer_load_dwordx4 v64, s[20:23], s83 offen lds
    s_mov_b32 m0, 144320
    s_mov_b32 s83, 0xf0000
    buffer_load_dwordx4 v64, s[20:23], s83 offen lds
    s_mov_b32 m0, 145360
    s_mov_b32 s83, 0xf4000
    buffer_load_dwordx4 v64, s[20:23], s83 offen lds
    s_mov_b32 m0, 146400
    s_mov_b32 s83, 0xf8000
    buffer_load_dwordx4 v64, s[20:23], s83 offen lds
    s_mov_b32 m0, 147440
    s_mov_b32 s83, 0xfc000
    buffer_load_dwordx4 v64, s[20:23], s83 offen lds
    s_mov_b32 m0, 40960
    s_mov_b32 s83, 0xa0000
    buffer_load_dwordx4 v64, s[24:27], s83 offen lds
    s_mov_b32 m0, 41984
    s_mov_b32 s83, 0xa4000
    buffer_load_dwordx4 v64, s[24:27], s83 offen lds
    s_mov_b32 m0, 43008
    s_mov_b32 s83, 0xa8000
    buffer_load_dwordx4 v64, s[24:27], s83 offen lds
    s_mov_b32 m0, 44032
    s_mov_b32 s83, 0xac000
    buffer_load_dwordx4 v64, s[24:27], s83 offen lds
    s_mov_b32 m0, 45056
    s_mov_b32 s83, 0xb0000
    buffer_load_dwordx4 v64, s[24:27], s83 offen lds
    s_mov_b32 m0, 46080
    s_mov_b32 s83, 0xb4000
    buffer_load_dwordx4 v64, s[24:27], s83 offen lds
    s_mov_b32 m0, 47104
    s_mov_b32 s83, 0xb8000
    buffer_load_dwordx4 v64, s[24:27], s83 offen lds
    s_mov_b32 m0, 48128
    s_mov_b32 s83, 0xbc000
    buffer_load_dwordx4 v64, s[24:27], s83 offen lds
    v_lshlrev_b32 v144, 16, v32
    v_and_b32 v145, 0xffff0000, v32
    v_lshlrev_b32 v146, 16, v33
    v_and_b32 v147, 0xffff0000, v33
    v_lshlrev_b32 v148, 16, v34
    v_and_b32 v149, 0xffff0000, v34
    v_lshlrev_b32 v150, 16, v35
    v_and_b32 v151, 0xffff0000, v35
    v_mul_f32 v144, 0x3e0293ee, v144
    v_mul_f32 v145, 0x3e0293ee, v145
    v_mul_f32 v146, 0x3e0293ee, v146
    v_mul_f32 v147, 0x3e0293ee, v147
    v_mul_f32 v148, 0x3e0293ee, v148
    v_mul_f32 v149, 0x3e0293ee, v149
    v_mul_f32 v150, 0x3e0293ee, v150
    v_mul_f32 v151, 0x3e0293ee, v151
    v_cvt_pk_bf16_f32 v32, v144, v145
    v_cvt_pk_bf16_f32 v33, v146, v147
    v_cvt_pk_bf16_f32 v34, v148, v149
    v_cvt_pk_bf16_f32 v35, v150, v151
    v_lshlrev_b32 v152, 16, v36
    v_and_b32 v153, 0xffff0000, v36
    v_lshlrev_b32 v154, 16, v37
    v_and_b32 v155, 0xffff0000, v37
    v_lshlrev_b32 v156, 16, v38
    v_and_b32 v157, 0xffff0000, v38
    v_lshlrev_b32 v158, 16, v39
    v_and_b32 v159, 0xffff0000, v39
    v_mul_f32 v152, 0x3e0293ee, v152
    v_mul_f32 v153, 0x3e0293ee, v153
    v_mul_f32 v154, 0x3e0293ee, v154
    v_mul_f32 v155, 0x3e0293ee, v155
    v_mul_f32 v156, 0x3e0293ee, v156
    v_mul_f32 v157, 0x3e0293ee, v157
    v_mul_f32 v158, 0x3e0293ee, v158
    v_mul_f32 v159, 0x3e0293ee, v159
    v_cvt_pk_bf16_f32 v36, v152, v153
    v_cvt_pk_bf16_f32 v37, v154, v155
    v_cvt_pk_bf16_f32 v38, v156, v157
    v_cvt_pk_bf16_f32 v39, v158, v159
    s_waitcnt vmcnt(32)
    ds_write_b32 v66, v67 offset:4160
    v_and_b32 v68, 7, v1
    v_max_u32 v68, 0, v68
    v_min_u32 v68, 3, v68
    v_mul_u32_u24 v68, 1040, v68
    v_add_u32 v68, 116224, v68
    s_mov_b32 s82, 0
L_pw_L1_9_6_2:
    ds_read_b32 v69, v68 offset:0
    s_waitcnt lgkmcnt(0)
    v_cmp_gt_i32 vcc, s82, v69
    s_cbranch_vccz L_pw_L1_9_6_2_ok
    s_sleep 1
    s_cselect_b32 s64, 1, 0
    s_sub_u32 s67, s67, 1
    s_cbranch_scc1 L_end
    s_cmp_lg_u32 s64, 0
    s_branch L_pw_L1_9_6_2
L_pw_L1_9_6_2_ok:
    s_mov_b32 m0, 148480
    s_mov_b32 s83, 0x100000
    buffer_load_dwordx4 v64, s[20:23], s83 offen lds
    s_mov_b32 m0, 149520
    s_mov_b32 s83, 0x104000
    buffer_load_dwordx4 v64, s[20:23], s83 offen lds
    s_mov_b32 m0, 150560
    s_mov_b32 s83, 0x108000
    buffer_load_dwordx4 v64, s[20:23], s83 offen lds
    s_mov_b32 m0, 151600
    s_mov_b32 s83, 0x10c000
    buffer_load_dwordx4 v64, s[20:23], s83 offen lds
    s_mov_b32 m0, 152640
    s_mov_b32 s83, 0x110000
    buffer_load_dwordx4 v64, s[20:23], s83 offen lds
    s_mov_b32 m0, 153680
    s_mov_b32 s83, 0x114000
    buffer_load_dwordx4 v64, s[20:23], s83 offen lds
    s_mov_b32 m0, 154720
    s_mov_b32 s83, 0x118000
    buffer_load_dwordx4 v64, s[20:23], s83 offen lds
    s_mov_b32 m0, 155760
    s_mov_b32 s83, 0x11c000
    buffer_load_dwordx4 v64, s[20:23], s83 offen lds
    s_mov_b32 m0, 49152
    s_mov_b32 s83, 0xc0000
    buffer_load_dwordx4 v64, s[24:27], s83 offen lds
    s_mov_b32 m0, 50176
    s_mov_b32 s83, 0xc4000
    buffer_load_dwordx4 v64, s[24:27], s83 offen lds
    s_mov_b32 m0, 51200
    s_mov_b32 s83, 0xc8000
    buffer_load_dwordx4 v64, s[24:27], s83 offen lds
    s_mov_b32 m0, 52224
    s_mov_b32 s83, 0xcc000
    buffer_load_dwordx4 v64, s[24:27], s83 offen lds
    s_mov_b32 m0, 53248
    s_mov_b32 s83, 0xd0000
    buffer_load_dwordx4 v64, s[24:27], s83 offen lds
    s_mov_b32 m0, 54272
    s_mov_b32 s83, 0xd4000
    buffer_load_dwordx4 v64, s[24:27], s83 offen lds
    s_mov_b32 m0, 55296
    s_mov_b32 s83, 0xd8000
    buffer_load_dwordx4 v64, s[24:27], s83 offen lds
    s_mov_b32 m0, 56320
    s_mov_b32 s83, 0xdc000
    buffer_load_dwordx4 v64, s[24:27], s83 offen lds
    v_lshlrev_b32 v144, 16, v40
    v_and_b32 v145, 0xffff0000, v40
    v_lshlrev_b32 v146, 16, v41
    v_and_b32 v147, 0xffff0000, v41
    v_lshlrev_b32 v148, 16, v42
    v_and_b32 v149, 0xffff0000, v42
    v_lshlrev_b32 v150, 16, v43
    v_and_b32 v151, 0xffff0000, v43
    v_mul_f32 v144, 0x3e0293ee, v144
    v_mul_f32 v145, 0x3e0293ee, v145
    v_mul_f32 v146, 0x3e0293ee, v146
    v_mul_f32 v147, 0x3e0293ee, v147
    v_mul_f32 v148, 0x3e0293ee, v148
    v_mul_f32 v149, 0x3e0293ee, v149
    v_mul_f32 v150, 0x3e0293ee, v150
    v_mul_f32 v151, 0x3e0293ee, v151
    v_cvt_pk_bf16_f32 v40, v144, v145
    v_cvt_pk_bf16_f32 v41, v146, v147
    v_cvt_pk_bf16_f32 v42, v148, v149
    v_cvt_pk_bf16_f32 v43, v150, v151
    v_lshlrev_b32 v152, 16, v44
    v_and_b32 v153, 0xffff0000, v44
    v_lshlrev_b32 v154, 16, v45
    v_and_b32 v155, 0xffff0000, v45
    v_lshlrev_b32 v156, 16, v46
    v_and_b32 v157, 0xffff0000, v46
    v_lshlrev_b32 v158, 16, v47
    v_and_b32 v159, 0xffff0000, v47
    v_mul_f32 v152, 0x3e0293ee, v152
    v_mul_f32 v153, 0x3e0293ee, v153
    v_mul_f32 v154, 0x3e0293ee, v154
    v_mul_f32 v155, 0x3e0293ee, v155
    v_mul_f32 v156, 0x3e0293ee, v156
    v_mul_f32 v157, 0x3e0293ee, v157
    v_mul_f32 v158, 0x3e0293ee, v158
    v_mul_f32 v159, 0x3e0293ee, v159
    v_cvt_pk_bf16_f32 v44, v152, v153
    v_cvt_pk_bf16_f32 v45, v154, v155
    v_cvt_pk_bf16_f32 v46, v156, v157
    v_cvt_pk_bf16_f32 v47, v158, v159
    s_waitcnt vmcnt(32)
    ds_write_b32 v66, v67 offset:5200
    v_and_b32 v68, 7, v1
    v_max_u32 v68, 4, v68
    v_min_u32 v68, 6, v68
    v_mul_u32_u24 v68, 1040, v68
    v_add_u32 v68, 116224, v68
    s_mov_b32 s82, 0
L_pw_L1_9_6_3:
    ds_read_b32 v69, v68 offset:0
    s_waitcnt lgkmcnt(0)
    v_cmp_gt_i32 vcc, s82, v69
    s_cbranch_vccz L_pw_L1_9_6_3_ok
    s_sleep 1
    s_cselect_b32 s64, 1, 0
    s_sub_u32 s67, s67, 1
    s_cbranch_scc1 L_end
    s_cmp_lg_u32 s64, 0
    s_branch L_pw_L1_9_6_3
L_pw_L1_9_6_3_ok:
    s_mov_b32 m0, 57344
    s_mov_b32 s83, 0xe0000
    buffer_load_dwordx4 v64, s[24:27], s83 offen lds
    s_mov_b32 m0, 58368
    s_mov_b32 s83, 0xe4000
    buffer_load_dwordx4 v64, s[24:27], s83 offen lds
    s_mov_b32 m0, 59392
    s_mov_b32 s83, 0xe8000
    buffer_load_dwordx4 v64, s[24:27], s83 offen lds
    s_mov_b32 m0, 60416
    s_mov_b32 s83, 0xec000
    buffer_load_dwordx4 v64, s[24:27], s83 offen lds
    s_mov_b32 m0, 61440
    s_mov_b32 s83, 0xf0000
    buffer_load_dwordx4 v64, s[24:27], s83 offen lds
    s_mov_b32 m0, 62464
    s_mov_b32 s83, 0xf4000
    buffer_load_dwordx4 v64, s[24:27], s83 offen lds
    s_mov_b32 m0, 63488
    s_mov_b32 s83, 0xf8000
    buffer_load_dwordx4 v64, s[24:27], s83 offen lds
    s_mov_b32 m0, 64512
    s_mov_b32 s83, 0xfc000
    buffer_load_dwordx4 v64, s[24:27], s83 offen lds
    v_lshlrev_b32 v144, 16, v48
    v_and_b32 v145, 0xffff0000, v48
    v_lshlrev_b32 v146, 16, v49
    v_and_b32 v147, 0xffff0000, v49
    v_lshlrev_b32 v148, 16, v50
    v_and_b32 v149, 0xffff0000, v50
    v_lshlrev_b32 v150, 16, v51
    v_and_b32 v151, 0xffff0000, v51
    v_mul_f32 v144, 0x3e0293ee, v144
    v_mul_f32 v145, 0x3e0293ee, v145
    v_mul_f32 v146, 0x3e0293ee, v146
    v_mul_f32 v147, 0x3e0293ee, v147
    v_mul_f32 v148, 0x3e0293ee, v148
    v_mul_f32 v149, 0x3e0293ee, v149
    v_mul_f32 v150, 0x3e0293ee, v150
    v_mul_f32 v151, 0x3e0293ee, v151
    v_cvt_pk_bf16_f32 v48, v144, v145
    v_cvt_pk_bf16_f32 v49, v146, v147
    v_cvt_pk_bf16_f32 v50, v148, v149
    v_cvt_pk_bf16_f32 v51, v150, v151
    v_lshlrev_b32 v152, 16, v52
    v_and_b32 v153, 0xffff0000, v52
    v_lshlrev_b32 v154, 16, v53
    v_and_b32 v155, 0xffff0000, v53
    v_lshlrev_b32 v156, 16, v54
    v_and_b32 v157, 0xffff0000, v54
    v_lshlrev_b32 v158, 16, v55
    v_and_b32 v159, 0xffff0000, v55
    v_mul_f32 v152, 0x3e0293ee, v152
    v_mul_f32 v153, 0x3e0293ee, v153
    v_mul_f32 v154, 0x3e0293ee, v154
    v_mul_f32 v155, 0x3e0293ee, v155
    v_mul_f32 v156, 0x3e0293ee, v156
    v_mul_f32 v157, 0x3e0293ee, v157
    v_mul_f32 v158, 0x3e0293ee, v158
    v_mul_f32 v159, 0x3e0293ee, v159
    v_cvt_pk_bf16_f32 v52, v152, v153
    v_cvt_pk_bf16_f32 v53, v154, v155
    v_cvt_pk_bf16_f32 v54, v156, v157
    v_cvt_pk_bf16_f32 v55, v158, v159
    s_waitcnt vmcnt(24)
    ds_write_b32 v66, v67 offset:6240
    s_mov_b32 m0, 65536
    s_mov_b32 s83, 0x100000
    buffer_load_dwordx4 v64, s[24:27], s83 offen lds
    s_mov_b32 m0, 66560
    s_mov_b32 s83, 0x104000
    buffer_load_dwordx4 v64, s[24:27], s83 offen lds
    s_mov_b32 m0, 67584
    s_mov_b32 s83, 0x108000
    buffer_load_dwordx4 v64, s[24:27], s83 offen lds
    s_mov_b32 m0, 68608
    s_mov_b32 s83, 0x10c000
    buffer_load_dwordx4 v64, s[24:27], s83 offen lds
    s_mov_b32 m0, 69632
    s_mov_b32 s83, 0x110000
    buffer_load_dwordx4 v64, s[24:27], s83 offen lds
    s_mov_b32 m0, 70656
    s_mov_b32 s83, 0x114000
    buffer_load_dwordx4 v64, s[24:27], s83 offen lds
    s_mov_b32 m0, 71680
    s_mov_b32 s83, 0x118000
    buffer_load_dwordx4 v64, s[24:27], s83 offen lds
    s_mov_b32 m0, 72704
    s_mov_b32 s83, 0x11c000
    buffer_load_dwordx4 v64, s[24:27], s83 offen lds
    v_lshlrev_b32 v144, 16, v56
    v_and_b32 v145, 0xffff0000, v56
    v_lshlrev_b32 v146, 16, v57
    v_and_b32 v147, 0xffff0000, v57
    v_lshlrev_b32 v148, 16, v58
    v_and_b32 v149, 0xffff0000, v58
    v_lshlrev_b32 v150, 16, v59
    v_and_b32 v151, 0xffff0000, v59
    v_mul_f32 v144, 0x3e0293ee, v144
    v_mul_f32 v145, 0x3e0293ee, v145
    v_mul_f32 v146, 0x3e0293ee, v146
    v_mul_f32 v147, 0x3e0293ee, v147
    v_mul_f32 v148, 0x3e0293ee, v148
    v_mul_f32 v149, 0x3e0293ee, v149
    v_mul_f32 v150, 0x3e0293ee, v150
    v_mul_f32 v151, 0x3e0293ee, v151
    v_cvt_pk_bf16_f32 v56, v144, v145
    v_cvt_pk_bf16_f32 v57, v146, v147
    v_cvt_pk_bf16_f32 v58, v148, v149
    v_cvt_pk_bf16_f32 v59, v150, v151
    v_lshlrev_b32 v152, 16, v60
    v_and_b32 v153, 0xffff0000, v60
    v_lshlrev_b32 v154, 16, v61
    v_and_b32 v155, 0xffff0000, v61
    v_lshlrev_b32 v156, 16, v62
    v_and_b32 v157, 0xffff0000, v62
    v_lshlrev_b32 v158, 16, v63
    v_and_b32 v159, 0xffff0000, v63
    v_mul_f32 v152, 0x3e0293ee, v152
    v_mul_f32 v153, 0x3e0293ee, v153
    v_mul_f32 v154, 0x3e0293ee, v154
    v_mul_f32 v155, 0x3e0293ee, v155
    v_mul_f32 v156, 0x3e0293ee, v156
    v_mul_f32 v157, 0x3e0293ee, v157
    v_mul_f32 v158, 0x3e0293ee, v158
    v_mul_f32 v159, 0x3e0293ee, v159
    v_cvt_pk_bf16_f32 v60, v152, v153
    v_cvt_pk_bf16_f32 v61, v154, v155
    v_cvt_pk_bf16_f32 v62, v156, v157
    v_cvt_pk_bf16_f32 v63, v158, v159
    s_waitcnt vmcnt(16)
    ds_write_b32 v66, v67 offset:7280
    s_waitcnt vmcnt(8)
    ds_write_b32 v66, v67 offset:8320
    s_waitcnt vmcnt(0)
    ds_write_b32 v66, v67 offset:9360
    s_branch L_helper_go
L_prog_7:
    s_setprio 2
    v_mov_b32 v64, v70
    s_mov_b32 s32, s20
    s_mov_b32 s33, s21
    s_mov_b32 s34, s22
    s_mov_b32 s35, 0x20000
    s_mov_b32 s36, s24
    s_mov_b32 s37, s25
    s_mov_b32 s38, s26
    s_mov_b32 s39, 0x20000
    s_add_u32 s20, s6, s11
    s_addc_u32 s21, s7, 0
    s_mov_b32 s22, s65
    s_mov_b32 s23, 0x20000
    s_add_u32 s24, s8, s11
    s_addc_u32 s25, s9, 0
    s_mov_b32 s26, s65
    s_mov_b32 s27, 0x20000
    s_mov_b32 m0, 156800
    s_mov_b32 s83, 0x60000
    buffer_load_dwordx4 v64, s[32:35], s83 offen lds
    s_mov_b32 m0, 157840
    s_mov_b32 s83, 0x64000
    buffer_load_dwordx4 v64, s[32:35], s83 offen lds
    s_mov_b32 m0, 158880
    s_mov_b32 s83, 0x68000
    buffer_load_dwordx4 v64, s[32:35], s83 offen lds
    s_mov_b32 m0, 159920
    s_mov_b32 s83, 0x6c000
    buffer_load_dwordx4 v64, s[32:35], s83 offen lds
    s_mov_b32 m0, 160960
    s_mov_b32 s83, 0x70000
    buffer_load_dwordx4 v64, s[32:35], s83 offen lds
    s_mov_b32 m0, 162000
    s_mov_b32 s83, 0x74000
    buffer_load_dwordx4 v64, s[32:35], s83 offen lds
    s_mov_b32 m0, 163040
    s_mov_b32 s83, 0x78000
    buffer_load_dwordx4 v64, s[32:35], s83 offen lds
    s_mov_b32 m0, 164080
    s_mov_b32 s83, 0x7c000
    buffer_load_dwordx4 v64, s[32:35], s83 offen lds
    s_mov_b32 m0, 57344
    s_mov_b32 s83, 0x20000
    buffer_load_dwordx4 v64, s[36:39], s83 offen lds
    s_mov_b32 m0, 58368
    s_mov_b32 s83, 0x24000
    buffer_load_dwordx4 v64, s[36:39], s83 offen lds
    s_mov_b32 m0, 59392
    s_mov_b32 s83, 0x28000
    buffer_load_dwordx4 v64, s[36:39], s83 offen lds
    s_mov_b32 m0, 60416
    s_mov_b32 s83, 0x2c000
    buffer_load_dwordx4 v64, s[36:39], s83 offen lds
    s_mov_b32 m0, 61440
    s_mov_b32 s83, 0x30000
    buffer_load_dwordx4 v64, s[36:39], s83 offen lds
    s_mov_b32 m0, 62464
    s_mov_b32 s83, 0x34000
    buffer_load_dwordx4 v64, s[36:39], s83 offen lds
    s_mov_b32 m0, 63488
    s_mov_b32 s83, 0x38000
    buffer_load_dwordx4 v64, s[36:39], s83 offen lds
    s_mov_b32 m0, 64512
    s_mov_b32 s83, 0x3c000
    buffer_load_dwordx4 v64, s[36:39], s83 offen lds
    s_waitcnt vmcnt(16)
    ds_write_b32 v66, v67 offset:1040
    v_and_b32 v66, 3, v1
    v_lshlrev_b32 v66, 2, v66
    v_add_u32 v66, 82944, v66
    s_mov_b32 m0, 65536
    s_mov_b32 s83, 0x40000
    buffer_load_dwordx4 v64, s[36:39], s83 offen lds
    s_mov_b32 m0, 66560
    s_mov_b32 s83, 0x44000
    buffer_load_dwordx4 v64, s[36:39], s83 offen lds
    s_mov_b32 m0, 67584
    s_mov_b32 s83, 0x48000
    buffer_load_dwordx4 v64, s[36:39], s83 offen lds
    s_mov_b32 m0, 68608
    s_mov_b32 s83, 0x4c000
    buffer_load_dwordx4 v64, s[36:39], s83 offen lds
    s_mov_b32 m0, 69632
    s_mov_b32 s83, 0x50000
    buffer_load_dwordx4 v64, s[36:39], s83 offen lds
    s_mov_b32 m0, 70656
    s_mov_b32 s83, 0x54000
    buffer_load_dwordx4 v64, s[36:39], s83 offen lds
    s_mov_b32 m0, 71680
    s_mov_b32 s83, 0x58000
    buffer_load_dwordx4 v64, s[36:39], s83 offen lds
    s_mov_b32 m0, 72704
    s_mov_b32 s83, 0x5c000
    buffer_load_dwordx4 v64, s[36:39], s83 offen lds
    s_mov_b32 m0, 73728
    s_mov_b32 s83, 0x60000
    buffer_load_dwordx4 v64, s[36:39], s83 offen lds
    s_mov_b32 m0, 74752
    s_mov_b32 s83, 0x64000
    buffer_load_dwordx4 v64, s[36:39], s83 offen lds
    s_mov_b32 m0, 75776
    s_mov_b32 s83, 0x68000
    buffer_load_dwordx4 v64, s[36:39], s83 offen lds
    s_mov_b32 m0, 76800
    s_mov_b32 s83, 0x6c000
    buffer_load_dwordx4 v64, s[36:39], s83 offen lds
    s_mov_b32 m0, 77824
    s_mov_b32 s83, 0x70000
    buffer_load_dwordx4 v64, s[36:39], s83 offen lds
    s_mov_b32 m0, 78848
    s_mov_b32 s83, 0x74000
    buffer_load_dwordx4 v64, s[36:39], s83 offen lds
    s_mov_b32 m0, 79872
    s_mov_b32 s83, 0x78000
    buffer_load_dwordx4 v64, s[36:39], s83 offen lds
    s_mov_b32 m0, 80896
    s_mov_b32 s83, 0x7c000
    buffer_load_dwordx4 v64, s[36:39], s83 offen lds
    s_mov_b32 m0, 81920
    s_mov_b32 s83, 0x0
    buffer_load_dwordx4 v64, s[20:23], s83 offen lds
    s_mov_b32 m0, 82960
    s_mov_b32 s83, 0x4000
    buffer_load_dwordx4 v64, s[20:23], s83 offen lds
    s_mov_b32 m0, 84000
    s_mov_b32 s83, 0x8000
    buffer_load_dwordx4 v64, s[20:23], s83 offen lds
    s_mov_b32 m0, 85040
    s_mov_b32 s83, 0xc000
    buffer_load_dwordx4 v64, s[20:23], s83 offen lds
    s_mov_b32 m0, 86080
    s_mov_b32 s83, 0x10000
    buffer_load_dwordx4 v64, s[20:23], s83 offen lds
    s_mov_b32 m0, 87120
    s_mov_b32 s83, 0x14000
    buffer_load_dwordx4 v64, s[20:23], s83 offen lds
    s_mov_b32 m0, 88160
    s_mov_b32 s83, 0x18000
    buffer_load_dwordx4 v64, s[20:23], s83 offen lds
    s_mov_b32 m0, 89200
    s_mov_b32 s83, 0x1c000
    buffer_load_dwordx4 v64, s[20:23], s83 offen lds
    s_waitcnt vmcnt(24)
    ds_write_b32 v66, v67 offset:18720
    s_mov_b32 m0, 90240
    s_mov_b32 s83, 0x20000
    buffer_load_dwordx4 v64, s[20:23], s83 offen lds
    s_mov_b32 m0, 91280
    s_mov_b32 s83, 0x24000
    buffer_load_dwordx4 v64, s[20:23], s83 offen lds
    s_mov_b32 m0, 92320
    s_mov_b32 s83, 0x28000
    buffer_load_dwordx4 v64, s[20:23], s83 offen lds
    s_mov_b32 m0, 93360
    s_mov_b32 s83, 0x2c000
    buffer_load_dwordx4 v64, s[20:23], s83 offen lds
    s_mov_b32 m0, 94400
    s_mov_b32 s83, 0x30000
    buffer_load_dwordx4 v64, s[20:23], s83 offen lds
    s_mov_b32 m0, 95440
    s_mov_b32 s83, 0x34000
    buffer_load_dwordx4 v64, s[20:23], s83 offen lds
    s_mov_b32 m0, 96480
    s_mov_b32 s83, 0x38000
    buffer_load_dwordx4 v64, s[20:23], s83 offen lds
    s_mov_b32 m0, 97520
    s_mov_b32 s83, 0x3c000
    buffer_load_dwordx4 v64, s[20:23], s83 offen lds
    s_waitcnt vmcnt(24)
    ds_write_b32 v66, v67 offset:19760
    v_and_b32 v68, 7, v1
    v_max_u32 v68, 0, v68
    v_min_u32 v68, 6, v68
    v_mul_u32_u24 v68, 1040, v68
    v_add_u32 v68, 116224, v68
    s_mov_b32 s82, 0
L_pw_L2_0:
    ds_read_b32 v69, v68 offset:0
    s_waitcnt lgkmcnt(0)
    v_cmp_gt_i32 vcc, s82, v69
    s_cbranch_vccz L_pw_L2_0_ok
    s_sleep 1
    s_cselect_b32 s64, 1, 0
    s_sub_u32 s67, s67, 1
    s_cbranch_scc1 L_end
    s_cmp_lg_u32 s64, 0
    s_branch L_pw_L2_0
L_pw_L2_0_ok:
    s_mov_b32 m0, 98560
    s_mov_b32 s83, 0x40000
    buffer_load_dwordx4 v64, s[20:23], s83 offen lds
    s_mov_b32 m0, 99600
    s_mov_b32 s83, 0x44000
    buffer_load_dwordx4 v64, s[20:23], s83 offen lds
    s_mov_b32 m0, 100640
    s_mov_b32 s83, 0x48000
    buffer_load_dwordx4 v64, s[20:23], s83 offen lds
    s_mov_b32 m0, 101680
    s_mov_b32 s83, 0x4c000
    buffer_load_dwordx4 v64, s[20:23], s83 offen lds
    s_mov_b32 m0, 102720
    s_mov_b32 s83, 0x50000
    buffer_load_dwordx4 v64, s[20:23], s83 offen lds
    s_mov_b32 m0, 103760
    s_mov_b32 s83, 0x54000
    buffer_load_dwordx4 v64, s[20:23], s83 offen lds
    s_mov_b32 m0, 104800
    s_mov_b32 s83, 0x58000
    buffer_load_dwordx4 v64, s[20:23], s83 offen lds
    s_mov_b32 m0, 105840
    s_mov_b32 s83, 0x5c000
    buffer_load_dwordx4 v64, s[20:23], s83 offen lds
    s_mov_b32 m0, 0
    s_mov_b32 s83, 0x0
    buffer_load_dwordx4 v64, s[24:27], s83 offen lds
    s_mov_b32 m0, 1024
    s_mov_b32 s83, 0x4000
    buffer_load_dwordx4 v64, s[24:27], s83 offen lds
    s_mov_b32 m0, 2048
    s_mov_b32 s83, 0x8000
    buffer_load_dwordx4 v64, s[24:27], s83 offen lds
    s_mov_b32 m0, 3072
    s_mov_b32 s83, 0xc000
    buffer_load_dwordx4 v64, s[24:27], s83 offen lds
    s_mov_b32 m0, 4096
    s_mov_b32 s83, 0x10000
    buffer_load_dwordx4 v64, s[24:27], s83 offen lds
    s_mov_b32 m0, 5120
    s_mov_b32 s83, 0x14000
    buffer_load_dwordx4 v64, s[24:27], s83 offen lds
    s_mov_b32 m0, 6144
    s_mov_b32 s83, 0x18000
    buffer_load_dwordx4 v64, s[24:27], s83 offen lds
    s_mov_b32 m0, 7168
    s_mov_b32 s83, 0x1c000
    buffer_load_dwordx4 v64, s[24:27], s83 offen lds
    s_waitcnt vmcnt(32)
    ds_write_b32 v66, v67 offset:20800
    s_mov_b32 m0, 106880
    s_mov_b32 s83, 0x60000
    buffer_load_dwordx4 v64, s[20:23], s83 offen lds
    s_mov_b32 m0, 107920
    s_mov_b32 s83, 0x64000
    buffer_load_dwordx4 v64, s[20:23], s83 offen lds
    s_mov_b32 m0, 108960
    s_mov_b32 s83, 0x68000
    buffer_load_dwordx4 v64, s[20:23], s83 offen lds
    s_mov_b32 m0, 110000
    s_mov_b32 s83, 0x6c000
    buffer_load_dwordx4 v64, s[20:23], s83 offen lds
    s_mov_b32 m0, 111040
    s_mov_b32 s83, 0x70000
    buffer_load_dwordx4 v64, s[20:23], s83 offen lds
    s_mov_b32 m0, 112080
    s_mov_b32 s83, 0x74000
    buffer_load_dwordx4 v64, s[20:23], s83 offen lds
    s_mov_b32 m0, 113120
    s_mov_b32 s83, 0x78000
    buffer_load_dwordx4 v64, s[20:23], s83 offen lds
    s_mov_b32 m0, 114160
    s_mov_b32 s83, 0x7c000
    buffer_load_dwordx4 v64, s[20:23], s83 offen lds
    s_mov_b32 m0, 8192
    s_mov_b32 s83, 0x20000
    buffer_load_dwordx4 v64, s[24:27], s83 offen lds
    s_mov_b32 m0, 9216
    s_mov_b32 s83, 0x24000
    buffer_load_dwordx4 v64, s[24:27], s83 offen lds
    s_mov_b32 m0, 10240
    s_mov_b32 s83, 0x28000
    buffer_load_dwordx4 v64, s[24:27], s83 offen lds
    s_mov_b32 m0, 11264
    s_mov_b32 s83, 0x2c000
    buffer_load_dwordx4 v64, s[24:27], s83 offen lds
    s_mov_b32 m0, 12288
    s_mov_b32 s83, 0x30000
    buffer_load_dwordx4 v64, s[24:27], s83 offen lds
    s_mov_b32 m0, 13312
    s_mov_b32 s83, 0x34000
    buffer_load_dwordx4 v64, s[24:27], s83 offen lds
    s_mov_b32 m0, 14336
    s_mov_b32 s83, 0x38000
    buffer_load_dwordx4 v64, s[24:27], s83 offen lds
    s_mov_b32 m0, 15360
    s_mov_b32 s83, 0x3c000
    buffer_load_dwordx4 v64, s[24:27], s83 offen lds
    s_waitcnt vmcnt(32)
    ds_write_b32 v66, v67 offset:0
    s_mov_b32 m0, 115200
    s_mov_b32 s83, 0x80000
    buffer_load_dwordx4 v64, s[20:23], s83 offen lds
    s_mov_b32 m0, 116240
    s_mov_b32 s83, 0x84000
    buffer_load_dwordx4 v64, s[20:23], s83 offen lds
    s_mov_b32 m0, 117280
    s_mov_b32 s83, 0x88000
    buffer_load_dwordx4 v64, s[20:23], s83 offen lds
    s_mov_b32 m0, 118320
    s_mov_b32 s83, 0x8c000
    buffer_load_dwordx4 v64, s[20:23], s83 offen lds
    s_mov_b32 m0, 119360
    s_mov_b32 s83, 0x90000
    buffer_load_dwordx4 v64, s[20:23], s83 offen lds
    s_mov_b32 m0, 120400
    s_mov_b32 s83, 0x94000
    buffer_load_dwordx4 v64, s[20:23], s83 offen lds
    s_mov_b32 m0, 121440
    s_mov_b32 s83, 0x98000
    buffer_load_dwordx4 v64, s[20:23], s83 offen lds
    s_mov_b32 m0, 122480
    s_mov_b32 s83, 0x9c000
    buffer_load_dwordx4 v64, s[20:23], s83 offen lds
    s_mov_b32 m0, 16384
    s_mov_b32 s83, 0x40000
    buffer_load_dwordx4 v64, s[24:27], s83 offen lds
    s_mov_b32 m0, 17408
    s_mov_b32 s83, 0x44000
    buffer_load_dwordx4 v64, s[24:27], s83 offen lds
    s_mov_b32 m0, 18432
    s_mov_b32 s83, 0x48000
    buffer_load_dwordx4 v64, s[24:27], s83 offen lds
    s_mov_b32 m0, 19456
    s_mov_b32 s83, 0x4c000
    buffer_load_dwordx4 v64, s[24:27], s83 offen lds
    s_mov_b32 m0, 20480
    s_mov_b32 s83, 0x50000
    buffer_load_dwordx4 v64, s[24:27], s83 offen lds
    s_mov_b32 m0, 21504
    s_mov_b32 s83, 0x54000
    buffer_load_dwordx4 v64, s[24:27], s83 offen lds
    s_mov_b32 m0, 22528
    s_mov_b32 s83, 0x58000
    buffer_load_dwordx4 v64, s[24:27], s83 offen lds
    s_mov_b32 m0, 23552
    s_mov_b32 s83, 0x5c000
    buffer_load_dwordx4 v64, s[24:27], s83 offen lds
    s_waitcnt vmcnt(32)
    ds_write_b32 v66, v67 offset:1040
    s_mov_b32 m0, 123520
    s_mov_b32 s83, 0xa0000
    buffer_load_dwordx4 v64, s[20:23], s83 offen lds
    s_mov_b32 m0, 124560
    s_mov_b32 s83, 0xa4000
    buffer_load_dwordx4 v64, s[20:23], s83 offen lds
    s_mov_b32 m0, 125600
    s_mov_b32 s83, 0xa8000
    buffer_load_dwordx4 v64, s[20:23], s83 offen lds
    s_mov_b32 m0, 126640
    s_mov_b32 s83, 0xac000
    buffer_load_dwordx4 v64, s[20:23], s83 offen lds
    s_mov_b32 m0, 127680
    s_mov_b32 s83, 0xb0000
    buffer_load_dwordx4 v64, s[20:23], s83 offen lds
    s_mov_b32 m0, 128720
    s_mov_b32 s83, 0xb4000
    buffer_load_dwordx4 v64, s[20:23], s83 offen lds
    s_mov_b32 m0, 129760
    s_mov_b32 s83, 0xb8000
    buffer_load_dwordx4 v64, s[20:23], s83 offen lds
    s_mov_b32 m0, 130800
    s_mov_b32 s83, 0xbc000
    buffer_load_dwordx4 v64, s[20:23], s83 offen lds
    s_mov_b32 m0, 24576
    s_mov_b32 s83, 0x60000
    buffer_load_dwordx4 v64, s[24:27], s83 offen lds
    s_mov_b32 m0, 25600
    s_mov_b32 s83, 0x64000
    buffer_load_dwordx4 v64, s[24:27], s83 offen lds
    s_mov_b32 m0, 26624
    s_mov_b32 s83, 0x68000
    buffer_load_dwordx4 v64, s[24:27], s83 offen lds
    s_mov_b32 m0, 27648
    s_mov_b32 s83, 0x6c000
    buffer_load_dwordx4 v64, s[24:27], s83 offen lds
    s_mov_b32 m0, 28672
    s_mov_b32 s83, 0x70000
    buffer_load_dwordx4 v64, s[24:27], s83 offen lds
    s_mov_b32 m0, 29696
    s_mov_b32 s83, 0x74000
    buffer_load_dwordx4 v64, s[24:27], s83 offen lds
    s_mov_b32 m0, 30720
    s_mov_b32 s83, 0x78000
    buffer_load_dwordx4 v64, s[24:27], s83 offen lds
    s_mov_b32 m0, 31744
    s_mov_b32 s83, 0x7c000
    buffer_load_dwordx4 v64, s[24:27], s83 offen lds
    s_waitcnt vmcnt(32)
    ds_write_b32 v66, v67 offset:2080
    v_and_b32 v68, 7, v1
    v_max_u32 v68, 0, v68
    v_min_u32 v68, 3, v68
    v_mul_u32_u24 v68, 1040, v68
    v_add_u32 v68, 116224, v68
    s_mov_b32 s82, 99584
L_pw_L2_1:
    ds_read_b32 v69, v68 offset:0
    s_waitcnt lgkmcnt(0)
    v_cmp_gt_i32 vcc, s82, v69
    s_cbranch_vccz L_pw_L2_1_ok
    s_sleep 1
    s_cselect_b32 s64, 1, 0
    s_sub_u32 s67, s67, 1
    s_cbranch_scc1 L_end
    s_cmp_lg_u32 s64, 0
    s_branch L_pw_L2_1
L_pw_L2_1_ok:
    s_mov_b32 m0, 131840
    s_mov_b32 s83, 0xc0000
    buffer_load_dwordx4 v64, s[20:23], s83 offen lds
    s_mov_b32 m0, 132880
    s_mov_b32 s83, 0xc4000
    buffer_load_dwordx4 v64, s[20:23], s83 offen lds
    s_mov_b32 m0, 133920
    s_mov_b32 s83, 0xc8000
    buffer_load_dwordx4 v64, s[20:23], s83 offen lds
    s_mov_b32 m0, 134960
    s_mov_b32 s83, 0xcc000
    buffer_load_dwordx4 v64, s[20:23], s83 offen lds
    s_mov_b32 m0, 136000
    s_mov_b32 s83, 0xd0000
    buffer_load_dwordx4 v64, s[20:23], s83 offen lds
    s_mov_b32 m0, 137040
    s_mov_b32 s83, 0xd4000
    buffer_load_dwordx4 v64, s[20:23], s83 offen lds
    s_mov_b32 m0, 138080
    s_mov_b32 s83, 0xd8000
    buffer_load_dwordx4 v64, s[20:23], s83 offen lds
    s_mov_b32 m0, 139120
    s_mov_b32 s83, 0xdc000
    buffer_load_dwordx4 v64, s[20:23], s83 offen lds
    s_mov_b32 m0, 32768
    s_mov_b32 s83, 0x80000
    buffer_load_dwordx4 v64, s[24:27], s83 offen lds
    s_mov_b32 m0, 33792
    s_mov_b32 s83, 0x84000
    buffer_load_dwordx4 v64, s[24:27], s83 offen lds
    s_mov_b32 m0, 34816
    s_mov_b32 s83, 0x88000
    buffer_load_dwordx4 v64, s[24:27], s83 offen lds
    s_mov_b32 m0, 35840
    s_mov_b32 s83, 0x8c000
    buffer_load_dwordx4 v64, s[24:27], s83 offen lds
    s_mov_b32 m0, 36864
    s_mov_b32 s83, 0x90000
    buffer_load_dwordx4 v64, s[24:27], s83 offen lds
    s_mov_b32 m0, 37888
    s_mov_b32 s83, 0x94000
    buffer_load_dwordx4 v64, s[24:27], s83 offen lds
    s_mov_b32 m0, 38912
    s_mov_b32 s83, 0x98000
    buffer_load_dwordx4 v64, s[24:27], s83 offen lds
    s_mov_b32 m0, 39936
    s_mov_b32 s83, 0x9c000
    buffer_load_dwordx4 v64, s[24:27], s83 offen lds
    s_waitcnt vmcnt(32)
    ds_write_b32 v66, v67 offset:3120
    s_mov_b32 m0, 140160
    s_mov_b32 s83, 0xe0000
    buffer_load_dwordx4 v64, s[20:23], s83 offen lds
    s_mov_b32 m0, 141200
    s_mov_b32 s83, 0xe4000
    buffer_load_dwordx4 v64, s[20:23], s83 offen lds
    s_mov_b32 m0, 142240
    s_mov_b32 s83, 0xe8000
    buffer_load_dwordx4 v64, s[20:23], s83 offen lds
    s_mov_b32 m0, 143280
    s_mov_b32 s83, 0xec000
    buffer_load_dwordx4 v64, s[20:23], s83 offen lds
    s_mov_b32 m0, 144320
    s_mov_b32 s83, 0xf0000
    buffer_load_dwordx4 v64, s[20:23], s83 offen lds
    s_mov_b32 m0, 145360
    s_mov_b32 s83, 0xf4000
    buffer_load_dwordx4 v64, s[20:23], s83 offen lds
    s_mov_b32 m0, 146400
    s_mov_b32 s83, 0xf8000
    buffer_load_dwordx4 v64, s[20:23], s83 offen lds
    s_mov_b32 m0, 147440
    s_mov_b32 s83, 0xfc000
    buffer_load_dwordx4 v64, s[20:23], s83 offen lds
    s_mov_b32 m0, 40960
    s_mov_b32 s83, 0xa0000
    buffer_load_dwordx4 v64, s[24:27], s83 offen lds
    s_mov_b32 m0, 41984
    s_mov_b32 s83, 0xa4000
    buffer_load_dwordx4 v64, s[24:27], s83 offen lds
    s_mov_b32 m0, 43008
    s_mov_b32 s83, 0xa8000
    buffer_load_dwordx4 v64, s[24:27], s83 offen lds
    s_mov_b32 m0, 44032
    s_mov_b32 s83, 0xac000
    buffer_load_dwordx4 v64, s[24:27], s83 offen lds
    s_mov_b32 m0, 45056
    s_mov_b32 s83, 0xb0000
    buffer_load_dwordx4 v64, s[24:27], s83 offen lds
    s_mov_b32 m0, 46080
    s_mov_b32 s83, 0xb4000
    buffer_load_dwordx4 v64, s[24:27], s83 offen lds
    s_mov_b32 m0, 47104
    s_mov_b32 s83, 0xb8000
    buffer_load_dwordx4 v64, s[24:27], s83 offen lds
    s_mov_b32 m0, 48128
    s_mov_b32 s83, 0xbc000
    buffer_load_dwordx4 v64, s[24:27], s83 offen lds
    s_waitcnt vmcnt(32)
    ds_write_b32 v66, v67 offset:4160
    s_mov_b32 m0, 148480
    s_mov_b32 s83, 0x100000
    buffer_load_dwordx4 v64, s[20:23], s83 offen lds
    s_mov_b32 m0, 149520
    s_mov_b32 s83, 0x104000
    buffer_load_dwordx4 v64, s[20:23], s83 offen lds
    s_mov_b32 m0, 150560
    s_mov_b32 s83, 0x108000
    buffer_load_dwordx4 v64, s[20:23], s83 offen lds
    s_mov_b32 m0, 151600
    s_mov_b32 s83, 0x10c000
    buffer_load_dwordx4 v64, s[20:23], s83 offen lds
    s_mov_b32 m0, 152640
    s_mov_b32 s83, 0x110000
    buffer_load_dwordx4 v64, s[20:23], s83 offen lds
    s_mov_b32 m0, 153680
    s_mov_b32 s83, 0x114000
    buffer_load_dwordx4 v64, s[20:23], s83 offen lds
    s_mov_b32 m0, 154720
    s_mov_b32 s83, 0x118000
    buffer_load_dwordx4 v64, s[20:23], s83 offen lds
    s_mov_b32 m0, 155760
    s_mov_b32 s83, 0x11c000
    buffer_load_dwordx4 v64, s[20:23], s83 offen lds
    s_mov_b32 m0, 49152
    s_mov_b32 s83, 0xc0000
    buffer_load_dwordx4 v64, s[24:27], s83 offen lds
    s_mov_b32 m0, 50176
    s_mov_b32 s83, 0xc4000
    buffer_load_dwordx4 v64, s[24:27], s83 offen lds
    s_mov_b32 m0, 51200
    s_mov_b32 s83, 0xc8000
    buffer_load_dwordx4 v64, s[24:27], s83 offen lds
    s_mov_b32 m0, 52224
    s_mov_b32 s83, 0xcc000
    buffer_load_dwordx4 v64, s[24:27], s83 offen lds
    s_mov_b32 m0, 53248
    s_mov_b32 s83, 0xd0000
    buffer_load_dwordx4 v64, s[24:27], s83 offen lds
    s_mov_b32 m0, 54272
    s_mov_b32 s83, 0xd4000
    buffer_load_dwordx4 v64, s[24:27], s83 offen lds
    s_mov_b32 m0, 55296
    s_mov_b32 s83, 0xd8000
    buffer_load_dwordx4 v64, s[24:27], s83 offen lds
    s_mov_b32 m0, 56320
    s_mov_b32 s83, 0xdc000
    buffer_load_dwordx4 v64, s[24:27], s83 offen lds
    s_waitcnt vmcnt(32)
    ds_write_b32 v66, v67 offset:5200
    s_mov_b32 m0, 57344
    s_mov_b32 s83, 0xe0000
    buffer_load_dwordx4 v64, s[24:27], s83 offen lds
    s_mov_b32 m0, 58368
    s_mov_b32 s83, 0xe4000
    buffer_load_dwordx4 v64, s[24:27], s83 offen lds
    s_mov_b32 m0, 59392
    s_mov_b32 s83, 0xe8000
    buffer_load_dwordx4 v64, s[24:27], s83 offen lds
    s_mov_b32 m0, 60416
    s_mov_b32 s83, 0xec000
    buffer_load_dwordx4 v64, s[24:27], s83 offen lds
    s_mov_b32 m0, 61440
    s_mov_b32 s83, 0xf0000
    buffer_load_dwordx4 v64, s[24:27], s83 offen lds
    s_mov_b32 m0, 62464
    s_mov_b32 s83, 0xf4000
    buffer_load_dwordx4 v64, s[24:27], s83 offen lds
    s_mov_b32 m0, 63488
    s_mov_b32 s83, 0xf8000
    buffer_load_dwordx4 v64, s[24:27], s83 offen lds
    s_mov_b32 m0, 64512
    s_mov_b32 s83, 0xfc000
    buffer_load_dwordx4 v64, s[24:27], s83 offen lds
    s_waitcnt vmcnt(24)
    ds_write_b32 v66, v67 offset:6240
    v_and_b32 v68, 7, v1
    v_max_u32 v68, 0, v68
    v_min_u32 v68, 3, v68
    v_mul_u32_u24 v68, 1040, v68
    v_add_u32 v68, 116224, v68
    s_mov_b32 s82, 101664
L_pw_L2_2:
    ds_read_b32 v69, v68 offset:0
    s_waitcnt lgkmcnt(0)
    v_cmp_gt_i32 vcc, s82, v69
    s_cbranch_vccz L_pw_L2_2_ok
    s_sleep 1
    s_cselect_b32 s64, 1, 0
    s_sub_u32 s67, s67, 1
    s_cbranch_scc1 L_end
    s_cmp_lg_u32 s64, 0
    s_branch L_pw_L2_2
L_pw_L2_2_ok:
    s_mov_b32 m0, 65536
    s_mov_b32 s83, 0x100000
    buffer_load_dwordx4 v64, s[24:27], s83 offen lds
    s_mov_b32 m0, 66560
    s_mov_b32 s83, 0x104000
    buffer_load_dwordx4 v64, s[24:27], s83 offen lds
    s_mov_b32 m0, 67584
    s_mov_b32 s83, 0x108000
    buffer_load_dwordx4 v64, s[24:27], s83 offen lds
    s_mov_b32 m0, 68608
    s_mov_b32 s83, 0x10c000
    buffer_load_dwordx4 v64, s[24:27], s83 offen lds
    s_mov_b32 m0, 69632
    s_mov_b32 s83, 0x110000
    buffer_load_dwordx4 v64, s[24:27], s83 offen lds
    s_mov_b32 m0, 70656
    s_mov_b32 s83, 0x114000
    buffer_load_dwordx4 v64, s[24:27], s83 offen lds
    s_mov_b32 m0, 71680
    s_mov_b32 s83, 0x118000
    buffer_load_dwordx4 v64, s[24:27], s83 offen lds
    s_mov_b32 m0, 72704
    s_mov_b32 s83, 0x11c000
    buffer_load_dwordx4 v64, s[24:27], s83 offen lds
    s_waitcnt vmcnt(16)
    ds_write_b32 v66, v67 offset:7280
    s_waitcnt vmcnt(8)
    ds_write_b32 v66, v67 offset:8320
    s_waitcnt vmcnt(0)
    ds_write_b32 v66, v67 offset:9360
    s_waitcnt lgkmcnt(0)
    s_endpgm
L_prog_8:
    s_setprio 2
    s_add_u32 m0, s84, 106880
    s_mov_b32 s83, 0x60000
    buffer_load_dwordx4 v64, s[20:23], s83 offen lds
    s_add_u32 m0, s84, 111040
    s_nop 0
    buffer_load_dwordx4 v65, s[20:23], s83 offen lds
    s_add_u32 m0, s85, 8192
    s_mov_b32 s83, 0x20000
    buffer_load_dwordx4 v64, s[24:27], s83 offen lds
    s_add_u32 m0, s85, 12288
    s_nop 0
    buffer_load_dwordx4 v65, s[24:27], s83 offen lds
    s_add_u32 m0, s84, 115200
    s_mov_b32 s83, 0x80000
    buffer_load_dwordx4 v64, s[20:23], s83 offen lds
    s_add_u32 m0, s84, 119360
    s_nop 0
    buffer_load_dwordx4 v65, s[20:23], s83 offen lds
    s_add_u32 m0, s85, 16384
    s_mov_b32 s83, 0x40000
    buffer_load_dwordx4 v64, s[24:27], s83 offen lds
    s_add_u32 m0, s85, 20480
    s_nop 0
    buffer_load_dwordx4 v65, s[24:27], s83 offen lds
    s_add_u32 m0, s84, 123520
    s_mov_b32 s83, 0xa0000
    buffer_load_dwordx4 v64, s[20:23], s83 offen lds
    s_add_u32 m0, s84, 127680
    s_nop 0
    buffer_load_dwordx4 v65, s[20:23], s83 offen lds
    s_add_u32 m0, s85, 24576
    s_mov_b32 s83, 0x60000
    buffer_load_dwordx4 v64, s[24:27], s83 offen lds
    s_add_u32 m0, s85, 28672
    s_nop 0
    buffer_load_dwordx4 v65, s[24:27], s83 offen lds
    s_add_u32 m0, s84, 131840
    s_mov_b32 s83, 0xc0000
    buffer_load_dwordx4 v64, s[20:23], s83 offen lds
    s_add_u32 m0, s84, 136000
    s_nop 0
    buffer_load_dwordx4 v65, s[20:23], s83 offen lds
    s_add_u32 m0, s85, 32768
    s_mov_b32 s83, 0x80000
    buffer_load_dwordx4 v64, s[24:27], s83 offen lds
    s_add_u32 m0, s85, 36864
    s_nop 0
    buffer_load_dwordx4 v65, s[24:27], s83 offen lds
    s_waitcnt vmcnt(16)
    ds_write_b32 v66, v67 offset:1040
    s_waitcnt vmcnt(12)
    ds_write_b32 v66, v67 offset:2080
    v_and_b32 v68, 7, v1
    v_max_u32 v68, 0, v68
    v_min_u32 v68, 3, v68
    v_mul_u32_u24 v68, 1040, v68
    v_add_u32 v68, 116224, v68
    s_mov_b32 s82, 0
L_pw_L4_11_8_0:
    ds_read_b32 v69, v68 offset:0
    s_waitcnt lgkmcnt(0)
    v_cmp_gt_i32 vcc, s82, v69
    s_cbranch_vccz L_pw_L4_11_8_0_ok
    s_sleep 1
    s_cselect_b32 s64, 1, 0
    s_sub_u32 s67, s67, 1
    s_cbranch_scc1 L_end
    s_cmp_lg_u32 s64, 0
    s_branch L_pw_L4_11_8_0
L_pw_L4_11_8_0_ok:
    s_add_u32 m0, s84, 140160
    s_mov_b32 s83, 0xe0000
    buffer_load_dwordx4 v64, s[20:23], s83 offen lds
    s_add_u32 m0, s84, 144320
    s_nop 0
    buffer_load_dwordx4 v65, s[20:23], s83 offen lds
    s_add_u32 m0, s85, 40960
    s_mov_b32 s83, 0xa0000
    buffer_load_dwordx4 v64, s[24:27], s83 offen lds
    s_add_u32 m0, s85, 45056
    s_nop 0
    buffer_load_dwordx4 v65, s[24:27], s83 offen lds
    s_waitcnt vmcnt(12)
    ds_write_b32 v66, v67 offset:3120
    v_and_b32 v68, 7, v1
    v_max_u32 v68, 0, v68
    v_min_u32 v68, 3, v68
    v_mul_u32_u24 v68, 1040, v68
    v_add_u32 v68, 116224, v68
    s_mov_b32 s82, 1
L_pw_L4_11_8_1:
    ds_read_b32 v69, v68 offset:0
    s_waitcnt lgkmcnt(0)
    v_cmp_gt_i32 vcc, s82, v69
    s_cbranch_vccz L_pw_L4_11_8_1_ok
    s_sleep 1
    s_cselect_b32 s64, 1, 0
    s_sub_u32 s67, s67, 1
    s_cbranch_scc1 L_end
    s_cmp_lg_u32 s64, 0
    s_branch L_pw_L4_11_8_1
L_pw_L4_11_8_1_ok:
    s_add_u32 m0, s84, 81920
    s_mov_b32 s83, 0x100000
    buffer_load_dwordx4 v64, s[20:23], s83 offen lds
    s_add_u32 m0, s84, 86080
    s_nop 0
    buffer_load_dwordx4 v65, s[20:23], s83 offen lds
    s_add_u32 m0, s85, 49152
    s_mov_b32 s83, 0xc0000
    buffer_load_dwordx4 v64, s[24:27], s83 offen lds
    s_add_u32 m0, s85, 53248
    s_nop 0
    buffer_load_dwordx4 v65, s[24:27], s83 offen lds
    s_waitcnt vmcnt(12)
    ds_write_b32 v66, v67 offset:4160
    s_add_u32 m0, s84, 90240
    s_mov_b32 s83, 0x120000
    buffer_load_dwordx4 v64, s[20:23], s83 offen lds
    s_add_u32 m0, s84, 94400
    s_nop 0
    buffer_load_dwordx4 v65, s[20:23], s83 offen lds
    s_add_u32 m0, s85, 57344
    s_mov_b32 s83, 0xe0000
    buffer_load_dwordx4 v64, s[24:27], s83 offen lds
    s_add_u32 m0, s85, 61440
    s_nop 0
    buffer_load_dwordx4 v65, s[24:27], s83 offen lds
    s_waitcnt vmcnt(12)
    ds_write_b32 v66, v67 offset:5200
    v_and_b32 v68, 7, v1
    v_max_u32 v68, 0, v68
    v_min_u32 v68, 3, v68
    v_mul_u32_u24 v68, 1040, v68
    v_add_u32 v68, 116224, v68
    s_mov_b32 s82, 82944
L_pw_L4_11_8_2:
    ds_read_b32 v69, v68 offset:4
    s_waitcnt lgkmcnt(0)
    v_cmp_gt_i32 vcc, s82, v69
    s_cbranch_vccz L_pw_L4_11_8_2_ok
    s_sleep 1
    s_cselect_b32 s64, 1, 0
    s_sub_u32 s67, s67, 1
    s_cbranch_scc1 L_end
    s_cmp_lg_u32 s64, 0
    s_branch L_pw_L4_11_8_2
L_pw_L4_11_8_2_ok:
    s_add_u32 m0, s84, 98560
    s_mov_b32 s83, 0x140000
    buffer_load_dwordx4 v64, s[20:23], s83 offen lds
    s_add_u32 m0, s84, 102720
    s_nop 0
    buffer_load_dwordx4 v65, s[20:23], s83 offen lds
    s_add_u32 m0, s85, 65536
    s_mov_b32 s83, 0x100000
    buffer_load_dwordx4 v64, s[24:27], s83 offen lds
    s_add_u32 m0, s85, 69632
    s_nop 0
    buffer_load_dwordx4 v65, s[24:27], s83 offen lds
    s_waitcnt vmcnt(12)
    ds_write_b32 v66, v67 offset:6240
    v_and_b32 v68, 7, v1
    v_max_u32 v68, 0, v68
    v_min_u32 v68, 3, v68
    v_mul_u32_u24 v68, 1040, v68
    v_add_u32 v68, 116224, v68
    s_mov_b32 s82, 82944
L_pw_L4_11_8_3:
    ds_read_b32 v69, v68 offset:0
    s_waitcnt lgkmcnt(0)
    v_cmp_gt_i32 vcc, s82, v69
    s_cbranch_vccz L_pw_L4_11_8_3_ok
    s_sleep 1
    s_cselect_b32 s64, 1, 0
    s_sub_u32 s67, s67, 1
    s_cbranch_scc1 L_end
    s_cmp_lg_u32 s64, 0
    s_branch L_pw_L4_11_8_3
L_pw_L4_11_8_3_ok:
    s_add_u32 m0, s85, 8192
    s_mov_b32 s83, 0x120000
    buffer_load_dwordx4 v64, s[24:27], s83 offen lds
    s_add_u32 m0, s85, 12288
    s_nop 0
    buffer_load_dwordx4 v65, s[24:27], s83 offen lds
    s_waitcnt vmcnt(10)
    ds_write_b32 v66, v67 offset:7280
    v_and_b32 v68, 7, v1
    v_max_u32 v68, 0, v68
    v_min_u32 v68, 3, v68
    v_mul_u32_u24 v68, 1040, v68
    v_add_u32 v68, 116224, v68
    s_mov_b32 s82, 85024
L_pw_L4_11_8_4:
    ds_read_b32 v69, v68 offset:4
    s_waitcnt lgkmcnt(0)
    v_cmp_gt_i32 vcc, s82, v69
    s_cbranch_vccz L_pw_L4_11_8_4_ok
    s_sleep 1
    s_cselect_b32 s64, 1, 0
    s_sub_u32 s67, s67, 1
    s_cbranch_scc1 L_end
    s_cmp_lg_u32 s64, 0
    s_branch L_pw_L4_11_8_4
L_pw_L4_11_8_4_ok:
    s_add_u32 m0, s85, 16384
    s_mov_b32 s83, 0x140000
    buffer_load_dwordx4 v64, s[24:27], s83 offen lds
    s_add_u32 m0, s85, 20480
    s_nop 0
    buffer_load_dwordx4 v65, s[24:27], s83 offen lds
    s_waitcnt vmcnt(8)
    ds_write_b32 v66, v67 offset:8320
    s_waitcnt vmcnt(4)
    ds_write_b32 v66, v67 offset:9360
    s_waitcnt vmcnt(2)
    ds_write_b32 v66, v67 offset:10400
    s_waitcnt vmcnt(0)
    ds_write_b32 v66, v67 offset:11440
    s_waitcnt lgkmcnt(0)
    s_endpgm
L_leave:
    s_cmp_eq_u32 s74, 2
    s_cbranch_scc1 L_tail_odd
    s_branch L_md_loop
L_md_first:
    s_mov_b32 s98, m0
    s_mul_i32 s99, s81, 8320
    s_add_u32 m0, s99, 48640
    s_lshl_b32 s99, s80, 17
    s_add_u32 s16, s4, s11
    s_addc_u32 s17, s5, 0
    buffer_load_dwordx4 v70, s[16:19], s99 offen lds
    s_add_u32 m0, m0, 1040
    s_addk_i32 s99, 0x4000
    buffer_load_dwordx4 v70, s[16:19], s99 offen lds
    s_add_u32 m0, m0, 1040
    s_addk_i32 s99, 0x4000
    buffer_load_dwordx4 v70, s[16:19], s99 offen lds
    s_add_u32 m0, m0, 1040
    s_addk_i32 s99, 0x4000
    buffer_load_dwordx4 v70, s[16:19], s99 offen lds
    s_add_u32 m0, m0, 1040
    s_addk_i32 s99, 0x4000
    buffer_load_dwordx4 v70, s[16:19], s99 offen lds
    s_add_u32 m0, m0, 1040
    s_addk_i32 s99, 0x4000
    buffer_load_dwordx4 v70, s[16:19], s99 offen lds
    s_add_u32 m0, m0, 1040
    s_addk_i32 s99, 0x4000
    buffer_load_dwordx4 v70, s[16:19], s99 offen lds
    s_add_u32 m0, m0, 1040
    s_addk_i32 s99, 0x4000
    buffer_load_dwordx4 v70, s[16:19], s99 offen lds
    s_mov_b32 m0, s98
    s_waitcnt vmcnt(8)
    s_branch L_md_back
L_scale_h:
    v_lshlrev_b32 v144, 16, v32
    v_and_b32 v145, 0xffff0000, v32
    v_lshlrev_b32 v146, 16, v33
    v_and_b32 v147, 0xffff0000, v33
    v_lshlrev_b32 v148, 16, v34
    v_and_b32 v149, 0xffff0000, v34
    v_lshlrev_b32 v150, 16, v35
    v_and_b32 v151, 0xffff0000, v35
    v_mul_f32 v144, 0x3e0293ee, v144
    v_mul_f32 v145, 0x3e0293ee, v145
    v_mul_f32 v146, 0x3e0293ee, v146
    v_mul_f32 v147, 0x3e0293ee, v147
    v_mul_f32 v148, 0x3e0293ee, v148
    v_mul_f32 v149, 0x3e0293ee, v149
    v_mul_f32 v150, 0x3e0293ee, v150
    v_mul_f32 v151, 0x3e0293ee, v151
    v_cvt_pk_bf16_f32 v32, v144, v145
    v_cvt_pk_bf16_f32 v33, v146, v147
    v_cvt_pk_bf16_f32 v34, v148, v149
    v_cvt_pk_bf16_f32 v35, v150, v151
    v_lshlrev_b32 v152, 16, v36
    v_and_b32 v153, 0xffff0000, v36
    v_lshlrev_b32 v154, 16, v37
    v_and_b32 v155, 0xffff0000, v37
    v_lshlrev_b32 v156, 16, v38
    v_and_b32 v157, 0xffff0000, v38
    v_lshlrev_b32 v158, 16, v39
    v_and_b32 v159, 0xffff0000, v39
    v_mul_f32 v152, 0x3e0293ee, v152
    v_mul_f32 v153, 0x3e0293ee, v153
    v_mul_f32 v154, 0x3e0293ee, v154
    v_mul_f32 v155, 0x3e0293ee, v155
    v_mul_f32 v156, 0x3e0293ee, v156
    v_mul_f32 v157, 0x3e0293ee, v157
    v_mul_f32 v158, 0x3e0293ee, v158
    v_mul_f32 v159, 0x3e0293ee, v159
    v_cvt_pk_bf16_f32 v36, v152, v153
    v_cvt_pk_bf16_f32 v37, v154, v155
    v_cvt_pk_bf16_f32 v38, v156, v157
    v_cvt_pk_bf16_f32 v39, v158, v159
    v_lshlrev_b32 v144, 16, v40
    v_and_b32 v145, 0xffff0000, v40
    v_lshlrev_b32 v146, 16, v41
    v_and_b32 v147, 0xffff0000, v41
    v_lshlrev_b32 v148, 16, v42
    v_and_b32 v149, 0xffff0000, v42
    v_lshlrev_b32 v150, 16, v43
    v_and_b32 v151, 0xffff0000, v43
    v_mul_f32 v144, 0x3e0293ee, v144
    v_mul_f32 v145, 0x3e0293ee, v145
    v_mul_f32 v146, 0x3e0293ee, v146
    v_mul_f32 v147, 0x3e0293ee, v147
    v_mul_f32 v148, 0x3e0293ee, v148
    v_mul_f32 v149, 0x3e0293ee, v149
    v_mul_f32 v150, 0x3e0293ee, v150
    v_mul_f32 v151, 0x3e0293ee, v151
    v_cvt_pk_bf16_f32 v40, v144, v145
    v_cvt_pk_bf16_f32 v41, v146, v147
    v_cvt_pk_bf16_f32 v42, v148, v149
    v_cvt_pk_bf16_f32 v43, v150, v151
    v_lshlrev_b32 v152, 16, v44
    v_and_b32 v153, 0xffff0000, v44
    v_lshlrev_b32 v154, 16, v45
    v_and_b32 v155, 0xffff0000, v45
    v_lshlrev_b32 v156, 16, v46
    v_and_b32 v157, 0xffff0000, v46
    v_lshlrev_b32 v158, 16, v47
    v_and_b32 v159, 0xffff0000, v47
    v_mul_f32 v152, 0x3e0293ee, v152
    v_mul_f32 v153, 0x3e0293ee, v153
    v_mul_f32 v154, 0x3e0293ee, v154
    v_mul_f32 v155, 0x3e0293ee, v155
    v_mul_f32 v156, 0x3e0293ee, v156
    v_mul_f32 v157, 0x3e0293ee, v157
    v_mul_f32 v158, 0x3e0293ee, v158
    v_mul_f32 v159, 0x3e0293ee, v159
    v_cvt_pk_bf16_f32 v44, v152, v153
    v_cvt_pk_bf16_f32 v45, v154, v155
    v_cvt_pk_bf16_f32 v46, v156, v157
    v_cvt_pk_bf16_f32 v47, v158, v159
    v_lshlrev_b32 v144, 16, v48
    v_and_b32 v145, 0xffff0000, v48
    v_lshlrev_b32 v146, 16, v49
    v_and_b32 v147, 0xffff0000, v49
    v_lshlrev_b32 v148, 16, v50
    v_and_b32 v149, 0xffff0000, v50
    v_lshlrev_b32 v150, 16, v51
    v_and_b32 v151, 0xffff0000, v51
    v_mul_f32 v144, 0x3e0293ee, v144
    v_mul_f32 v145, 0x3e0293ee, v145
    v_mul_f32 v146, 0x3e0293ee, v146
    v_mul_f32 v147, 0x3e0293ee, v147
    v_mul_f32 v148, 0x3e0293ee, v148
    v_mul_f32 v149, 0x3e0293ee, v149
    v_mul_f32 v150, 0x3e0293ee, v150
    v_mul_f32 v151, 0x3e0293ee, v151
    v_cvt_pk_bf16_f32 v48, v144, v145
    v_cvt_pk_bf16_f32 v49, v146, v147
    v_cvt_pk_bf16_f32 v50, v148, v149
    v_cvt_pk_bf16_f32 v51, v150, v151
    v_lshlrev_b32 v152, 16, v52
    v_and_b32 v153, 0xffff0000, v52
    v_lshlrev_b32 v154, 16, v53
    v_and_b32 v155, 0xffff0000, v53
    v_lshlrev_b32 v156, 16, v54
    v_and_b32 v157, 0xffff0000, v54
    v_lshlrev_b32 v158, 16, v55
    v_and_b32 v159, 0xffff0000, v55
    v_mul_f32 v152, 0x3e0293ee, v152
    v_mul_f32 v153, 0x3e0293ee, v153
    v_mul_f32 v154, 0x3e0293ee, v154
    v_mul_f32 v155, 0x3e0293ee, v155
    v_mul_f32 v156, 0x3e0293ee, v156
    v_mul_f32 v157, 0x3e0293ee, v157
    v_mul_f32 v158, 0x3e0293ee, v158
    v_mul_f32 v159, 0x3e0293ee, v159
    v_cvt_pk_bf16_f32 v52, v152, v153
    v_cvt_pk_bf16_f32 v53, v154, v155
    v_cvt_pk_bf16_f32 v54, v156, v157
    v_cvt_pk_bf16_f32 v55, v158, v159
    v_lshlrev_b32 v144, 16, v56
    v_and_b32 v145, 0xffff0000, v56
    v_lshlrev_b32 v146, 16, v57
    v_and_b32 v147, 0xffff0000, v57
    v_lshlrev_b32 v148, 16, v58
    v_and_b32 v149, 0xffff0000, v58
    v_lshlrev_b32 v150, 16, v59
    v_and_b32 v151, 0xffff0000, v59
    v_mul_f32 v144, 0x3e0293ee, v144
    v_mul_f32 v145, 0x3e0293ee, v145
    v_mul_f32 v146, 0x3e0293ee, v146
    v_mul_f32 v147, 0x3e0293ee, v147
    v_mul_f32 v148, 0x3e0293ee, v148
    v_mul_f32 v149, 0x3e0293ee, v149
    v_mul_f32 v150, 0x3e0293ee, v150
    v_mul_f32 v151, 0x3e0293ee, v151
    v_cvt_pk_bf16_f32 v56, v144, v145
    v_cvt_pk_bf16_f32 v57, v146, v147
    v_cvt_pk_bf16_f32 v58, v148, v149
    v_cvt_pk_bf16_f32 v59, v150, v151
    v_lshlrev_b32 v152, 16, v60
    v_and_b32 v153, 0xffff0000, v60
    v_lshlrev_b32 v154, 16, v61
    v_and_b32 v155, 0xffff0000, v61
    v_lshlrev_b32 v156, 16, v62
    v_and_b32 v157, 0xffff0000, v62
    v_lshlrev_b32 v158, 16, v63
    v_and_b32 v159, 0xffff0000, v63
    v_mul_f32 v152, 0x3e0293ee, v152
    v_mul_f32 v153, 0x3e0293ee, v153
    v_mul_f32 v154, 0x3e0293ee, v154
    v_mul_f32 v155, 0x3e0293ee, v155
    v_mul_f32 v156, 0x3e0293ee, v156
    v_mul_f32 v157, 0x3e0293ee, v157
    v_mul_f32 v158, 0x3e0293ee, v158
    v_mul_f32 v159, 0x3e0293ee, v159
    v_cvt_pk_bf16_f32 v60, v152, v153
    v_cvt_pk_bf16_f32 v61, v154, v155
    v_cvt_pk_bf16_f32 v62, v156, v157
    v_cvt_pk_bf16_f32 v63, v158, v159
L_spin_h:
    s_cselect_b32 s64, 1, 0
    s_sub_u32 s67, s67, 1
    s_cbranch_scc1 L_end
    s_cmp_lg_u32 s64, 0
    s_sleep 1
    ds_read_b32 v3, v0 offset:0
    s_waitcnt lgkmcnt(0)
    v_cmp_gt_f32 vcc, 0, v3
    s_cbranch_vccnz L_spin_h
    s_bitcmp1_b32 s68, 18
    s_cbranch_scc0 L_helper_go
    v_and_b32 v14, 1, v1
    v_mul_u32_u24 v14, 1040, v14
    v_add_u32 v14, 116224, v14
L_helper_wait:
    s_cselect_b32 s64, 1, 0
    s_sub_u32 s67, s67, 1
    s_cbranch_scc1 L_end
    s_cmp_lg_u32 s64, 0
    s_sleep 1
    ds_read_b32 v3, v14
    s_waitcnt lgkmcnt(0)
    v_cmp_gt_i32 vcc, 1, v3
    s_cbranch_vccnz L_helper_wait
L_helper_go:
    s_setprio 0
    s_bitcmp1_b32 s68, 16
    s_cbranch_scc0 L_helper_go2
    s_setprio 1
L_helper_go2:
    ds_read_b128 v[64:67], v4 offset:0
    ds_read_b128 v[68:71], v4 offset:32
    ds_read_b128 v[72:75], v5 offset:0
    ds_read_b128 v[76:79], v5 offset:32
    ds_read_b128 v[80:83], v6 offset:0
    ds_read_b128 v[84:87], v6 offset:32
    ds_read_b128 v[88:91], v7 offset:0
    ds_read_b128 v[92:95], v7 offset:32
    s_branch L_qk0
L_init:
    s_bitcmp1_b32 s68, 19
    s_cbranch_scc1 L_init_shared
    s_waitcnt vmcnt(8)
    ds_write_b32 v66, v67 offset:1040
    s_branch L_noinit
L_init_shared:
    s_waitcnt vmcnt(0)
    ds_write_b32 v66, v67 offset:1040
    s_lshr_b32 s82, s77, 24
    s_mul_i32 s82, s82, 1040
    s_add_u32 s82, s82, 116224
    v_mov_b32 v14, s82
L_init_wait:
    s_cselect_b32 s64, 1, 0
    s_sub_u32 s67, s67, 1
    s_cbranch_scc1 L_end
    s_cmp_lg_u32 s64, 0
    s_sleep 1
    ds_read_b32 v3, v14
    s_waitcnt lgkmcnt(0)
    v_cmp_gt_i32 vcc, 0, v3
    s_cbranch_vccnz L_init_wait
    s_branch L_noinit
L_stg_T01:
    s_cselect_b32 s64, 1, 0
    s_sub_u32 s67, s67, 1
    s_cbranch_scc1 L_end
    s_cmp_lg_u32 s64, 0
    s_sleep 1
    ds_read_b32 v3, v190
    s_waitcnt lgkmcnt(0)
    v_cmp_gt_i32 vcc, s15, v3
    s_cbranch_vccnz L_stg_T01
    s_branch L_stgback_T01
L_stg_T11:
    s_cselect_b32 s64, 1, 0
    s_sub_u32 s67, s67, 1
    s_cbranch_scc1 L_end
    s_cmp_lg_u32 s64, 0
    s_sleep 1
    ds_read_b32 v3, v190
    s_waitcnt lgkmcnt(0)
    v_cmp_gt_i32 vcc, s15, v3
    s_cbranch_vccnz L_stg_T11
    s_branch L_stgback_T11
L_stg_T21:
    s_cselect_b32 s64, 1, 0
    s_sub_u32 s67, s67, 1
    s_cbranch_scc1 L_end
    s_cmp_lg_u32 s64, 0
    s_sleep 1
    ds_read_b32 v3, v190
    s_waitcnt lgkmcnt(0)
    v_cmp_gt_i32 vcc, s15, v3
    s_cbranch_vccnz L_stg_T21
    s_branch L_stgback_T21
L_stg_T00:
    s_cselect_b32 s64, 1, 0
    s_sub_u32 s67, s67, 1
    s_cbranch_scc1 L_end
    s_cmp_lg_u32 s64, 0
    s_sleep 1
    ds_read_b32 v3, v190
    s_waitcnt lgkmcnt(0)
    v_cmp_gt_i32 vcc, s15, v3
    s_cbranch_vccnz L_stg_T00
    s_branch L_stgback_T00
L_stg_T10:
    s_cselect_b32 s64, 1, 0
    s_sub_u32 s67, s67, 1
    s_cbranch_scc1 L_end
    s_cmp_lg_u32 s64, 0
    s_sleep 1
    ds_read_b32 v3, v190
    s_waitcnt lgkmcnt(0)
    v_cmp_gt_i32 vcc, s15, v3
    s_cbranch_vccnz L_stg_T10
    s_branch L_stgback_T10
L_stg_T20:
    s_cselect_b32 s64, 1, 0
    s_sub_u32 s67, s67, 1
    s_cbranch_scc1 L_end
    s_cmp_lg_u32 s64, 0
    s_sleep 1
    ds_read_b32 v3, v190
    s_waitcnt lgkmcnt(0)
    v_cmp_gt_i32 vcc, s15, v3
    s_cbranch_vccnz L_stg_T20
    s_branch L_stgback_T20
L_rare_i0:
    v_cmp_lt_f32 vcc, s3, v13
    s_nop 1
    s_or_b64 vcc, vcc, s[84:85]
    s_cbranch_vccz L_spin_i0
    s_nop 15
    s_nop 7
    v_max3_f32 v176, v128, v129, v130
    v_max3_f32 v177, v131, v132, v133
    v_max3_f32 v176, v176, v134, v135
    v_max3_f32 v177, v177, v136, v137
    v_max3_f32 v176, v176, v138, v139
    v_max3_f32 v177, v177, v140, v141
    v_max3_f32 v176, v176, v142, v143
    v_max_f32 v176, v176, v177
    v_mov_b32 v177, v176
    s_nop 1
    v_permlane32_swap_b32 v176, v177
    s_nop 1
    v_max_f32 v176, v176, v177
    v_mov_b32 v14, v176
    v_sub_f32 v128, v128, v14
    v_sub_f32 v144, v144, v14
    v_sub_f32 v16, v16, v14
    v_sub_f32 v129, v129, v14
    v_sub_f32 v145, v145, v14
    v_sub_f32 v17, v17, v14
    v_sub_f32 v130, v130, v14
    v_sub_f32 v146, v146, v14
    v_sub_f32 v18, v18, v14
    v_sub_f32 v131, v131, v14
    v_sub_f32 v147, v147, v14
    v_sub_f32 v19, v19, v14
    v_sub_f32 v132, v132, v14
    v_sub_f32 v148, v148, v14
    v_sub_f32 v20, v20, v14
    v_sub_f32 v133, v133, v14
    v_sub_f32 v149, v149, v14
    v_sub_f32 v21, v21, v14
    v_sub_f32 v134, v134, v14
    v_sub_f32 v150, v150, v14
    v_sub_f32 v22, v22, v14
    v_sub_f32 v135, v135, v14
    v_sub_f32 v151, v151, v14
    v_sub_f32 v23, v23, v14
    v_sub_f32 v136, v136, v14
    v_sub_f32 v152, v152, v14
    v_sub_f32 v24, v24, v14
    v_sub_f32 v137, v137, v14
    v_sub_f32 v153, v153, v14
    v_sub_f32 v25, v25, v14
    v_sub_f32 v138, v138, v14
    v_sub_f32 v154, v154, v14
    v_sub_f32 v26, v26, v14
    v_sub_f32 v139, v139, v14
    v_sub_f32 v155, v155, v14
    v_sub_f32 v27, v27, v14
    v_sub_f32 v140, v140, v14
    v_sub_f32 v156, v156, v14
    v_sub_f32 v28, v28, v14
    v_sub_f32 v141, v141, v14
    v_sub_f32 v157, v157, v14
    v_sub_f32 v29, v29, v14
    v_sub_f32 v142, v142, v14
    v_sub_f32 v158, v158, v14
    v_sub_f32 v30, v30, v14
    v_sub_f32 v143, v143, v14
    v_sub_f32 v159, v159, v14
    v_sub_f32 v31, v31, v14
    v_exp_f32 v176, v128
    v_exp_f32 v177, v129
    v_exp_f32 v178, v130
    v_add_f32 v13, v176, v177
    v_cvt_pk_bf16_f32 v160, v176, v177
    v_exp_f32 v179, v131
    v_add_f32 v13, v13, v178
    v_exp_f32 v180, v132
    v_add_f32 v13, v13, v179
    v_cvt_pk_bf16_f32 v161, v178, v179
    v_exp_f32 v181, v133
    v_add_f32 v13, v13, v180
    v_exp_f32 v182, v134
    v_add_f32 v13, v13, v181
    v_cvt_pk_bf16_f32 v162, v180, v181
    v_exp_f32 v183, v135
    v_add_f32 v13, v13, v182
    v_exp_f32 v176, v136
    v_add_f32 v13, v13, v183
    v_cvt_pk_bf16_f32 v163, v182, v183
    v_exp_f32 v177, v137
    v_add_f32 v13, v13, v176
    v_exp_f32 v178, v138
    v_add_f32 v13, v13, v177
    v_cvt_pk_bf16_f32 v164, v176, v177
    v_exp_f32 v179, v139
    v_add_f32 v13, v13, v178
    v_exp_f32 v180, v140
    v_add_f32 v13, v13, v179
    v_cvt_pk_bf16_f32 v165, v178, v179
    v_exp_f32 v181, v141
    v_add_f32 v13, v13, v180
    v_exp_f32 v182, v142
    v_add_f32 v13, v13, v181
    v_cvt_pk_bf16_f32 v166, v180, v181
    v_exp_f32 v183, v143
    v_add_f32 v13, v13, v182
    v_add_f32 v13, v13, v183
    v_cvt_pk_bf16_f32 v167, v182, v183
    s_nop 1
L_spin_i0:
    s_cselect_b32 s64, 1, 0
    s_sub_u32 s67, s67, 1
    s_cbranch_scc1 L_end
    s_cmp_lg_u32 s64, 0
    ds_read_b32 v3, v0 offset:2080
    s_waitcnt lgkmcnt(0)
    v_cmp_gt_f32 vcc, 0, v3
    s_cbranch_vccnz L_spin_i0
    s_branch L_back_i0
L_rare_A:
    v_cmp_lt_f32 vcc, s3, v13
    s_cbranch_vccz L_spin_A
    s_nop 15
    s_nop 7
    v_max3_f32 v176, v144, v145, v146
    v_max3_f32 v177, v147, v148, v149
    v_max3_f32 v176, v176, v150, v151
    v_max3_f32 v177, v177, v152, v153
    v_max3_f32 v176, v176, v154, v155
    v_max3_f32 v177, v177, v156, v157
    v_max3_f32 v176, v176, v158, v159
    v_max_f32 v176, v176, v177
    v_mov_b32 v177, v176
    s_nop 1
    v_permlane32_swap_b32 v176, v177
    s_nop 1
    v_max_f32 v176, v176, v177
    v_max_f32 v14, 0, v176
    v_sub_f32 v177, 0, v14
    v_exp_f32 v177, v177
    v_sub_f32 v144, v144, v14
    v_sub_f32 v128, v128, v14
    v_sub_f32 v16, v16, v14
    v_sub_f32 v145, v145, v14
    v_sub_f32 v129, v129, v14
    v_sub_f32 v17, v17, v14
    v_sub_f32 v146, v146, v14
    v_sub_f32 v130, v130, v14
    v_sub_f32 v18, v18, v14
    v_sub_f32 v147, v147, v14
    v_sub_f32 v131, v131, v14
    v_sub_f32 v19, v19, v14
    v_sub_f32 v148, v148, v14
    v_sub_f32 v132, v132, v14
    v_sub_f32 v20, v20, v14
    v_sub_f32 v149, v149, v14
    v_sub_f32 v133, v133, v14
    v_sub_f32 v21, v21, v14
    v_sub_f32 v150, v150, v14
    v_sub_f32 v134, v134, v14
    v_sub_f32 v22, v22, v14
    v_sub_f32 v151, v151, v14
    v_sub_f32 v135, v135, v14
    v_sub_f32 v23, v23, v14
    v_sub_f32 v152, v152, v14
    v_sub_f32 v136, v136, v14
    v_sub_f32 v24, v24, v14
    v_sub_f32 v153, v153, v14
    v_sub_f32 v137, v137, v14
    v_sub_f32 v25, v25, v14
    v_sub_f32 v154, v154, v14
    v_sub_f32 v138, v138, v14
    v_sub_f32 v26, v26, v14
    v_sub_f32 v155, v155, v14
    v_sub_f32 v139, v139, v14
    v_sub_f32 v27, v27, v14
    v_sub_f32 v156, v156, v14
    v_sub_f32 v140, v140, v14
    v_sub_f32 v28, v28, v14
    v_sub_f32 v157, v157, v14
    v_sub_f32 v141, v141, v14
    v_sub_f32 v29, v29, v14
    v_sub_f32 v158, v158, v14
    v_sub_f32 v142, v142, v14
    v_sub_f32 v30, v30, v14
    v_sub_f32 v159, v159, v14
    v_sub_f32 v143, v143, v14
    v_sub_f32 v31, v31, v14
    v_mul_f32 v192, v192, v177
    v_mul_f32 v193, v193, v177
    v_mul_f32 v194, v194, v177
    v_mul_f32 v195, v195, v177
    v_mul_f32 v196, v196, v177
    v_mul_f32 v197, v197, v177
    v_mul_f32 v198, v198, v177
    v_mul_f32 v199, v199, v177
    v_mul_f32 v200, v200, v177
    v_mul_f32 v201, v201, v177
    v_mul_f32 v202, v202, v177
    v_mul_f32 v203, v203, v177
    v_mul_f32 v204, v204, v177
    v_mul_f32 v205, v205, v177
    v_mul_f32 v206, v206, v177
    v_mul_f32 v207, v207, v177
    v_mul_f32 v208, v208, v177
    v_mul_f32 v209, v209, v177
    v_mul_f32 v210, v210, v177
    v_mul_f32 v211, v211, v177
    v_mul_f32 v212, v212, v177
    v_mul_f32 v213, v213, v177
    v_mul_f32 v214, v214, v177
    v_mul_f32 v215, v215, v177
    v_mul_f32 v216, v216, v177
    v_mul_f32 v217, v217, v177
    v_mul_f32 v218, v218, v177
    v_mul_f32 v219, v219, v177
    v_mul_f32 v220, v220, v177
    v_mul_f32 v221, v221, v177
    v_mul_f32 v222, v222, v177
    v_mul_f32 v223, v223, v177
    v_mul_f32 v224, v224, v177
    v_mul_f32 v225, v225, v177
    v_mul_f32 v226, v226, v177
    v_mul_f32 v227, v227, v177
    v_mul_f32 v228, v228, v177
    v_mul_f32 v229, v229, v177
    v_mul_f32 v230, v230, v177
    v_mul_f32 v231, v231, v177
    v_mul_f32 v232, v232, v177
    v_mul_f32 v233, v233, v177
    v_mul_f32 v234, v234, v177
    v_mul_f32 v235, v235, v177
    v_mul_f32 v236, v236, v177
    v_mul_f32 v237, v237, v177
    v_mul_f32 v238, v238, v177
    v_mul_f32 v239, v239, v177
    v_mul_f32 v240, v240, v177
    v_mul_f32 v241, v241, v177
    v_mul_f32 v242, v242, v177
    v_mul_f32 v243, v243, v177
    v_mul_f32 v244, v244, v177
    v_mul_f32 v245, v245, v177
    v_mul_f32 v246, v246, v177
    v_mul_f32 v247, v247, v177
    v_mul_f32 v248, v248, v177
    v_mul_f32 v249, v249, v177
    v_mul_f32 v250, v250, v177
    v_mul_f32 v251, v251, v177
    v_mul_f32 v252, v252, v177
    v_mul_f32 v253, v253, v177
    v_mul_f32 v254, v254, v177
    v_mul_f32 v255, v255, v177
    v_mul_f32 v12, v12, v177
    v_exp_f32 v176, v144
    v_exp_f32 v177, v145
    v_exp_f32 v178, v146
    v_add_f32 v13, v176, v177
    v_cvt_pk_bf16_f32 v168, v176, v177
    v_exp_f32 v179, v147
    v_add_f32 v13, v13, v178
    v_exp_f32 v180, v148
    v_add_f32 v13, v13, v179
    v_cvt_pk_bf16_f32 v169, v178, v179
    v_exp_f32 v181, v149
    v_add_f32 v13, v13, v180
    v_exp_f32 v182, v150
    v_add_f32 v13, v13, v181
    v_cvt_pk_bf16_f32 v170, v180, v181
    v_exp_f32 v183, v151
    v_add_f32 v13, v13, v182
    v_exp_f32 v176, v152
    v_add_f32 v13, v13, v183
    v_cvt_pk_bf16_f32 v171, v182, v183
    v_exp_f32 v177, v153
    v_add_f32 v13, v13, v176
    v_exp_f32 v178, v154
    v_add_f32 v13, v13, v177
    v_cvt_pk_bf16_f32 v172, v176, v177
    v_exp_f32 v179, v155
    v_add_f32 v13, v13, v178
    v_exp_f32 v180, v156
    v_add_f32 v13, v13, v179
    v_cvt_pk_bf16_f32 v173, v178, v179
    v_exp_f32 v181, v157
    v_add_f32 v13, v13, v180
    v_exp_f32 v182, v158
    v_add_f32 v13, v13, v181
    v_cvt_pk_bf16_f32 v174, v180, v181
    v_exp_f32 v183, v159
    v_add_f32 v13, v13, v182
    v_add_f32 v13, v13, v183
    v_cvt_pk_bf16_f32 v175, v182, v183
    s_nop 1
L_spin_A:
    s_cselect_b32 s64, 1, 0
    s_sub_u32 s67, s67, 1
    s_cbranch_scc1 L_end
    s_cmp_lg_u32 s64, 0
    ds_read_b32 v3, v0 offset:3120
    s_waitcnt lgkmcnt(0)
    v_cmp_gt_f32 vcc, 0, v3
    s_cbranch_vccnz L_spin_A
    s_branch L_back_A
L_rare_B:
    v_cmp_lt_f32 vcc, s3, v13
    s_cbranch_vccz L_spin_B
    s_nop 15
    s_nop 7
    v_max3_f32 v176, v128, v129, v130
    v_max3_f32 v177, v131, v132, v133
    v_max3_f32 v176, v176, v134, v135
    v_max3_f32 v177, v177, v136, v137
    v_max3_f32 v176, v176, v138, v139
    v_max3_f32 v177, v177, v140, v141
    v_max3_f32 v176, v176, v142, v143
    v_max_f32 v176, v176, v177
    v_mov_b32 v177, v176
    s_nop 1
    v_permlane32_swap_b32 v176, v177
    s_nop 1
    v_max_f32 v176, v176, v177
    v_max_f32 v14, 0, v176
    v_sub_f32 v177, 0, v14
    v_exp_f32 v177, v177
    v_sub_f32 v128, v128, v14
    v_sub_f32 v144, v144, v14
    v_sub_f32 v16, v16, v14
    v_sub_f32 v129, v129, v14
    v_sub_f32 v145, v145, v14
    v_sub_f32 v17, v17, v14
    v_sub_f32 v130, v130, v14
    v_sub_f32 v146, v146, v14
    v_sub_f32 v18, v18, v14
    v_sub_f32 v131, v131, v14
    v_sub_f32 v147, v147, v14
    v_sub_f32 v19, v19, v14
    v_sub_f32 v132, v132, v14
    v_sub_f32 v148, v148, v14
    v_sub_f32 v20, v20, v14
    v_sub_f32 v133, v133, v14
    v_sub_f32 v149, v149, v14
    v_sub_f32 v21, v21, v14
    v_sub_f32 v134, v134, v14
    v_sub_f32 v150, v150, v14
    v_sub_f32 v22, v22, v14
    v_sub_f32 v135, v135, v14
    v_sub_f32 v151, v151, v14
    v_sub_f32 v23, v23, v14
    v_sub_f32 v136, v136, v14
    v_sub_f32 v152, v152, v14
    v_sub_f32 v24, v24, v14
    v_sub_f32 v137, v137, v14
    v_sub_f32 v153, v153, v14
    v_sub_f32 v25, v25, v14
    v_sub_f32 v138, v138, v14
    v_sub_f32 v154, v154, v14
    v_sub_f32 v26, v26, v14
    v_sub_f32 v139, v139, v14
    v_sub_f32 v155, v155, v14
    v_sub_f32 v27, v27, v14
    v_sub_f32 v140, v140, v14
    v_sub_f32 v156, v156, v14
    v_sub_f32 v28, v28, v14
    v_sub_f32 v141, v141, v14
    v_sub_f32 v157, v157, v14
    v_sub_f32 v29, v29, v14
    v_sub_f32 v142, v142, v14
    v_sub_f32 v158, v158, v14
    v_sub_f32 v30, v30, v14
    v_sub_f32 v143, v143, v14
    v_sub_f32 v159, v159, v14
    v_sub_f32 v31, v31, v14
    v_mul_f32 v192, v192, v177
    v_mul_f32 v193, v193, v177
    v_mul_f32 v194, v194, v177
    v_mul_f32 v195, v195, v177
    v_mul_f32 v196, v196, v177
    v_mul_f32 v197, v197, v177
    v_mul_f32 v198, v198, v177
    v_mul_f32 v199, v199, v177
    v_mul_f32 v200, v200, v177
    v_mul_f32 v201, v201, v177
    v_mul_f32 v202, v202, v177
    v_mul_f32 v203, v203, v177
    v_mul_f32 v204, v204, v177
    v_mul_f32 v205, v205, v177
    v_mul_f32 v206, v206, v177
    v_mul_f32 v207, v207, v177
    v_mul_f32 v208, v208, v177
    v_mul_f32 v209, v209, v177
    v_mul_f32 v210, v210, v177
    v_mul_f32 v211, v211, v177
    v_mul_f32 v212, v212, v177
    v_mul_f32 v213, v213, v177
    v_mul_f32 v214, v214, v177
    v_mul_f32 v215, v215, v177
    v_mul_f32 v216, v216, v177
    v_mul_f32 v217, v217, v177
    v_mul_f32 v218, v218, v177
    v_mul_f32 v219, v219, v177
    v_mul_f32 v220, v220, v177
    v_mul_f32 v221, v221, v177
    v_mul_f32 v222, v222, v177
    v_mul_f32 v223, v223, v177
    v_mul_f32 v224, v224, v177
    v_mul_f32 v225, v225, v177
    v_mul_f32 v226, v226, v177
    v_mul_f32 v227, v227, v177
    v_mul_f32 v228, v228, v177
    v_mul_f32 v229, v229, v177
    v_mul_f32 v230, v230, v177
    v_mul_f32 v231, v231, v177
    v_mul_f32 v232, v232, v177
    v_mul_f32 v233, v233, v177
    v_mul_f32 v234, v234, v177
    v_mul_f32 v235, v235, v177
    v_mul_f32 v236, v236, v177
    v_mul_f32 v237, v237, v177
    v_mul_f32 v238, v238, v177
    v_mul_f32 v239, v239, v177
    v_mul_f32 v240, v240, v177
    v_mul_f32 v241, v241, v177
    v_mul_f32 v242, v242, v177
    v_mul_f32 v243, v243, v177
    v_mul_f32 v244, v244, v177
    v_mul_f32 v245, v245, v177
    v_mul_f32 v246, v246, v177
    v_mul_f32 v247, v247, v177
    v_mul_f32 v248, v248, v177
    v_mul_f32 v249, v249, v177
    v_mul_f32 v250, v250, v177
    v_mul_f32 v251, v251, v177
    v_mul_f32 v252, v252, v177
    v_mul_f32 v253, v253, v177
    v_mul_f32 v254, v254, v177
    v_mul_f32 v255, v255, v177
    v_mul_f32 v12, v12, v177
    v_exp_f32 v176, v128
    v_exp_f32 v177, v129
    v_exp_f32 v178, v130
    v_add_f32 v13, v176, v177
    v_cvt_pk_bf16_f32 v160, v176, v177
    v_exp_f32 v179, v131
    v_add_f32 v13, v13, v178
    v_exp_f32 v180, v132
    v_add_f32 v13, v13, v179
    v_cvt_pk_bf16_f32 v161, v178, v179
    v_exp_f32 v181, v133
    v_add_f32 v13, v13, v180
    v_exp_f32 v182, v134
    v_add_f32 v13, v13, v181
    v_cvt_pk_bf16_f32 v162, v180, v181
    v_exp_f32 v183, v135
    v_add_f32 v13, v13, v182
    v_exp_f32 v176, v136
    v_add_f32 v13, v13, v183
    v_cvt_pk_bf16_f32 v163, v182, v183
    v_exp_f32 v177, v137
    v_add_f32 v13, v13, v176
    v_exp_f32 v178, v138
    v_add_f32 v13, v13, v177
    v_cvt_pk_bf16_f32 v164, v176, v177
    v_exp_f32 v179, v139
    v_add_f32 v13, v13, v178
    v_exp_f32 v180, v140
    v_add_f32 v13, v13, v179
    v_cvt_pk_bf16_f32 v165, v178, v179
    v_exp_f32 v181, v141
    v_add_f32 v13, v13, v180
    v_exp_f32 v182, v142
    v_add_f32 v13, v13, v181
    v_cvt_pk_bf16_f32 v166, v180, v181
    v_exp_f32 v183, v143
    v_add_f32 v13, v13, v182
    v_add_f32 v13, v13, v183
    v_cvt_pk_bf16_f32 v167, v182, v183
    s_nop 1
L_spin_B:
    s_cselect_b32 s64, 1, 0
    s_sub_u32 s67, s67, 1
    s_cbranch_scc1 L_end
    s_cmp_lg_u32 s64, 0
    ds_read_b32 v3, v0 offset:2080
    s_waitcnt lgkmcnt(0)
    v_cmp_gt_f32 vcc, 0, v3
    s_cbranch_vccnz L_spin_B
    s_branch L_back_B
L_rare_T11:
    s_nop 15
    s_nop 7
    v_max3_f32 v176, v144, v145, v146
    v_max3_f32 v177, v147, v148, v149
    v_max3_f32 v176, v176, v150, v151
    v_max3_f32 v177, v177, v152, v153
    v_max3_f32 v176, v176, v154, v155
    v_max3_f32 v177, v177, v156, v157
    v_max3_f32 v176, v176, v158, v159
    v_max_f32 v176, v176, v177
    v_mov_b32 v177, v176
    s_nop 1
    v_permlane32_swap_b32 v176, v177
    s_nop 1
    v_max_f32 v176, v176, v177
    v_max_f32 v14, 0, v176
    v_sub_f32 v177, 0, v14
    v_exp_f32 v177, v177
    v_sub_f32 v144, v144, v14
    v_sub_f32 v16, v16, v14
    v_sub_f32 v145, v145, v14
    v_sub_f32 v17, v17, v14
    v_sub_f32 v146, v146, v14
    v_sub_f32 v18, v18, v14
    v_sub_f32 v147, v147, v14
    v_sub_f32 v19, v19, v14
    v_sub_f32 v148, v148, v14
    v_sub_f32 v20, v20, v14
    v_sub_f32 v149, v149, v14
    v_sub_f32 v21, v21, v14
    v_sub_f32 v150, v150, v14
    v_sub_f32 v22, v22, v14
    v_sub_f32 v151, v151, v14
    v_sub_f32 v23, v23, v14
    v_sub_f32 v152, v152, v14
    v_sub_f32 v24, v24, v14
    v_sub_f32 v153, v153, v14
    v_sub_f32 v25, v25, v14
    v_sub_f32 v154, v154, v14
    v_sub_f32 v26, v26, v14
    v_sub_f32 v155, v155, v14
    v_sub_f32 v27, v27, v14
    v_sub_f32 v156, v156, v14
    v_sub_f32 v28, v28, v14
    v_sub_f32 v157, v157, v14
    v_sub_f32 v29, v29, v14
    v_sub_f32 v158, v158, v14
    v_sub_f32 v30, v30, v14
    v_sub_f32 v159, v159, v14
    v_sub_f32 v31, v31, v14
    v_mul_f32 v192, v192, v177
    v_mul_f32 v193, v193, v177
    v_mul_f32 v194, v194, v177
    v_mul_f32 v195, v195, v177
    v_mul_f32 v196, v196, v177
    v_mul_f32 v197, v197, v177
    v_mul_f32 v198, v198, v177
    v_mul_f32 v199, v199, v177
    v_mul_f32 v200, v200, v177
    v_mul_f32 v201, v201, v177
    v_mul_f32 v202, v202, v177
    v_mul_f32 v203, v203, v177
    v_mul_f32 v204, v204, v177
    v_mul_f32 v205, v205, v177
    v_mul_f32 v206, v206, v177
    v_mul_f32 v207, v207, v177
    v_mul_f32 v208, v208, v177
    v_mul_f32 v209, v209, v177
    v_mul_f32 v210, v210, v177
    v_mul_f32 v211, v211, v177
    v_mul_f32 v212, v212, v177
    v_mul_f32 v213, v213, v177
    v_mul_f32 v214, v214, v177
    v_mul_f32 v215, v215, v177
    v_mul_f32 v216, v216, v177
    v_mul_f32 v217, v217, v177
    v_mul_f32 v218, v218, v177
    v_mul_f32 v219, v219, v177
    v_mul_f32 v220, v220, v177
    v_mul_f32 v221, v221, v177
    v_mul_f32 v222, v222, v177
    v_mul_f32 v223, v223, v177
    v_mul_f32 v224, v224, v177
    v_mul_f32 v225, v225, v177
    v_mul_f32 v226, v226, v177
    v_mul_f32 v227, v227, v177
    v_mul_f32 v228, v228, v177
    v_mul_f32 v229, v229, v177
    v_mul_f32 v230, v230, v177
    v_mul_f32 v231, v231, v177
    v_mul_f32 v232, v232, v177
    v_mul_f32 v233, v233, v177
    v_mul_f32 v234, v234, v177
    v_mul_f32 v235, v235, v177
    v_mul_f32 v236, v236, v177
    v_mul_f32 v237, v237, v177
    v_mul_f32 v238, v238, v177
    v_mul_f32 v239, v239, v177
    v_mul_f32 v240, v240, v177
    v_mul_f32 v241, v241, v177
    v_mul_f32 v242, v242, v177
    v_mul_f32 v243, v243, v177
    v_mul_f32 v244, v244, v177
    v_mul_f32 v245, v245, v177
    v_mul_f32 v246, v246, v177
    v_mul_f32 v247, v247, v177
    v_mul_f32 v248, v248, v177
    v_mul_f32 v249, v249, v177
    v_mul_f32 v250, v250, v177
    v_mul_f32 v251, v251, v177
    v_mul_f32 v252, v252, v177
    v_mul_f32 v253, v253, v177
    v_mul_f32 v254, v254, v177
    v_mul_f32 v255, v255, v177
    v_mul_f32 v12, v12, v177
    v_exp_f32 v176, v144
    v_exp_f32 v177, v145
    v_exp_f32 v178, v146
    v_add_f32 v13, v176, v177
    v_cvt_pk_bf16_f32 v168, v176, v177
    v_exp_f32 v179, v147
    v_add_f32 v13, v13, v178
    v_exp_f32 v180, v148
    v_add_f32 v13, v13, v179
    v_cvt_pk_bf16_f32 v169, v178, v179
    v_exp_f32 v181, v149
    v_add_f32 v13, v13, v180
    v_exp_f32 v182, v150
    v_add_f32 v13, v13, v181
    v_cvt_pk_bf16_f32 v170, v180, v181
    v_exp_f32 v183, v151
    v_add_f32 v13, v13, v182
    v_exp_f32 v176, v152
    v_add_f32 v13, v13, v183
    v_cvt_pk_bf16_f32 v171, v182, v183
    v_exp_f32 v177, v153
    v_add_f32 v13, v13, v176
    v_exp_f32 v178, v154
    v_add_f32 v13, v13, v177
    v_cvt_pk_bf16_f32 v172, v176, v177
    v_exp_f32 v179, v155
    v_add_f32 v13, v13, v178
    v_exp_f32 v180, v156
    v_add_f32 v13, v13, v179
    v_cvt_pk_bf16_f32 v173, v178, v179
    v_exp_f32 v181, v157
    v_add_f32 v13, v13, v180
    v_exp_f32 v182, v158
    v_add_f32 v13, v13, v181
    v_cvt_pk_bf16_f32 v174, v180, v181
    v_exp_f32 v183, v159
    v_add_f32 v13, v13, v182
    v_add_f32 v13, v13, v183
    v_cvt_pk_bf16_f32 v175, v182, v183
    s_nop 1
    s_branch L_back_T11
L_rare_T21:
    s_nop 15
    s_nop 7
    v_max3_f32 v176, v144, v145, v146
    v_max3_f32 v177, v147, v148, v149
    v_max3_f32 v176, v176, v150, v151
    v_max3_f32 v177, v177, v152, v153
    v_max3_f32 v176, v176, v154, v155
    v_max3_f32 v177, v177, v156, v157
    v_max3_f32 v176, v176, v158, v159
    v_max_f32 v176, v176, v177
    v_mov_b32 v177, v176
    s_nop 1
    v_permlane32_swap_b32 v176, v177
    s_nop 1
    v_max_f32 v176, v176, v177
    v_max_f32 v14, 0, v176
    v_sub_f32 v177, 0, v14
    v_exp_f32 v177, v177
    v_sub_f32 v144, v144, v14
    v_sub_f32 v16, v16, v14
    v_sub_f32 v145, v145, v14
    v_sub_f32 v17, v17, v14
    v_sub_f32 v146, v146, v14
    v_sub_f32 v18, v18, v14
    v_sub_f32 v147, v147, v14
    v_sub_f32 v19, v19, v14
    v_sub_f32 v148, v148, v14
    v_sub_f32 v20, v20, v14
    v_sub_f32 v149, v149, v14
    v_sub_f32 v21, v21, v14
    v_sub_f32 v150, v150, v14
    v_sub_f32 v22, v22, v14
    v_sub_f32 v151, v151, v14
    v_sub_f32 v23, v23, v14
    v_sub_f32 v152, v152, v14
    v_sub_f32 v24, v24, v14
    v_sub_f32 v153, v153, v14
    v_sub_f32 v25, v25, v14
    v_sub_f32 v154, v154, v14
    v_sub_f32 v26, v26, v14
    v_sub_f32 v155, v155, v14
    v_sub_f32 v27, v27, v14
    v_sub_f32 v156, v156, v14
    v_sub_f32 v28, v28, v14
    v_sub_f32 v157, v157, v14
    v_sub_f32 v29, v29, v14
    v_sub_f32 v158, v158, v14
    v_sub_f32 v30, v30, v14
    v_sub_f32 v159, v159, v14
    v_sub_f32 v31, v31, v14
    v_mul_f32 v192, v192, v177
    v_mul_f32 v193, v193, v177
    v_mul_f32 v194, v194, v177
    v_mul_f32 v195, v195, v177
    v_mul_f32 v196, v196, v177
    v_mul_f32 v197, v197, v177
    v_mul_f32 v198, v198, v177
    v_mul_f32 v199, v199, v177
    v_mul_f32 v200, v200, v177
    v_mul_f32 v201, v201, v177
    v_mul_f32 v202, v202, v177
    v_mul_f32 v203, v203, v177
    v_mul_f32 v204, v204, v177
    v_mul_f32 v205, v205, v177
    v_mul_f32 v206, v206, v177
    v_mul_f32 v207, v207, v177
    v_mul_f32 v208, v208, v177
    v_mul_f32 v209, v209, v177
    v_mul_f32 v210, v210, v177
    v_mul_f32 v211, v211, v177
    v_mul_f32 v212, v212, v177
    v_mul_f32 v213, v213, v177
    v_mul_f32 v214, v214, v177
    v_mul_f32 v215, v215, v177
    v_mul_f32 v216, v216, v177
    v_mul_f32 v217, v217, v177
    v_mul_f32 v218, v218, v177
    v_mul_f32 v219, v219, v177
    v_mul_f32 v220, v220, v177
    v_mul_f32 v221, v221, v177
    v_mul_f32 v222, v222, v177
    v_mul_f32 v223, v223, v177
    v_mul_f32 v224, v224, v177
    v_mul_f32 v225, v225, v177
    v_mul_f32 v226, v226, v177
    v_mul_f32 v227, v227, v177
    v_mul_f32 v228, v228, v177
    v_mul_f32 v229, v229, v177
    v_mul_f32 v230, v230, v177
    v_mul_f32 v231, v231, v177
    v_mul_f32 v232, v232, v177
    v_mul_f32 v233, v233, v177
    v_mul_f32 v234, v234, v177
    v_mul_f32 v235, v235, v177
    v_mul_f32 v236, v236, v177
    v_mul_f32 v237, v237, v177
    v_mul_f32 v238, v238, v177
    v_mul_f32 v239, v239, v177
    v_mul_f32 v240, v240, v177
    v_mul_f32 v241, v241, v177
    v_mul_f32 v242, v242, v177
    v_mul_f32 v243, v243, v177
    v_mul_f32 v244, v244, v177
    v_mul_f32 v245, v245, v177
    v_mul_f32 v246, v246, v177
    v_mul_f32 v247, v247, v177
    v_mul_f32 v248, v248, v177
    v_mul_f32 v249, v249, v177
    v_mul_f32 v250, v250, v177
    v_mul_f32 v251, v251, v177
    v_mul_f32 v252, v252, v177
    v_mul_f32 v253, v253, v177
    v_mul_f32 v254, v254, v177
    v_mul_f32 v255, v255, v177
    v_mul_f32 v12, v12, v177
    v_exp_f32 v176, v144
    v_exp_f32 v177, v145
    v_exp_f32 v178, v146
    v_add_f32 v13, v176, v177
    v_cvt_pk_bf16_f32 v168, v176, v177
    v_exp_f32 v179, v147
    v_add_f32 v13, v13, v178
    v_exp_f32 v180, v148
    v_add_f32 v13, v13, v179
    v_cvt_pk_bf16_f32 v169, v178, v179
    v_exp_f32 v181, v149
    v_add_f32 v13, v13, v180
    v_exp_f32 v182, v150
    v_add_f32 v13, v13, v181
    v_cvt_pk_bf16_f32 v170, v180, v181
    v_exp_f32 v183, v151
    v_add_f32 v13, v13, v182
    v_exp_f32 v176, v152
    v_add_f32 v13, v13, v183
    v_cvt_pk_bf16_f32 v171, v182, v183
    v_exp_f32 v177, v153
    v_add_f32 v13, v13, v176
    v_exp_f32 v178, v154
    v_add_f32 v13, v13, v177
    v_cvt_pk_bf16_f32 v172, v176, v177
    v_exp_f32 v179, v155
    v_add_f32 v13, v13, v178
    v_exp_f32 v180, v156
    v_add_f32 v13, v13, v179
    v_cvt_pk_bf16_f32 v173, v178, v179
    v_exp_f32 v181, v157
    v_add_f32 v13, v13, v180
    v_exp_f32 v182, v158
    v_add_f32 v13, v13, v181
    v_cvt_pk_bf16_f32 v174, v180, v181
    v_exp_f32 v183, v159
    v_add_f32 v13, v13, v182
    v_add_f32 v13, v13, v183
    v_cvt_pk_bf16_f32 v175, v182, v183
    s_nop 1
    s_branch L_back_T21
L_rare_T10:
    s_nop 15
    s_nop 7
    v_max3_f32 v176, v128, v129, v130
    v_max3_f32 v177, v131, v132, v133
    v_max3_f32 v176, v176, v134, v135
    v_max3_f32 v177, v177, v136, v137
    v_max3_f32 v176, v176, v138, v139
    v_max3_f32 v177, v177, v140, v141
    v_max3_f32 v176, v176, v142, v143
    v_max_f32 v176, v176, v177
    v_mov_b32 v177, v176
    s_nop 1
    v_permlane32_swap_b32 v176, v177
    s_nop 1
    v_max_f32 v176, v176, v177
    v_max_f32 v14, 0, v176
    v_sub_f32 v177, 0, v14
    v_exp_f32 v177, v177
    v_sub_f32 v128, v128, v14
    v_sub_f32 v16, v16, v14
    v_sub_f32 v129, v129, v14
    v_sub_f32 v17, v17, v14
    v_sub_f32 v130, v130, v14
    v_sub_f32 v18, v18, v14
    v_sub_f32 v131, v131, v14
    v_sub_f32 v19, v19, v14
    v_sub_f32 v132, v132, v14
    v_sub_f32 v20, v20, v14
    v_sub_f32 v133, v133, v14
    v_sub_f32 v21, v21, v14
    v_sub_f32 v134, v134, v14
    v_sub_f32 v22, v22, v14
    v_sub_f32 v135, v135, v14
    v_sub_f32 v23, v23, v14
    v_sub_f32 v136, v136, v14
    v_sub_f32 v24, v24, v14
    v_sub_f32 v137, v137, v14
    v_sub_f32 v25, v25, v14
    v_sub_f32 v138, v138, v14
    v_sub_f32 v26, v26, v14
    v_sub_f32 v139, v139, v14
    v_sub_f32 v27, v27, v14
    v_sub_f32 v140, v140, v14
    v_sub_f32 v28, v28, v14
    v_sub_f32 v141, v141, v14
    v_sub_f32 v29, v29, v14
    v_sub_f32 v142, v142, v14
    v_sub_f32 v30, v30, v14
    v_sub_f32 v143, v143, v14
    v_sub_f32 v31, v31, v14
    v_mul_f32 v192, v192, v177
    v_mul_f32 v193, v193, v177
    v_mul_f32 v194, v194, v177
    v_mul_f32 v195, v195, v177
    v_mul_f32 v196, v196, v177
    v_mul_f32 v197, v197, v177
    v_mul_f32 v198, v198, v177
    v_mul_f32 v199, v199, v177
    v_mul_f32 v200, v200, v177
    v_mul_f32 v201, v201, v177
    v_mul_f32 v202, v202, v177
    v_mul_f32 v203, v203, v177
    v_mul_f32 v204, v204, v177
    v_mul_f32 v205, v205, v177
    v_mul_f32 v206, v206, v177
    v_mul_f32 v207, v207, v177
    v_mul_f32 v208, v208, v177
    v_mul_f32 v209, v209, v177
    v_mul_f32 v210, v210, v177
    v_mul_f32 v211, v211, v177
    v_mul_f32 v212, v212, v177
    v_mul_f32 v213, v213, v177
    v_mul_f32 v214, v214, v177
    v_mul_f32 v215, v215, v177
    v_mul_f32 v216, v216, v177
    v_mul_f32 v217, v217, v177
    v_mul_f32 v218, v218, v177
    v_mul_f32 v219, v219, v177
    v_mul_f32 v220, v220, v177
    v_mul_f32 v221, v221, v177
    v_mul_f32 v222, v222, v177
    v_mul_f32 v223, v223, v177
    v_mul_f32 v224, v224, v177
    v_mul_f32 v225, v225, v177
    v_mul_f32 v226, v226, v177
    v_mul_f32 v227, v227, v177
    v_mul_f32 v228, v228, v177
    v_mul_f32 v229, v229, v177
    v_mul_f32 v230, v230, v177
    v_mul_f32 v231, v231, v177
    v_mul_f32 v232, v232, v177
    v_mul_f32 v233, v233, v177
    v_mul_f32 v234, v234, v177
    v_mul_f32 v235, v235, v177
    v_mul_f32 v236, v236, v177
    v_mul_f32 v237, v237, v177
    v_mul_f32 v238, v238, v177
    v_mul_f32 v239, v239, v177
    v_mul_f32 v240, v240, v177
    v_mul_f32 v241, v241, v177
    v_mul_f32 v242, v242, v177
    v_mul_f32 v243, v243, v177
    v_mul_f32 v244, v244, v177
    v_mul_f32 v245, v245, v177
    v_mul_f32 v246, v246, v177
    v_mul_f32 v247, v247, v177
    v_mul_f32 v248, v248, v177
    v_mul_f32 v249, v249, v177
    v_mul_f32 v250, v250, v177
    v_mul_f32 v251, v251, v177
    v_mul_f32 v252, v252, v177
    v_mul_f32 v253, v253, v177
    v_mul_f32 v254, v254, v177
    v_mul_f32 v255, v255, v177
    v_mul_f32 v12, v12, v177
    v_exp_f32 v176, v128
    v_exp_f32 v177, v129
    v_exp_f32 v178, v130
    v_add_f32 v13, v176, v177
    v_cvt_pk_bf16_f32 v160, v176, v177
    v_exp_f32 v179, v131
    v_add_f32 v13, v13, v178
    v_exp_f32 v180, v132
    v_add_f32 v13, v13, v179
    v_cvt_pk_bf16_f32 v161, v178, v179
    v_exp_f32 v181, v133
    v_add_f32 v13, v13, v180
    v_exp_f32 v182, v134
    v_add_f32 v13, v13, v181
    v_cvt_pk_bf16_f32 v162, v180, v181
    v_exp_f32 v183, v135
    v_add_f32 v13, v13, v182
    v_exp_f32 v176, v136
    v_add_f32 v13, v13, v183
    v_cvt_pk_bf16_f32 v163, v182, v183
    v_exp_f32 v177, v137
    v_add_f32 v13, v13, v176
    v_exp_f32 v178, v138
    v_add_f32 v13, v13, v177
    v_cvt_pk_bf16_f32 v164, v176, v177
    v_exp_f32 v179, v139
    v_add_f32 v13, v13, v178
    v_exp_f32 v180, v140
    v_add_f32 v13, v13, v179
    v_cvt_pk_bf16_f32 v165, v178, v179
    v_exp_f32 v181, v141
    v_add_f32 v13, v13, v180
    v_exp_f32 v182, v142
    v_add_f32 v13, v13, v181
    v_cvt_pk_bf16_f32 v166, v180, v181
    v_exp_f32 v183, v143
    v_add_f32 v13, v13, v182
    v_add_f32 v13, v13, v183
    v_cvt_pk_bf16_f32 v167, v182, v183
    s_nop 1
    s_branch L_back_T10
L_rare_T20:
    s_nop 15
    s_nop 7
    v_max3_f32 v176, v128, v129, v130
    v_max3_f32 v177, v131, v132, v133
    v_max3_f32 v176, v176, v134, v135
    v_max3_f32 v177, v177, v136, v137
    v_max3_f32 v176, v176, v138, v139
    v_max3_f32 v177, v177, v140, v141
    v_max3_f32 v176, v176, v142, v143
    v_max_f32 v176, v176, v177
    v_mov_b32 v177, v176
    s_nop 1
    v_permlane32_swap_b32 v176, v177
    s_nop 1
    v_max_f32 v176, v176, v177
    v_max_f32 v14, 0, v176
    v_sub_f32 v177, 0, v14
    v_exp_f32 v177, v177
    v_sub_f32 v128, v128, v14
    v_sub_f32 v16, v16, v14
    v_sub_f32 v129, v129, v14
    v_sub_f32 v17, v17, v14
    v_sub_f32 v130, v130, v14
    v_sub_f32 v18, v18, v14
    v_sub_f32 v131, v131, v14
    v_sub_f32 v19, v19, v14
    v_sub_f32 v132, v132, v14
    v_sub_f32 v20, v20, v14
    v_sub_f32 v133, v133, v14
    v_sub_f32 v21, v21, v14
    v_sub_f32 v134, v134, v14
    v_sub_f32 v22, v22, v14
    v_sub_f32 v135, v135, v14
    v_sub_f32 v23, v23, v14
    v_sub_f32 v136, v136, v14
    v_sub_f32 v24, v24, v14
    v_sub_f32 v137, v137, v14
    v_sub_f32 v25, v25, v14
    v_sub_f32 v138, v138, v14
    v_sub_f32 v26, v26, v14
    v_sub_f32 v139, v139, v14
    v_sub_f32 v27, v27, v14
    v_sub_f32 v140, v140, v14
    v_sub_f32 v28, v28, v14
    v_sub_f32 v141, v141, v14
    v_sub_f32 v29, v29, v14
    v_sub_f32 v142, v142, v14
    v_sub_f32 v30, v30, v14
    v_sub_f32 v143, v143, v14
    v_sub_f32 v31, v31, v14
    v_mul_f32 v192, v192, v177
    v_mul_f32 v193, v193, v177
    v_mul_f32 v194, v194, v177
    v_mul_f32 v195, v195, v177
    v_mul_f32 v196, v196, v177
    v_mul_f32 v197, v197, v177
    v_mul_f32 v198, v198, v177
    v_mul_f32 v199, v199, v177
    v_mul_f32 v200, v200, v177
    v_mul_f32 v201, v201, v177
    v_mul_f32 v202, v202, v177
    v_mul_f32 v203, v203, v177
    v_mul_f32 v204, v204, v177
    v_mul_f32 v205, v205, v177
    v_mul_f32 v206, v206, v177
    v_mul_f32 v207, v207, v177
    v_mul_f32 v208, v208, v177
    v_mul_f32 v209, v209, v177
    v_mul_f32 v210, v210, v177
    v_mul_f32 v211, v211, v177
    v_mul_f32 v212, v212, v177
    v_mul_f32 v213, v213, v177
    v_mul_f32 v214, v214, v177
    v_mul_f32 v215, v215, v177
    v_mul_f32 v216, v216, v177
    v_mul_f32 v217, v217, v177
    v_mul_f32 v218, v218, v177
    v_mul_f32 v219, v219, v177
    v_mul_f32 v220, v220, v177
    v_mul_f32 v221, v221, v177
    v_mul_f32 v222, v222, v177
    v_mul_f32 v223, v223, v177
    v_mul_f32 v224, v224, v177
    v_mul_f32 v225, v225, v177
    v_mul_f32 v226, v226, v177
    v_mul_f32 v227, v227, v177
    v_mul_f32 v228, v228, v177
    v_mul_f32 v229, v229, v177
    v_mul_f32 v230, v230, v177
    v_mul_f32 v231, v231, v177
    v_mul_f32 v232, v232, v177
    v_mul_f32 v233, v233, v177
    v_mul_f32 v234, v234, v177
    v_mul_f32 v235, v235, v177
    v_mul_f32 v236, v236, v177
    v_mul_f32 v237, v237, v177
    v_mul_f32 v238, v238, v177
    v_mul_f32 v239, v239, v177
    v_mul_f32 v240, v240, v177
    v_mul_f32 v241, v241, v177
    v_mul_f32 v242, v242, v177
    v_mul_f32 v243, v243, v177
    v_mul_f32 v244, v244, v177
    v_mul_f32 v245, v245, v177
    v_mul_f32 v246, v246, v177
    v_mul_f32 v247, v247, v177
    v_mul_f32 v248, v248, v177
    v_mul_f32 v249, v249, v177
    v_mul_f32 v250, v250, v177
    v_mul_f32 v251, v251, v177
    v_mul_f32 v252, v252, v177
    v_mul_f32 v253, v253, v177
    v_mul_f32 v254, v254, v177
    v_mul_f32 v255, v255, v177
    v_mul_f32 v12, v12, v177
    v_exp_f32 v176, v128
    v_exp_f32 v177, v129
    v_exp_f32 v178, v130
    v_add_f32 v13, v176, v177
    v_cvt_pk_bf16_f32 v160, v176, v177
    v_exp_f32 v179, v131
    v_add_f32 v13, v13, v178
    v_exp_f32 v180, v132
    v_add_f32 v13, v13, v179
    v_cvt_pk_bf16_f32 v161, v178, v179
    v_exp_f32 v181, v133
    v_add_f32 v13, v13, v180
    v_exp_f32 v182, v134
    v_add_f32 v13, v13, v181
    v_cvt_pk_bf16_f32 v162, v180, v181
    v_exp_f32 v183, v135
    v_add_f32 v13, v13, v182
    v_exp_f32 v176, v136
    v_add_f32 v13, v13, v183
    v_cvt_pk_bf16_f32 v163, v182, v183
    v_exp_f32 v177, v137
    v_add_f32 v13, v13, v176
    v_exp_f32 v178, v138
    v_add_f32 v13, v13, v177
    v_cvt_pk_bf16_f32 v164, v176, v177
    v_exp_f32 v179, v139
    v_add_f32 v13, v13, v178
    v_exp_f32 v180, v140
    v_add_f32 v13, v13, v179
    v_cvt_pk_bf16_f32 v165, v178, v179
    v_exp_f32 v181, v141
    v_add_f32 v13, v13, v180
    v_exp_f32 v182, v142
    v_add_f32 v13, v13, v181
    v_cvt_pk_bf16_f32 v166, v180, v181
    v_exp_f32 v183, v143
    v_add_f32 v13, v13, v182
    v_add_f32 v13, v13, v183
    v_cvt_pk_bf16_f32 v167, v182, v183
    s_nop 1
    s_branch L_back_T20
L_rare_Amd1:
    v_cmp_lt_f32 vcc, s3, v13
    s_cbranch_vccz L_spin_Amd1
    s_nop 15
    s_nop 7
    v_max3_f32 v176, v144, v145, v146
    v_max3_f32 v177, v147, v148, v149
    v_max3_f32 v176, v176, v150, v151
    v_max3_f32 v177, v177, v152, v153
    v_max3_f32 v176, v176, v154, v155
    v_max3_f32 v177, v177, v156, v157
    v_max3_f32 v176, v176, v158, v159
    v_max_f32 v176, v176, v177
    v_mov_b32 v177, v176
    s_nop 1
    v_permlane32_swap_b32 v176, v177
    s_nop 1
    v_max_f32 v176, v176, v177
    v_max_f32 v14, 0, v176
    v_sub_f32 v177, 0, v14
    v_exp_f32 v177, v177
    v_sub_f32 v144, v144, v14
    v_sub_f32 v128, v128, v14
    v_sub_f32 v16, v16, v14
    v_sub_f32 v145, v145, v14
    v_sub_f32 v129, v129, v14
    v_sub_f32 v17, v17, v14
    v_sub_f32 v146, v146, v14
    v_sub_f32 v130, v130, v14
    v_sub_f32 v18, v18, v14
    v_sub_f32 v147, v147, v14
    v_sub_f32 v131, v131, v14
    v_sub_f32 v19, v19, v14
    v_sub_f32 v148, v148, v14
    v_sub_f32 v132, v132, v14
    v_sub_f32 v20, v20, v14
    v_sub_f32 v149, v149, v14
    v_sub_f32 v133, v133, v14
    v_sub_f32 v21, v21, v14
    v_sub_f32 v150, v150, v14
    v_sub_f32 v134, v134, v14
    v_sub_f32 v22, v22, v14
    v_sub_f32 v151, v151, v14
    v_sub_f32 v135, v135, v14
    v_sub_f32 v23, v23, v14
    v_sub_f32 v152, v152, v14
    v_sub_f32 v136, v136, v14
    v_sub_f32 v24, v24, v14
    v_sub_f32 v153, v153, v14
    v_sub_f32 v137, v137, v14
    v_sub_f32 v25, v25, v14
    v_sub_f32 v154, v154, v14
    v_sub_f32 v138, v138, v14
    v_sub_f32 v26, v26, v14
    v_sub_f32 v155, v155, v14
    v_sub_f32 v139, v139, v14
    v_sub_f32 v27, v27, v14
    v_sub_f32 v156, v156, v14
    v_sub_f32 v140, v140, v14
    v_sub_f32 v28, v28, v14
    v_sub_f32 v157, v157, v14
    v_sub_f32 v141, v141, v14
    v_sub_f32 v29, v29, v14
    v_sub_f32 v158, v158, v14
    v_sub_f32 v142, v142, v14
    v_sub_f32 v30, v30, v14
    v_sub_f32 v159, v159, v14
    v_sub_f32 v143, v143, v14
    v_sub_f32 v31, v31, v14
    v_mul_f32 v192, v192, v177
    v_mul_f32 v193, v193, v177
    v_mul_f32 v194, v194, v177
    v_mul_f32 v195, v195, v177
    v_mul_f32 v196, v196, v177
    v_mul_f32 v197, v197, v177
    v_mul_f32 v198, v198, v177
    v_mul_f32 v199, v199, v177
    v_mul_f32 v200, v200, v177
    v_mul_f32 v201, v201, v177
    v_mul_f32 v202, v202, v177
    v_mul_f32 v203, v203, v177
    v_mul_f32 v204, v204, v177
    v_mul_f32 v205, v205, v177
    v_mul_f32 v206, v206, v177
    v_mul_f32 v207, v207, v177
    v_mul_f32 v208, v208, v177
    v_mul_f32 v209, v209, v177
    v_mul_f32 v210, v210, v177
    v_mul_f32 v211, v211, v177
    v_mul_f32 v212, v212, v177
    v_mul_f32 v213, v213, v177
    v_mul_f32 v214, v214, v177
    v_mul_f32 v215, v215, v177
    v_mul_f32 v216, v216, v177
    v_mul_f32 v217, v217, v177
    v_mul_f32 v218, v218, v177
    v_mul_f32 v219, v219, v177
    v_mul_f32 v220, v220, v177
    v_mul_f32 v221, v221, v177
    v_mul_f32 v222, v222, v177
    v_mul_f32 v223, v223, v177
    v_mul_f32 v224, v224, v177
    v_mul_f32 v225, v225, v177
    v_mul_f32 v226, v226, v177
    v_mul_f32 v227, v227, v177
    v_mul_f32 v228, v228, v177
    v_mul_f32 v229, v229, v177
    v_mul_f32 v230, v230, v177
    v_mul_f32 v231, v231, v177
    v_mul_f32 v232, v232, v177
    v_mul_f32 v233, v233, v177
    v_mul_f32 v234, v234, v177
    v_mul_f32 v235, v235, v177
    v_mul_f32 v236, v236, v177
    v_mul_f32 v237, v237, v177
    v_mul_f32 v238, v238, v177
    v_mul_f32 v239, v239, v177
    v_mul_f32 v240, v240, v177
    v_mul_f32 v241, v241, v177
    v_mul_f32 v242, v242, v177
    v_mul_f32 v243, v243, v177
    v_mul_f32 v244, v244, v177
    v_mul_f32 v245, v245, v177
    v_mul_f32 v246, v246, v177
    v_mul_f32 v247, v247, v177
    v_mul_f32 v248, v248, v177
    v_mul_f32 v249, v249, v177
    v_mul_f32 v250, v250, v177
    v_mul_f32 v251, v251, v177
    v_mul_f32 v252, v252, v177
    v_mul_f32 v253, v253, v177
    v_mul_f32 v254, v254, v177
    v_mul_f32 v255, v255, v177
    v_mul_f32 v12, v12, v177
    v_exp_f32 v176, v144
    v_exp_f32 v177, v145
    v_exp_f32 v178, v146
    v_add_f32 v13, v176, v177
    v_cvt_pk_bf16_f32 v168, v176, v177
    v_exp_f32 v179, v147
    v_add_f32 v13, v13, v178
    v_exp_f32 v180, v148
    v_add_f32 v13, v13, v179
    v_cvt_pk_bf16_f32 v169, v178, v179
    v_exp_f32 v181, v149
    v_add_f32 v13, v13, v180
    v_exp_f32 v182, v150
    v_add_f32 v13, v13, v181
    v_cvt_pk_bf16_f32 v170, v180, v181
    v_exp_f32 v183, v151
    v_add_f32 v13, v13, v182
    v_exp_f32 v176, v152
    v_add_f32 v13, v13, v183
    v_cvt_pk_bf16_f32 v171, v182, v183
    v_exp_f32 v177, v153
    v_add_f32 v13, v13, v176
    v_exp_f32 v178, v154
    v_add_f32 v13, v13, v177
    v_cvt_pk_bf16_f32 v172, v176, v177
    v_exp_f32 v179, v155
    v_add_f32 v13, v13, v178
    v_exp_f32 v180, v156
    v_add_f32 v13, v13, v179
    v_cvt_pk_bf16_f32 v173, v178, v179
    v_exp_f32 v181, v157
    v_add_f32 v13, v13, v180
    v_exp_f32 v182, v158
    v_add_f32 v13, v13, v181
    v_cvt_pk_bf16_f32 v174, v180, v181
    v_exp_f32 v183, v159
    v_add_f32 v13, v13, v182
    v_add_f32 v13, v13, v183
    v_cvt_pk_bf16_f32 v175, v182, v183
    s_nop 1
L_spin_Amd1:
    s_cselect_b32 s64, 1, 0
    s_sub_u32 s67, s67, 1
    s_cbranch_scc1 L_end
    s_cmp_lg_u32 s64, 0
    ds_read_b32 v3, v0 offset:3120
    s_waitcnt lgkmcnt(0)
    v_cmp_gt_f32 vcc, 0, v3
    s_cbranch_vccnz L_spin_Amd1
    s_branch L_back_Amd1
L_rare_Bmd2:
    v_cmp_lt_f32 vcc, s3, v13
    s_cbranch_vccz L_spin_Bmd2
    s_nop 15
    s_nop 7
    v_max3_f32 v176, v128, v129, v130
    v_max3_f32 v177, v131, v132, v133
    v_max3_f32 v176, v176, v134, v135
    v_max3_f32 v177, v177, v136, v137
    v_max3_f32 v176, v176, v138, v139
    v_max3_f32 v177, v177, v140, v141
    v_max3_f32 v176, v176, v142, v143
    v_max_f32 v176, v176, v177
    v_mov_b32 v177, v176
    s_nop 1
    v_permlane32_swap_b32 v176, v177
    s_nop 1
    v_max_f32 v176, v176, v177
    v_max_f32 v14, 0, v176
    v_sub_f32 v177, 0, v14
    v_exp_f32 v177, v177
    v_sub_f32 v128, v128, v14
    v_sub_f32 v144, v144, v14
    v_sub_f32 v16, v16, v14
    v_sub_f32 v129, v129, v14
    v_sub_f32 v145, v145, v14
    v_sub_f32 v17, v17, v14
    v_sub_f32 v130, v130, v14
    v_sub_f32 v146, v146, v14
    v_sub_f32 v18, v18, v14
    v_sub_f32 v131, v131, v14
    v_sub_f32 v147, v147, v14
    v_sub_f32 v19, v19, v14
    v_sub_f32 v132, v132, v14
    v_sub_f32 v148, v148, v14
    v_sub_f32 v20, v20, v14
    v_sub_f32 v133, v133, v14
    v_sub_f32 v149, v149, v14
    v_sub_f32 v21, v21, v14
    v_sub_f32 v134, v134, v14
    v_sub_f32 v150, v150, v14
    v_sub_f32 v22, v22, v14
    v_sub_f32 v135, v135, v14
    v_sub_f32 v151, v151, v14
    v_sub_f32 v23, v23, v14
    v_sub_f32 v136, v136, v14
    v_sub_f32 v152, v152, v14
    v_sub_f32 v24, v24, v14
    v_sub_f32 v137, v137, v14
    v_sub_f32 v153, v153, v14
    v_sub_f32 v25, v25, v14
    v_sub_f32 v138, v138, v14
    v_sub_f32 v154, v154, v14
    v_sub_f32 v26, v26, v14
    v_sub_f32 v139, v139, v14
    v_sub_f32 v155, v155, v14
    v_sub_f32 v27, v27, v14
    v_sub_f32 v140, v140, v14
    v_sub_f32 v156, v156, v14
    v_sub_f32 v28, v28, v14
    v_sub_f32 v141, v141, v14
    v_sub_f32 v157, v157, v14
    v_sub_f32 v29, v29, v14
    v_sub_f32 v142, v142, v14
    v_sub_f32 v158, v158, v14
    v_sub_f32 v30, v30, v14
    v_sub_f32 v143, v143, v14
    v_sub_f32 v159, v159, v14
    v_sub_f32 v31, v31, v14
    v_mul_f32 v192, v192, v177
    v_mul_f32 v193, v193, v177
    v_mul_f32 v194, v194, v177
    v_mul_f32 v195, v195, v177
    v_mul_f32 v196, v196, v177
    v_mul_f32 v197, v197, v177
    v_mul_f32 v198, v198, v177
    v_mul_f32 v199, v199, v177
    v_mul_f32 v200, v200, v177
    v_mul_f32 v201, v201, v177
    v_mul_f32 v202, v202, v177
    v_mul_f32 v203, v203, v177
    v_mul_f32 v204, v204, v177
    v_mul_f32 v205, v205, v177
    v_mul_f32 v206, v206, v177
    v_mul_f32 v207, v207, v177
    v_mul_f32 v208, v208, v177
    v_mul_f32 v209, v209, v177
    v_mul_f32 v210, v210, v177
    v_mul_f32 v211, v211, v177
    v_mul_f32 v212, v212, v177
    v_mul_f32 v213, v213, v177
    v_mul_f32 v214, v214, v177
    v_mul_f32 v215, v215, v177
    v_mul_f32 v216, v216, v177
    v_mul_f32 v217, v217, v177
    v_mul_f32 v218, v218, v177
    v_mul_f32 v219, v219, v177
    v_mul_f32 v220, v220, v177
    v_mul_f32 v221, v221, v177
    v_mul_f32 v222, v222, v177
    v_mul_f32 v223, v223, v177
    v_mul_f32 v224, v224, v177
    v_mul_f32 v225, v225, v177
    v_mul_f32 v226, v226, v177
    v_mul_f32 v227, v227, v177
    v_mul_f32 v228, v228, v177
    v_mul_f32 v229, v229, v177
    v_mul_f32 v230, v230, v177
    v_mul_f32 v231, v231, v177
    v_mul_f32 v232, v232, v177
    v_mul_f32 v233, v233, v177
    v_mul_f32 v234, v234, v177
    v_mul_f32 v235, v235, v177
    v_mul_f32 v236, v236, v177
    v_mul_f32 v237, v237, v177
    v_mul_f32 v238, v238, v177
    v_mul_f32 v239, v239, v177
    v_mul_f32 v240, v240, v177
    v_mul_f32 v241, v241, v177
    v_mul_f32 v242, v242, v177
    v_mul_f32 v243, v243, v177
    v_mul_f32 v244, v244, v177
    v_mul_f32 v245, v245, v177
    v_mul_f32 v246, v246, v177
    v_mul_f32 v247, v247, v177
    v_mul_f32 v248, v248, v177
    v_mul_f32 v249, v249, v177
    v_mul_f32 v250, v250, v177
    v_mul_f32 v251, v251, v177
    v_mul_f32 v252, v252, v177
    v_mul_f32 v253, v253, v177
    v_mul_f32 v254, v254, v177
    v_mul_f32 v255, v255, v177
    v_mul_f32 v12, v12, v177
    v_exp_f32 v176, v128
    v_exp_f32 v177, v129
    v_exp_f32 v178, v130
    v_add_f32 v13, v176, v177
    v_cvt_pk_bf16_f32 v160, v176, v177
    v_exp_f32 v179, v131
    v_add_f32 v13, v13, v178
    v_exp_f32 v180, v132
    v_add_f32 v13, v13, v179
    v_cvt_pk_bf16_f32 v161, v178, v179
    v_exp_f32 v181, v133
    v_add_f32 v13, v13, v180
    v_exp_f32 v182, v134
    v_add_f32 v13, v13, v181
    v_cvt_pk_bf16_f32 v162, v180, v181
    v_exp_f32 v183, v135
    v_add_f32 v13, v13, v182
    v_exp_f32 v176, v136
    v_add_f32 v13, v13, v183
    v_cvt_pk_bf16_f32 v163, v182, v183
    v_exp_f32 v177, v137
    v_add_f32 v13, v13, v176
    v_exp_f32 v178, v138
    v_add_f32 v13, v13, v177
    v_cvt_pk_bf16_f32 v164, v176, v177
    v_exp_f32 v179, v139
    v_add_f32 v13, v13, v178
    v_exp_f32 v180, v140
    v_add_f32 v13, v13, v179
    v_cvt_pk_bf16_f32 v165, v178, v179
    v_exp_f32 v181, v141
    v_add_f32 v13, v13, v180
    v_exp_f32 v182, v142
    v_add_f32 v13, v13, v181
    v_cvt_pk_bf16_f32 v166, v180, v181
    v_exp_f32 v183, v143
    v_add_f32 v13, v13, v182
    v_add_f32 v13, v13, v183
    v_cvt_pk_bf16_f32 v167, v182, v183
    s_nop 1
L_spin_Bmd2:
    s_cselect_b32 s64, 1, 0
    s_sub_u32 s67, s67, 1
    s_cbranch_scc1 L_end
    s_cmp_lg_u32 s64, 0
    ds_read_b32 v3, v0 offset:2080
    s_waitcnt lgkmcnt(0)
    v_cmp_gt_f32 vcc, 0, v3
    s_cbranch_vccnz L_spin_Bmd2
    s_branch L_back_Bmd2
L_rare_Amd3:
    v_cmp_lt_f32 vcc, s3, v13
    s_cbranch_vccz L_spin_Amd3
    s_nop 15
    s_nop 7
    v_max3_f32 v176, v144, v145, v146
    v_max3_f32 v177, v147, v148, v149
    v_max3_f32 v176, v176, v150, v151
    v_max3_f32 v177, v177, v152, v153
    v_max3_f32 v176, v176, v154, v155
    v_max3_f32 v177, v177, v156, v157
    v_max3_f32 v176, v176, v158, v159
    v_max_f32 v176, v176, v177
    v_mov_b32 v177, v176
    s_nop 1
    v_permlane32_swap_b32 v176, v177
    s_nop 1
    v_max_f32 v176, v176, v177
    v_max_f32 v14, 0, v176
    v_sub_f32 v177, 0, v14
    v_exp_f32 v177, v177
    v_sub_f32 v144, v144, v14
    v_sub_f32 v128, v128, v14
    v_sub_f32 v16, v16, v14
    v_sub_f32 v145, v145, v14
    v_sub_f32 v129, v129, v14
    v_sub_f32 v17, v17, v14
    v_sub_f32 v146, v146, v14
    v_sub_f32 v130, v130, v14
    v_sub_f32 v18, v18, v14
    v_sub_f32 v147, v147, v14
    v_sub_f32 v131, v131, v14
    v_sub_f32 v19, v19, v14
    v_sub_f32 v148, v148, v14
    v_sub_f32 v132, v132, v14
    v_sub_f32 v20, v20, v14
    v_sub_f32 v149, v149, v14
    v_sub_f32 v133, v133, v14
    v_sub_f32 v21, v21, v14
    v_sub_f32 v150, v150, v14
    v_sub_f32 v134, v134, v14
    v_sub_f32 v22, v22, v14
    v_sub_f32 v151, v151, v14
    v_sub_f32 v135, v135, v14
    v_sub_f32 v23, v23, v14
    v_sub_f32 v152, v152, v14
    v_sub_f32 v136, v136, v14
    v_sub_f32 v24, v24, v14
    v_sub_f32 v153, v153, v14
    v_sub_f32 v137, v137, v14
    v_sub_f32 v25, v25, v14
    v_sub_f32 v154, v154, v14
    v_sub_f32 v138, v138, v14
    v_sub_f32 v26, v26, v14
    v_sub_f32 v155, v155, v14
    v_sub_f32 v139, v139, v14
    v_sub_f32 v27, v27, v14
    v_sub_f32 v156, v156, v14
    v_sub_f32 v140, v140, v14
    v_sub_f32 v28, v28, v14
    v_sub_f32 v157, v157, v14
    v_sub_f32 v141, v141, v14
    v_sub_f32 v29, v29, v14
    v_sub_f32 v158, v158, v14
    v_sub_f32 v142, v142, v14
    v_sub_f32 v30, v30, v14
    v_sub_f32 v159, v159, v14
    v_sub_f32 v143, v143, v14
    v_sub_f32 v31, v31, v14
    v_mul_f32 v192, v192, v177
    v_mul_f32 v193, v193, v177
    v_mul_f32 v194, v194, v177
    v_mul_f32 v195, v195, v177
    v_mul_f32 v196, v196, v177
    v_mul_f32 v197, v197, v177
    v_mul_f32 v198, v198, v177
    v_mul_f32 v199, v199, v177
    v_mul_f32 v200, v200, v177
    v_mul_f32 v201, v201, v177
    v_mul_f32 v202, v202, v177
    v_mul_f32 v203, v203, v177
    v_mul_f32 v204, v204, v177
    v_mul_f32 v205, v205, v177
    v_mul_f32 v206, v206, v177
    v_mul_f32 v207, v207, v177
    v_mul_f32 v208, v208, v177
    v_mul_f32 v209, v209, v177
    v_mul_f32 v210, v210, v177
    v_mul_f32 v211, v211, v177
    v_mul_f32 v212, v212, v177
    v_mul_f32 v213, v213, v177
    v_mul_f32 v214, v214, v177
    v_mul_f32 v215, v215, v177
    v_mul_f32 v216, v216, v177
    v_mul_f32 v217, v217, v177
    v_mul_f32 v218, v218, v177
    v_mul_f32 v219, v219, v177
    v_mul_f32 v220, v220, v177
    v_mul_f32 v221, v221, v177
    v_mul_f32 v222, v222, v177
    v_mul_f32 v223, v223, v177
    v_mul_f32 v224, v224, v177
    v_mul_f32 v225, v225, v177
    v_mul_f32 v226, v226, v177
    v_mul_f32 v227, v227, v177
    v_mul_f32 v228, v228, v177
    v_mul_f32 v229, v229, v177
    v_mul_f32 v230, v230, v177
    v_mul_f32 v231, v231, v177
    v_mul_f32 v232, v232, v177
    v_mul_f32 v233, v233, v177
    v_mul_f32 v234, v234, v177
    v_mul_f32 v235, v235, v177
    v_mul_f32 v236, v236, v177
    v_mul_f32 v237, v237, v177
    v_mul_f32 v238, v238, v177
    v_mul_f32 v239, v239, v177
    v_mul_f32 v240, v240, v177
    v_mul_f32 v241, v241, v177
    v_mul_f32 v242, v242, v177
    v_mul_f32 v243, v243, v177
    v_mul_f32 v244, v244, v177
    v_mul_f32 v245, v245, v177
    v_mul_f32 v246, v246, v177
    v_mul_f32 v247, v247, v177
    v_mul_f32 v248, v248, v177
    v_mul_f32 v249, v249, v177
    v_mul_f32 v250, v250, v177
    v_mul_f32 v251, v251, v177
    v_mul_f32 v252, v252, v177
    v_mul_f32 v253, v253, v177
    v_mul_f32 v254, v254, v177
    v_mul_f32 v255, v255, v177
    v_mul_f32 v12, v12, v177
    v_exp_f32 v176, v144
    v_exp_f32 v177, v145
    v_exp_f32 v178, v146
    v_add_f32 v13, v176, v177
    v_cvt_pk_bf16_f32 v168, v176, v177
    v_exp_f32 v179, v147
    v_add_f32 v13, v13, v178
    v_exp_f32 v180, v148
    v_add_f32 v13, v13, v179
    v_cvt_pk_bf16_f32 v169, v178, v179
    v_exp_f32 v181, v149
    v_add_f32 v13, v13, v180
    v_exp_f32 v182, v150
    v_add_f32 v13, v13, v181
    v_cvt_pk_bf16_f32 v170, v180, v181
    v_exp_f32 v183, v151
    v_add_f32 v13, v13, v182
    v_exp_f32 v176, v152
    v_add_f32 v13, v13, v183
    v_cvt_pk_bf16_f32 v171, v182, v183
    v_exp_f32 v177, v153
    v_add_f32 v13, v13, v176
    v_exp_f32 v178, v154
    v_add_f32 v13, v13, v177
    v_cvt_pk_bf16_f32 v172, v176, v177
    v_exp_f32 v179, v155
    v_add_f32 v13, v13, v178
    v_exp_f32 v180, v156
    v_add_f32 v13, v13, v179
    v_cvt_pk_bf16_f32 v173, v178, v179
    v_exp_f32 v181, v157
    v_add_f32 v13, v13, v180
    v_exp_f32 v182, v158
    v_add_f32 v13, v13, v181
    v_cvt_pk_bf16_f32 v174, v180, v181
    v_exp_f32 v183, v159
    v_add_f32 v13, v13, v182
    v_add_f32 v13, v13, v183
    v_cvt_pk_bf16_f32 v175, v182, v183
    s_nop 1
L_spin_Amd3:
    s_cselect_b32 s64, 1, 0
    s_sub_u32 s67, s67, 1
    s_cbranch_scc1 L_end
    s_cmp_lg_u32 s64, 0
    ds_read_b32 v3, v0 offset:3120
    s_waitcnt lgkmcnt(0)
    v_cmp_gt_f32 vcc, 0, v3
    s_cbranch_vccnz L_spin_Amd3
    s_branch L_back_Amd3
L_rare_Bmd4:
    v_cmp_lt_f32 vcc, s3, v13
    s_cbranch_vccz L_spin_Bmd4
    s_nop 15
    s_nop 7
    v_max3_f32 v176, v128, v129, v130
    v_max3_f32 v177, v131, v132, v133
    v_max3_f32 v176, v176, v134, v135
    v_max3_f32 v177, v177, v136, v137
    v_max3_f32 v176, v176, v138, v139
    v_max3_f32 v177, v177, v140, v141
    v_max3_f32 v176, v176, v142, v143
    v_max_f32 v176, v176, v177
    v_mov_b32 v177, v176
    s_nop 1
    v_permlane32_swap_b32 v176, v177
    s_nop 1
    v_max_f32 v176, v176, v177
    v_max_f32 v14, 0, v176
    v_sub_f32 v177, 0, v14
    v_exp_f32 v177, v177
    v_sub_f32 v128, v128, v14
    v_sub_f32 v144, v144, v14
    v_sub_f32 v16, v16, v14
    v_sub_f32 v129, v129, v14
    v_sub_f32 v145, v145, v14
    v_sub_f32 v17, v17, v14
    v_sub_f32 v130, v130, v14
    v_sub_f32 v146, v146, v14
    v_sub_f32 v18, v18, v14
    v_sub_f32 v131, v131, v14
    v_sub_f32 v147, v147, v14
    v_sub_f32 v19, v19, v14
    v_sub_f32 v132, v132, v14
    v_sub_f32 v148, v148, v14
    v_sub_f32 v20, v20, v14
    v_sub_f32 v133, v133, v14
    v_sub_f32 v149, v149, v14
    v_sub_f32 v21, v21, v14
    v_sub_f32 v134, v134, v14
    v_sub_f32 v150, v150, v14
    v_sub_f32 v22, v22, v14
    v_sub_f32 v135, v135, v14
    v_sub_f32 v151, v151, v14
    v_sub_f32 v23, v23, v14
    v_sub_f32 v136, v136, v14
    v_sub_f32 v152, v152, v14
    v_sub_f32 v24, v24, v14
    v_sub_f32 v137, v137, v14
    v_sub_f32 v153, v153, v14
    v_sub_f32 v25, v25, v14
    v_sub_f32 v138, v138, v14
    v_sub_f32 v154, v154, v14
    v_sub_f32 v26, v26, v14
    v_sub_f32 v139, v139, v14
    v_sub_f32 v155, v155, v14
    v_sub_f32 v27, v27, v14
    v_sub_f32 v140, v140, v14
    v_sub_f32 v156, v156, v14
    v_sub_f32 v28, v28, v14
    v_sub_f32 v141, v141, v14
    v_sub_f32 v157, v157, v14
    v_sub_f32 v29, v29, v14
    v_sub_f32 v142, v142, v14
    v_sub_f32 v158, v158, v14
    v_sub_f32 v30, v30, v14
    v_sub_f32 v143, v143, v14
    v_sub_f32 v159, v159, v14
    v_sub_f32 v31, v31, v14
    v_mul_f32 v192, v192, v177
    v_mul_f32 v193, v193, v177
    v_mul_f32 v194, v194, v177
    v_mul_f32 v195, v195, v177
    v_mul_f32 v196, v196, v177
    v_mul_f32 v197, v197, v177
    v_mul_f32 v198, v198, v177
    v_mul_f32 v199, v199, v177
    v_mul_f32 v200, v200, v177
    v_mul_f32 v201, v201, v177
    v_mul_f32 v202, v202, v177
    v_mul_f32 v203, v203, v177
    v_mul_f32 v204, v204, v177
    v_mul_f32 v205, v205, v177
    v_mul_f32 v206, v206, v177
    v_mul_f32 v207, v207, v177
    v_mul_f32 v208, v208, v177
    v_mul_f32 v209, v209, v177
    v_mul_f32 v210, v210, v177
    v_mul_f32 v211, v211, v177
    v_mul_f32 v212, v212, v177
    v_mul_f32 v213, v213, v177
    v_mul_f32 v214, v214, v177
    v_mul_f32 v215, v215, v177
    v_mul_f32 v216, v216, v177
    v_mul_f32 v217, v217, v177
    v_mul_f32 v218, v218, v177
    v_mul_f32 v219, v219, v177
    v_mul_f32 v220, v220, v177
    v_mul_f32 v221, v221, v177
    v_mul_f32 v222, v222, v177
    v_mul_f32 v223, v223, v177
    v_mul_f32 v224, v224, v177
    v_mul_f32 v225, v225, v177
    v_mul_f32 v226, v226, v177
    v_mul_f32 v227, v227, v177
    v_mul_f32 v228, v228, v177
    v_mul_f32 v229, v229, v177
    v_mul_f32 v230, v230, v177
    v_mul_f32 v231, v231, v177
    v_mul_f32 v232, v232, v177
    v_mul_f32 v233, v233, v177
    v_mul_f32 v234, v234, v177
    v_mul_f32 v235, v235, v177
    v_mul_f32 v236, v236, v177
    v_mul_f32 v237, v237, v177
    v_mul_f32 v238, v238, v177
    v_mul_f32 v239, v239, v177
    v_mul_f32 v240, v240, v177
    v_mul_f32 v241, v241, v177
    v_mul_f32 v242, v242, v177
    v_mul_f32 v243, v243, v177
    v_mul_f32 v244, v244, v177
    v_mul_f32 v245, v245, v177
    v_mul_f32 v246, v246, v177
    v_mul_f32 v247, v247, v177
    v_mul_f32 v248, v248, v177
    v_mul_f32 v249, v249, v177
    v_mul_f32 v250, v250, v177
    v_mul_f32 v251, v251, v177
    v_mul_f32 v252, v252, v177
    v_mul_f32 v253, v253, v177
    v_mul_f32 v254, v254, v177
    v_mul_f32 v255, v255, v177
    v_mul_f32 v12, v12, v177
    v_exp_f32 v176, v128
    v_exp_f32 v177, v129
    v_exp_f32 v178, v130
    v_add_f32 v13, v176, v177
    v_cvt_pk_bf16_f32 v160, v176, v177
    v_exp_f32 v179, v131
    v_add_f32 v13, v13, v178
    v_exp_f32 v180, v132
    v_add_f32 v13, v13, v179
    v_cvt_pk_bf16_f32 v161, v178, v179
    v_exp_f32 v181, v133
    v_add_f32 v13, v13, v180
    v_exp_f32 v182, v134
    v_add_f32 v13, v13, v181
    v_cvt_pk_bf16_f32 v162, v180, v181
    v_exp_f32 v183, v135
    v_add_f32 v13, v13, v182
    v_exp_f32 v176, v136
    v_add_f32 v13, v13, v183
    v_cvt_pk_bf16_f32 v163, v182, v183
    v_exp_f32 v177, v137
    v_add_f32 v13, v13, v176
    v_exp_f32 v178, v138
    v_add_f32 v13, v13, v177
    v_cvt_pk_bf16_f32 v164, v176, v177
    v_exp_f32 v179, v139
    v_add_f32 v13, v13, v178
    v_exp_f32 v180, v140
    v_add_f32 v13, v13, v179
    v_cvt_pk_bf16_f32 v165, v178, v179
    v_exp_f32 v181, v141
    v_add_f32 v13, v13, v180
    v_exp_f32 v182, v142
    v_add_f32 v13, v13, v181
    v_cvt_pk_bf16_f32 v166, v180, v181
    v_exp_f32 v183, v143
    v_add_f32 v13, v13, v182
    v_add_f32 v13, v13, v183
    v_cvt_pk_bf16_f32 v167, v182, v183
    s_nop 1
L_spin_Bmd4:
    s_cselect_b32 s64, 1, 0
    s_sub_u32 s67, s67, 1
    s_cbranch_scc1 L_end
    s_cmp_lg_u32 s64, 0
    ds_read_b32 v3, v0 offset:2080
    s_waitcnt lgkmcnt(0)
    v_cmp_gt_f32 vcc, 0, v3
    s_cbranch_vccnz L_spin_Bmd4
    s_branch L_back_Bmd4
L_rare_Amd5:
    v_cmp_lt_f32 vcc, s3, v13
    s_cbranch_vccz L_spin_Amd5
    s_nop 15
    s_nop 7
    v_max3_f32 v176, v144, v145, v146
    v_max3_f32 v177, v147, v148, v149
    v_max3_f32 v176, v176, v150, v151
    v_max3_f32 v177, v177, v152, v153
    v_max3_f32 v176, v176, v154, v155
    v_max3_f32 v177, v177, v156, v157
    v_max3_f32 v176, v176, v158, v159
    v_max_f32 v176, v176, v177
    v_mov_b32 v177, v176
    s_nop 1
    v_permlane32_swap_b32 v176, v177
    s_nop 1
    v_max_f32 v176, v176, v177
    v_max_f32 v14, 0, v176
    v_sub_f32 v177, 0, v14
    v_exp_f32 v177, v177
    v_sub_f32 v144, v144, v14
    v_sub_f32 v128, v128, v14
    v_sub_f32 v16, v16, v14
    v_sub_f32 v145, v145, v14
    v_sub_f32 v129, v129, v14
    v_sub_f32 v17, v17, v14
    v_sub_f32 v146, v146, v14
    v_sub_f32 v130, v130, v14
    v_sub_f32 v18, v18, v14
    v_sub_f32 v147, v147, v14
    v_sub_f32 v131, v131, v14
    v_sub_f32 v19, v19, v14
    v_sub_f32 v148, v148, v14
    v_sub_f32 v132, v132, v14
    v_sub_f32 v20, v20, v14
    v_sub_f32 v149, v149, v14
    v_sub_f32 v133, v133, v14
    v_sub_f32 v21, v21, v14
    v_sub_f32 v150, v150, v14
    v_sub_f32 v134, v134, v14
    v_sub_f32 v22, v22, v14
    v_sub_f32 v151, v151, v14
    v_sub_f32 v135, v135, v14
    v_sub_f32 v23, v23, v14
    v_sub_f32 v152, v152, v14
    v_sub_f32 v136, v136, v14
    v_sub_f32 v24, v24, v14
    v_sub_f32 v153, v153, v14
    v_sub_f32 v137, v137, v14
    v_sub_f32 v25, v25, v14
    v_sub_f32 v154, v154, v14
    v_sub_f32 v138, v138, v14
    v_sub_f32 v26, v26, v14
    v_sub_f32 v155, v155, v14
    v_sub_f32 v139, v139, v14
    v_sub_f32 v27, v27, v14
    v_sub_f32 v156, v156, v14
    v_sub_f32 v140, v140, v14
    v_sub_f32 v28, v28, v14
    v_sub_f32 v157, v157, v14
    v_sub_f32 v141, v141, v14
    v_sub_f32 v29, v29, v14
    v_sub_f32 v158, v158, v14
    v_sub_f32 v142, v142, v14
    v_sub_f32 v30, v30, v14
    v_sub_f32 v159, v159, v14
    v_sub_f32 v143, v143, v14
    v_sub_f32 v31, v31, v14
    v_mul_f32 v192, v192, v177
    v_mul_f32 v193, v193, v177
    v_mul_f32 v194, v194, v177
    v_mul_f32 v195, v195, v177
    v_mul_f32 v196, v196, v177
    v_mul_f32 v197, v197, v177
    v_mul_f32 v198, v198, v177
    v_mul_f32 v199, v199, v177
    v_mul_f32 v200, v200, v177
    v_mul_f32 v201, v201, v177
    v_mul_f32 v202, v202, v177
    v_mul_f32 v203, v203, v177
    v_mul_f32 v204, v204, v177
    v_mul_f32 v205, v205, v177
    v_mul_f32 v206, v206, v177
    v_mul_f32 v207, v207, v177
    v_mul_f32 v208, v208, v177
    v_mul_f32 v209, v209, v177
    v_mul_f32 v210, v210, v177
    v_mul_f32 v211, v211, v177
    v_mul_f32 v212, v212, v177
    v_mul_f32 v213, v213, v177
    v_mul_f32 v214, v214, v177
    v_mul_f32 v215, v215, v177
    v_mul_f32 v216, v216, v177
    v_mul_f32 v217, v217, v177
    v_mul_f32 v218, v218, v177
    v_mul_f32 v219, v219, v177
    v_mul_f32 v220, v220, v177
    v_mul_f32 v221, v221, v177
    v_mul_f32 v222, v222, v177
    v_mul_f32 v223, v223, v177
    v_mul_f32 v224, v224, v177
    v_mul_f32 v225, v225, v177
    v_mul_f32 v226, v226, v177
    v_mul_f32 v227, v227, v177
    v_mul_f32 v228, v228, v177
    v_mul_f32 v229, v229, v177
    v_mul_f32 v230, v230, v177
    v_mul_f32 v231, v231, v177
    v_mul_f32 v232, v232, v177
    v_mul_f32 v233, v233, v177
    v_mul_f32 v234, v234, v177
    v_mul_f32 v235, v235, v177
    v_mul_f32 v236, v236, v177
    v_mul_f32 v237, v237, v177
    v_mul_f32 v238, v238, v177
    v_mul_f32 v239, v239, v177
    v_mul_f32 v240, v240, v177
    v_mul_f32 v241, v241, v177
    v_mul_f32 v242, v242, v177
    v_mul_f32 v243, v243, v177
    v_mul_f32 v244, v244, v177
    v_mul_f32 v245, v245, v177
    v_mul_f32 v246, v246, v177
    v_mul_f32 v247, v247, v177
    v_mul_f32 v248, v248, v177
    v_mul_f32 v249, v249, v177
    v_mul_f32 v250, v250, v177
    v_mul_f32 v251, v251, v177
    v_mul_f32 v252, v252, v177
    v_mul_f32 v253, v253, v177
    v_mul_f32 v254, v254, v177
    v_mul_f32 v255, v255, v177
    v_mul_f32 v12, v12, v177
    v_exp_f32 v176, v144
    v_exp_f32 v177, v145
    v_exp_f32 v178, v146
    v_add_f32 v13, v176, v177
    v_cvt_pk_bf16_f32 v168, v176, v177
    v_exp_f32 v179, v147
    v_add_f32 v13, v13, v178
    v_exp_f32 v180, v148
    v_add_f32 v13, v13, v179
    v_cvt_pk_bf16_f32 v169, v178, v179
    v_exp_f32 v181, v149
    v_add_f32 v13, v13, v180
    v_exp_f32 v182, v150
    v_add_f32 v13, v13, v181
    v_cvt_pk_bf16_f32 v170, v180, v181
    v_exp_f32 v183, v151
    v_add_f32 v13, v13, v182
    v_exp_f32 v176, v152
    v_add_f32 v13, v13, v183
    v_cvt_pk_bf16_f32 v171, v182, v183
    v_exp_f32 v177, v153
    v_add_f32 v13, v13, v176
    v_exp_f32 v178, v154
    v_add_f32 v13, v13, v177
    v_cvt_pk_bf16_f32 v172, v176, v177
    v_exp_f32 v179, v155
    v_add_f32 v13, v13, v178
    v_exp_f32 v180, v156
    v_add_f32 v13, v13, v179
    v_cvt_pk_bf16_f32 v173, v178, v179
    v_exp_f32 v181, v157
    v_add_f32 v13, v13, v180
    v_exp_f32 v182, v158
    v_add_f32 v13, v13, v181
    v_cvt_pk_bf16_f32 v174, v180, v181
    v_exp_f32 v183, v159
    v_add_f32 v13, v13, v182
    v_add_f32 v13, v13, v183
    v_cvt_pk_bf16_f32 v175, v182, v183
    s_nop 1
L_spin_Amd5:
    s_cselect_b32 s64, 1, 0
    s_sub_u32 s67, s67, 1
    s_cbranch_scc1 L_end
    s_cmp_lg_u32 s64, 0
    ds_read_b32 v3, v0 offset:3120
    s_waitcnt lgkmcnt(0)
    v_cmp_gt_f32 vcc, 0, v3
    s_cbranch_vccnz L_spin_Amd5
    s_branch L_back_Amd5
L_rare_Bmd6:
    v_cmp_lt_f32 vcc, s3, v13
    s_cbranch_vccz L_spin_Bmd6
    s_nop 15
    s_nop 7
    v_max3_f32 v176, v128, v129, v130
    v_max3_f32 v177, v131, v132, v133
    v_max3_f32 v176, v176, v134, v135
    v_max3_f32 v177, v177, v136, v137
    v_max3_f32 v176, v176, v138, v139
    v_max3_f32 v177, v177, v140, v141
    v_max3_f32 v176, v176, v142, v143
    v_max_f32 v176, v176, v177
    v_mov_b32 v177, v176
    s_nop 1
    v_permlane32_swap_b32 v176, v177
    s_nop 1
    v_max_f32 v176, v176, v177
    v_max_f32 v14, 0, v176
    v_sub_f32 v177, 0, v14
    v_exp_f32 v177, v177
    v_sub_f32 v128, v128, v14
    v_sub_f32 v144, v144, v14
    v_sub_f32 v16, v16, v14
    v_sub_f32 v129, v129, v14
    v_sub_f32 v145, v145, v14
    v_sub_f32 v17, v17, v14
    v_sub_f32 v130, v130, v14
    v_sub_f32 v146, v146, v14
    v_sub_f32 v18, v18, v14
    v_sub_f32 v131, v131, v14
    v_sub_f32 v147, v147, v14
    v_sub_f32 v19, v19, v14
    v_sub_f32 v132, v132, v14
    v_sub_f32 v148, v148, v14
    v_sub_f32 v20, v20, v14
    v_sub_f32 v133, v133, v14
    v_sub_f32 v149, v149, v14
    v_sub_f32 v21, v21, v14
    v_sub_f32 v134, v134, v14
    v_sub_f32 v150, v150, v14
    v_sub_f32 v22, v22, v14
    v_sub_f32 v135, v135, v14
    v_sub_f32 v151, v151, v14
    v_sub_f32 v23, v23, v14
    v_sub_f32 v136, v136, v14
    v_sub_f32 v152, v152, v14
    v_sub_f32 v24, v24, v14
    v_sub_f32 v137, v137, v14
    v_sub_f32 v153, v153, v14
    v_sub_f32 v25, v25, v14
    v_sub_f32 v138, v138, v14
    v_sub_f32 v154, v154, v14
    v_sub_f32 v26, v26, v14
    v_sub_f32 v139, v139, v14
    v_sub_f32 v155, v155, v14
    v_sub_f32 v27, v27, v14
    v_sub_f32 v140, v140, v14
    v_sub_f32 v156, v156, v14
    v_sub_f32 v28, v28, v14
    v_sub_f32 v141, v141, v14
    v_sub_f32 v157, v157, v14
    v_sub_f32 v29, v29, v14
    v_sub_f32 v142, v142, v14
    v_sub_f32 v158, v158, v14
    v_sub_f32 v30, v30, v14
    v_sub_f32 v143, v143, v14
    v_sub_f32 v159, v159, v14
    v_sub_f32 v31, v31, v14
    v_mul_f32 v192, v192, v177
    v_mul_f32 v193, v193, v177
    v_mul_f32 v194, v194, v177
    v_mul_f32 v195, v195, v177
    v_mul_f32 v196, v196, v177
    v_mul_f32 v197, v197, v177
    v_mul_f32 v198, v198, v177
    v_mul_f32 v199, v199, v177
    v_mul_f32 v200, v200, v177
    v_mul_f32 v201, v201, v177
    v_mul_f32 v202, v202, v177
    v_mul_f32 v203, v203, v177
    v_mul_f32 v204, v204, v177
    v_mul_f32 v205, v205, v177
    v_mul_f32 v206, v206, v177
    v_mul_f32 v207, v207, v177
    v_mul_f32 v208, v208, v177
    v_mul_f32 v209, v209, v177
    v_mul_f32 v210, v210, v177
    v_mul_f32 v211, v211, v177
    v_mul_f32 v212, v212, v177
    v_mul_f32 v213, v213, v177
    v_mul_f32 v214, v214, v177
    v_mul_f32 v215, v215, v177
    v_mul_f32 v216, v216, v177
    v_mul_f32 v217, v217, v177
    v_mul_f32 v218, v218, v177
    v_mul_f32 v219, v219, v177
    v_mul_f32 v220, v220, v177
    v_mul_f32 v221, v221, v177
    v_mul_f32 v222, v222, v177
    v_mul_f32 v223, v223, v177
    v_mul_f32 v224, v224, v177
    v_mul_f32 v225, v225, v177
    v_mul_f32 v226, v226, v177
    v_mul_f32 v227, v227, v177
    v_mul_f32 v228, v228, v177
    v_mul_f32 v229, v229, v177
    v_mul_f32 v230, v230, v177
    v_mul_f32 v231, v231, v177
    v_mul_f32 v232, v232, v177
    v_mul_f32 v233, v233, v177
    v_mul_f32 v234, v234, v177
    v_mul_f32 v235, v235, v177
    v_mul_f32 v236, v236, v177
    v_mul_f32 v237, v237, v177
    v_mul_f32 v238, v238, v177
    v_mul_f32 v239, v239, v177
    v_mul_f32 v240, v240, v177
    v_mul_f32 v241, v241, v177
    v_mul_f32 v242, v242, v177
    v_mul_f32 v243, v243, v177
    v_mul_f32 v244, v244, v177
    v_mul_f32 v245, v245, v177
    v_mul_f32 v246, v246, v177
    v_mul_f32 v247, v247, v177
    v_mul_f32 v248, v248, v177
    v_mul_f32 v249, v249, v177
    v_mul_f32 v250, v250, v177
    v_mul_f32 v251, v251, v177
    v_mul_f32 v252, v252, v177
    v_mul_f32 v253, v253, v177
    v_mul_f32 v254, v254, v177
    v_mul_f32 v255, v255, v177
    v_mul_f32 v12, v12, v177
    v_exp_f32 v176, v128
    v_exp_f32 v177, v129
    v_exp_f32 v178, v130
    v_add_f32 v13, v176, v177
    v_cvt_pk_bf16_f32 v160, v176, v177
    v_exp_f32 v179, v131
    v_add_f32 v13, v13, v178
    v_exp_f32 v180, v132
    v_add_f32 v13, v13, v179
    v_cvt_pk_bf16_f32 v161, v178, v179
    v_exp_f32 v181, v133
    v_add_f32 v13, v13, v180
    v_exp_f32 v182, v134
    v_add_f32 v13, v13, v181
    v_cvt_pk_bf16_f32 v162, v180, v181
    v_exp_f32 v183, v135
    v_add_f32 v13, v13, v182
    v_exp_f32 v176, v136
    v_add_f32 v13, v13, v183
    v_cvt_pk_bf16_f32 v163, v182, v183
    v_exp_f32 v177, v137
    v_add_f32 v13, v13, v176
    v_exp_f32 v178, v138
    v_add_f32 v13, v13, v177
    v_cvt_pk_bf16_f32 v164, v176, v177
    v_exp_f32 v179, v139
    v_add_f32 v13, v13, v178
    v_exp_f32 v180, v140
    v_add_f32 v13, v13, v179
    v_cvt_pk_bf16_f32 v165, v178, v179
    v_exp_f32 v181, v141
    v_add_f32 v13, v13, v180
    v_exp_f32 v182, v142
    v_add_f32 v13, v13, v181
    v_cvt_pk_bf16_f32 v166, v180, v181
    v_exp_f32 v183, v143
    v_add_f32 v13, v13, v182
    v_add_f32 v13, v13, v183
    v_cvt_pk_bf16_f32 v167, v182, v183
    s_nop 1
L_spin_Bmd6:
    s_cselect_b32 s64, 1, 0
    s_sub_u32 s67, s67, 1
    s_cbranch_scc1 L_end
    s_cmp_lg_u32 s64, 0
    ds_read_b32 v3, v0 offset:2080
    s_waitcnt lgkmcnt(0)
    v_cmp_gt_f32 vcc, 0, v3
    s_cbranch_vccnz L_spin_Bmd6
    s_branch L_back_Bmd6
L_rare_T01:
    v_mfma_f32_32x32x16_bf16 v[224:239], v[104:107], v[160:163], v[224:239]
    v_mfma_f32_32x32x16_bf16 v[224:239], v[120:123], v[164:167], v[224:239]
    v_mfma_f32_32x32x16_bf16 v[240:255], v[108:111], v[160:163], v[240:255]
    v_mfma_f32_32x32x16_bf16 v[240:255], v[124:127], v[164:167], v[240:255]
L_rare_T01x:
    s_nop 15
    s_nop 7
    v_max3_f32 v176, v144, v145, v146
    v_max_f32 v176, v176, v147
    v_mov_b32 v177, v176
    s_nop 1
    v_permlane32_swap_b32 v176, v177
    s_nop 1
    v_max_f32 v176, v176, v177
    v_max_f32 v14, 0, v176
    v_sub_f32 v177, 0, v14
    v_exp_f32 v177, v177
    v_sub_f32 v144, v144, v14
    v_sub_f32 v16, v16, v14
    v_sub_f32 v145, v145, v14
    v_sub_f32 v17, v17, v14
    v_sub_f32 v146, v146, v14
    v_sub_f32 v18, v18, v14
    v_sub_f32 v147, v147, v14
    v_sub_f32 v19, v19, v14
    v_sub_f32 v148, v148, v14
    v_sub_f32 v20, v20, v14
    v_sub_f32 v149, v149, v14
    v_sub_f32 v21, v21, v14
    v_sub_f32 v150, v150, v14
    v_sub_f32 v22, v22, v14
    v_sub_f32 v151, v151, v14
    v_sub_f32 v23, v23, v14
    v_sub_f32 v152, v152, v14
    v_sub_f32 v24, v24, v14
    v_sub_f32 v153, v153, v14
    v_sub_f32 v25, v25, v14
    v_sub_f32 v154, v154, v14
    v_sub_f32 v26, v26, v14
    v_sub_f32 v155, v155, v14
    v_sub_f32 v27, v27, v14
    v_sub_f32 v156, v156, v14
    v_sub_f32 v28, v28, v14
    v_sub_f32 v157, v157, v14
    v_sub_f32 v29, v29, v14
    v_sub_f32 v158, v158, v14
    v_sub_f32 v30, v30, v14
    v_sub_f32 v159, v159, v14
    v_sub_f32 v31, v31, v14
    v_mul_f32 v192, v192, v177
    v_mul_f32 v193, v193, v177
    v_mul_f32 v194, v194, v177
    v_mul_f32 v195, v195, v177
    v_mul_f32 v196, v196, v177
    v_mul_f32 v197, v197, v177
    v_mul_f32 v198, v198, v177
    v_mul_f32 v199, v199, v177
    v_mul_f32 v200, v200, v177
    v_mul_f32 v201, v201, v177
    v_mul_f32 v202, v202, v177
    v_mul_f32 v203, v203, v177
    v_mul_f32 v204, v204, v177
    v_mul_f32 v205, v205, v177
    v_mul_f32 v206, v206, v177
    v_mul_f32 v207, v207, v177
    v_mul_f32 v208, v208, v177
    v_mul_f32 v209, v209, v177
    v_mul_f32 v210, v210, v177
    v_mul_f32 v211, v211, v177
    v_mul_f32 v212, v212, v177
    v_mul_f32 v213, v213, v177
    v_mul_f32 v214, v214, v177
    v_mul_f32 v215, v215, v177
    v_mul_f32 v216, v216, v177
    v_mul_f32 v217, v217, v177
    v_mul_f32 v218, v218, v177
    v_mul_f32 v219, v219, v177
    v_mul_f32 v220, v220, v177
    v_mul_f32 v221, v221, v177
    v_mul_f32 v222, v222, v177
    v_mul_f32 v223, v223, v177
    v_mul_f32 v224, v224, v177
    v_mul_f32 v225, v225, v177
    v_mul_f32 v226, v226, v177
    v_mul_f32 v227, v227, v177
    v_mul_f32 v228, v228, v177
    v_mul_f32 v229, v229, v177
    v_mul_f32 v230, v230, v177
    v_mul_f32 v231, v231, v177
    v_mul_f32 v232, v232, v177
    v_mul_f32 v233, v233, v177
    v_mul_f32 v234, v234, v177
    v_mul_f32 v235, v235, v177
    v_mul_f32 v236, v236, v177
    v_mul_f32 v237, v237, v177
    v_mul_f32 v238, v238, v177
    v_mul_f32 v239, v239, v177
    v_mul_f32 v240, v240, v177
    v_mul_f32 v241, v241, v177
    v_mul_f32 v242, v242, v177
    v_mul_f32 v243, v243, v177
    v_mul_f32 v244, v244, v177
    v_mul_f32 v245, v245, v177
    v_mul_f32 v246, v246, v177
    v_mul_f32 v247, v247, v177
    v_mul_f32 v248, v248, v177
    v_mul_f32 v249, v249, v177
    v_mul_f32 v250, v250, v177
    v_mul_f32 v251, v251, v177
    v_mul_f32 v252, v252, v177
    v_mul_f32 v253, v253, v177
    v_mul_f32 v254, v254, v177
    v_mul_f32 v255, v255, v177
    v_mul_f32 v12, v12, v177
    v_exp_f32 v176, v144
    v_exp_f32 v177, v145
    v_exp_f32 v178, v146
    v_add_f32 v13, v176, v177
    v_cvt_pk_bf16_f32 v168, v176, v177
    v_exp_f32 v179, v147
    v_add_f32 v13, v13, v178
    v_add_f32 v13, v13, v179
    v_cvt_pk_bf16_f32 v169, v178, v179
    s_nop 1
    s_branch L_back_T01x
L_back_T01x:
    s_waitcnt lgkmcnt(0)
    v_mfma_f32_32x32x16_bf16 v[192:207], v[64:67], v[168:171], v[192:207]
    v_mfma_f32_32x32x16_bf16 v[208:223], v[68:71], v[168:171], v[208:223]
    v_mfma_f32_32x32x16_bf16 v[224:239], v[72:75], v[168:171], v[224:239]
    v_mfma_f32_32x32x16_bf16 v[240:255], v[76:79], v[168:171], v[240:255]
    v_add_f32 v12, v12, v13
    v_mov_b32 v14, v12
L_stg_T01x:
    s_cselect_b32 s64, 1, 0
    s_sub_u32 s67, s67, 1
    s_cbranch_scc1 L_end
    s_cmp_lg_u32 s64, 0
    ds_read_b32 v3, v190
    s_waitcnt lgkmcnt(0)
    v_cmp_gt_i32 vcc, s15, v3
    s_cbranch_vccnz L_stg_T01x
    v_permlane32_swap_b32 v12, v14
    s_nop 1
    v_add_f32 v12, v12, v14
    s_branch L_store
L_rare_T00:
    v_mfma_f32_32x32x16_bf16 v[224:239], v[104:107], v[168:171], v[224:239]
    v_mfma_f32_32x32x16_bf16 v[224:239], v[120:123], v[172:175], v[224:239]
    v_mfma_f32_32x32x16_bf16 v[240:255], v[108:111], v[168:171], v[240:255]
    v_mfma_f32_32x32x16_bf16 v[240:255], v[124:127], v[172:175], v[240:255]
L_rare_T00x:
    s_nop 15
    s_nop 7
    v_max3_f32 v176, v128, v129, v130
    v_max_f32 v176, v176, v131
    v_mov_b32 v177, v176
    s_nop 1
    v_permlane32_swap_b32 v176, v177
    s_nop 1
    v_max_f32 v176, v176, v177
    v_max_f32 v14, 0, v176
    v_sub_f32 v177, 0, v14
    v_exp_f32 v177, v177
    v_sub_f32 v128, v128, v14
    v_sub_f32 v16, v16, v14
    v_sub_f32 v129, v129, v14
    v_sub_f32 v17, v17, v14
    v_sub_f32 v130, v130, v14
    v_sub_f32 v18, v18, v14
    v_sub_f32 v131, v131, v14
    v_sub_f32 v19, v19, v14
    v_sub_f32 v132, v132, v14
    v_sub_f32 v20, v20, v14
    v_sub_f32 v133, v133, v14
    v_sub_f32 v21, v21, v14
    v_sub_f32 v134, v134, v14
    v_sub_f32 v22, v22, v14
    v_sub_f32 v135, v135, v14
    v_sub_f32 v23, v23, v14
    v_sub_f32 v136, v136, v14
    v_sub_f32 v24, v24, v14
    v_sub_f32 v137, v137, v14
    v_sub_f32 v25, v25, v14
    v_sub_f32 v138, v138, v14
    v_sub_f32 v26, v26, v14
    v_sub_f32 v139, v139, v14
    v_sub_f32 v27, v27, v14
    v_sub_f32 v140, v140, v14
    v_sub_f32 v28, v28, v14
    v_sub_f32 v141, v141, v14
    v_sub_f32 v29, v29, v14
    v_sub_f32 v142, v142, v14
    v_sub_f32 v30, v30, v14
    v_sub_f32 v143, v143, v14
    v_sub_f32 v31, v31, v14
    v_mul_f32 v192, v192, v177
    v_mul_f32 v193, v193, v177
    v_mul_f32 v194, v194, v177
    v_mul_f32 v195, v195, v177
    v_mul_f32 v196, v196, v177
    v_mul_f32 v197, v197, v177
    v_mul_f32 v198, v198, v177
    v_mul_f32 v199, v199, v177
    v_mul_f32 v200, v200, v177
    v_mul_f32 v201, v201, v177
    v_mul_f32 v202, v202, v177
    v_mul_f32 v203, v203, v177
    v_mul_f32 v204, v204, v177
    v_mul_f32 v205, v205, v177
    v_mul_f32 v206, v206, v177
    v_mul_f32 v207, v207, v177
    v_mul_f32 v208, v208, v177
    v_mul_f32 v209, v209, v177
    v_mul_f32 v210, v210, v177
    v_mul_f32 v211, v211, v177
    v_mul_f32 v212, v212, v177
    v_mul_f32 v213, v213, v177
    v_mul_f32 v214, v214, v177
    v_mul_f32 v215, v215, v177
    v_mul_f32 v216, v216, v177
    v_mul_f32 v217, v217, v177
    v_mul_f32 v218, v218, v177
    v_mul_f32 v219, v219, v177
    v_mul_f32 v220, v220, v177
    v_mul_f32 v221, v221, v177
    v_mul_f32 v222, v222, v177
    v_mul_f32 v223, v223, v177
    v_mul_f32 v224, v224, v177
    v_mul_f32 v225, v225, v177
    v_mul_f32 v226, v226, v177
    v_mul_f32 v227, v227, v177
    v_mul_f32 v228, v228, v177
    v_mul_f32 v229, v229, v177
    v_mul_f32 v230, v230, v177
    v_mul_f32 v231, v231, v177
    v_mul_f32 v232, v232, v177
    v_mul_f32 v233, v233, v177
    v_mul_f32 v234, v234, v177
    v_mul_f32 v235, v235, v177
    v_mul_f32 v236, v236, v177
    v_mul_f32 v237, v237, v177
    v_mul_f32 v238, v238, v177
    v_mul_f32 v239, v239, v177
    v_mul_f32 v240, v240, v177
    v_mul_f32 v241, v241, v177
    v_mul_f32 v242, v242, v177
    v_mul_f32 v243, v243, v177
    v_mul_f32 v244, v244, v177
    v_mul_f32 v245, v245, v177
    v_mul_f32 v246, v246, v177
    v_mul_f32 v247, v247, v177
    v_mul_f32 v248, v248, v177
    v_mul_f32 v249, v249, v177
    v_mul_f32 v250, v250, v177
    v_mul_f32 v251, v251, v177
    v_mul_f32 v252, v252, v177
    v_mul_f32 v253, v253, v177
    v_mul_f32 v254, v254, v177
    v_mul_f32 v255, v255, v177
    v_mul_f32 v12, v12, v177
    v_exp_f32 v176, v128
    v_exp_f32 v177, v129
    v_exp_f32 v178, v130
    v_add_f32 v13, v176, v177
    v_cvt_pk_bf16_f32 v160, v176, v177
    v_exp_f32 v179, v131
    v_add_f32 v13, v13, v178
    v_add_f32 v13, v13, v179
    v_cvt_pk_bf16_f32 v161, v178, v179
    s_nop 1
    s_branch L_back_T00x
L_back_T00x:
    s_waitcnt lgkmcnt(0)
    v_mfma_f32_32x32x16_bf16 v[192:207], v[64:67], v[160:163], v[192:207]
    v_mfma_f32_32x32x16_bf16 v[208:223], v[68:71], v[160:163], v[208:223]
    v_mfma_f32_32x32x16_bf16 v[224:239], v[72:75], v[160:163], v[224:239]
    v_mfma_f32_32x32x16_bf16 v[240:255], v[76:79], v[160:163], v[240:255]
    v_add_f32 v12, v12, v13
    v_mov_b32 v14, v12
L_stg_T00x:
    s_cselect_b32 s64, 1, 0
    s_sub_u32 s67, s67, 1
    s_cbranch_scc1 L_end
    s_cmp_lg_u32 s64, 0
    ds_read_b32 v3, v190
    s_waitcnt lgkmcnt(0)
    v_cmp_gt_i32 vcc, s15, v3
    s_cbranch_vccnz L_stg_T00x
    v_permlane32_swap_b32 v12, v14
    s_nop 1
    v_add_f32 v12, v12, v14
    s_branch L_store
L_end:
    s_endpgm
.p2align 6
.type L_table,@object
L_table:
    .long 0x121000, 0xe6100, 0x14400, 0x61a80, 0x200000, 0x0, 0x1e280, 0x14000, 0x0, 0x14400, 0x8, 0x7, 0x24400, 0x0, 0x0, 0x0
    .long 0x121000, 0xe6100, 0x14400, 0x61a80, 0x200900, 0x20000, 0x20300, 0x14000, 0x0, 0x14400, 0x8, 0x7, 0x25400, 0x0, 0x0, 0x0
    .long 0x121000, 0xe6100, 0x14400, 0x61a80, 0x201200, 0x40000, 0x22380, 0x14000, 0x0, 0x14400, 0x8, 0x7, 0x26400, 0x0, 0x0, 0x0
    .long 0x121000, 0xe6100, 0x14400, 0x61a80, 0x203800, 0x60000, 0x24400, 0x14000, 0x0, 0x14400, 0x8, 0x7, 0x0, 0x0, 0x0, 0x0
    .long 0x121000, 0xe6100, 0x14400, 0x61a80, 0x312403, 0x80000, 0xbe00, 0x14000, 0x0, 0x14400, 0x8, 0x7, 0x10000, 0x0, 0x0, 0x0
    .long 0x121000, 0xe6100, 0x14400, 0x61a80, 0x312d03, 0xa0000, 0xde80, 0x14000, 0x0, 0x14400, 0x8, 0x7, 0x11000, 0x0, 0x0, 0x0
    .long 0x121000, 0xe6100, 0x14400, 0x61a80, 0x313603, 0xc0000, 0xff00, 0x14000, 0x0, 0x14400, 0x8, 0x7, 0x12000, 0x0, 0x0, 0x0
    .long 0x121000, 0xe6100, 0x14400, 0x61a80, 0x313f03, 0xe0000, 0x11f80, 0x14000, 0x0, 0x14400, 0x8, 0x7, 0x13000, 0x0, 0x0, 0x0
    .long 0x208000, 0x1a2100, 0x14400, 0x61a80, 0x200080, 0x0, 0xbe00, 0x14000, 0x0, 0x14400, 0xe, 0x3, 0x12000, 0x0, 0x0, 0x0
    .long 0x208000, 0x1a2100, 0x14400, 0x61a80, 0x200980, 0x20000, 0xde80, 0x14000, 0x0, 0x14400, 0xe, 0x3, 0x13000, 0x0, 0x0, 0x0
    .long 0x208000, 0x1a2100, 0x14400, 0x61a80, 0x201280, 0x40000, 0xff00, 0x14000, 0x0, 0x14400, 0xe, 0x3, 0x24400, 0x0, 0x0, 0x0
    .long 0x208000, 0x1a2100, 0x14400, 0x61a80, 0x201b80, 0x60000, 0x11f80, 0x14000, 0x0, 0x14400, 0xe, 0x3, 0x25400, 0x0, 0x0, 0x0
    .long 0x208000, 0x1a2100, 0x14400, 0x61a80, 0x200084, 0x0, 0x0, 0x14000, 0x0, 0x14400, 0xe, 0x3, 0x0, 0x0, 0x0, 0x0
    .long 0x208000, 0x1a2100, 0x14400, 0x61a80, 0x200084, 0x0, 0x0, 0x14000, 0x0, 0x14400, 0xe, 0x3, 0x0, 0x0, 0x0, 0x0
    .long 0x208000, 0x1a2100, 0x14400, 0x61a80, 0x200084, 0x0, 0x0, 0x14000, 0x0, 0x14400, 0xe, 0x3, 0x0, 0x0, 0x0, 0x0
    .long 0x208000, 0x1a2100, 0x14400, 0x61a80, 0x200084, 0x0, 0x0, 0x14000, 0x0, 0x14400, 0xe, 0x3, 0x0, 0x0, 0x0, 0x0
    .long 0x208000, 0x1a2100, 0x14400, 0x61a80, 0x200080, 0x80000, 0xbe00, 0x14000, 0x0, 0x14400, 0xe, 0x3, 0x12000, 0x0, 0x0, 0x0
    .long 0x208000, 0x1a2100, 0x14400, 0x61a80, 0x200980, 0xa0000, 0xde80, 0x14000, 0x0, 0x14400, 0xe, 0x3, 0x13000, 0x0, 0x0, 0x0
    .long 0x208000, 0x1a2100, 0x14400, 0x61a80, 0x201280, 0xc0000, 0xff00, 0x14000, 0x0, 0x14400, 0xe, 0x3, 0x24400, 0x0, 0x0, 0x0
    .long 0x208000, 0x1a2100, 0x14400, 0x61a80, 0x201b80, 0xe0000, 0x11f80, 0x14000, 0x0, 0x14400, 0xe, 0x3, 0x25400, 0x0, 0x0, 0x0
    .long 0x208000, 0x1a2100, 0x14400, 0x61a80, 0x200084, 0x0, 0x0, 0x14000, 0x0, 0x14400, 0xe, 0x3, 0x0, 0x0, 0x0, 0x0
    .long 0x208000, 0x1a2100, 0x14400, 0x61a80, 0x200084, 0x0, 0x0, 0x14000, 0x0, 0x14400, 0xe, 0x3, 0x0, 0x0, 0x0, 0x0
    .long 0x208000, 0x1a2100, 0x14400, 0x61a80, 0x200084, 0x0, 0x0, 0x14000, 0x0, 0x14400, 0xe, 0x3, 0x0, 0x0, 0x0, 0x0
    .long 0x208000, 0x1a2100, 0x14400, 0x61a80, 0x200084, 0x0, 0x0, 0x14000, 0x0, 0x14400, 0xe, 0x3, 0x0, 0x0, 0x0, 0x0
    .long 0x208000, 0x1a2100, 0x14400, 0x61a80, 0x200080, 0x100000, 0xbe00, 0x14000, 0x0, 0x14400, 0xe, 0x3, 0x12000, 0x0, 0x0, 0x0
    .long 0x208000, 0x1a2100, 0x14400, 0x61a80, 0x200980, 0x120000, 0xde80, 0x14000, 0x0, 0x14400, 0xe, 0x3, 0x13000, 0x0, 0x0, 0x0
    .long 0x208000, 0x1a2100, 0x14400, 0x61a80, 0x201280, 0x140000, 0xff00, 0x14000, 0x0, 0x14400, 0xe, 0x3, 0x24400, 0x0, 0x0, 0x0
    .long 0x208000, 0x1a2100, 0x14400, 0x61a80, 0x200082, 0x0, 0x0, 0x14000, 0x0, 0x14400, 0x0, 0x3, 0x0, 0x0, 0x0, 0x0
    .long 0x208000, 0x1a2100, 0x14400, 0x61a80, 0x200084, 0x0, 0x0, 0x14000, 0x0, 0x14400, 0xe, 0x3, 0x0, 0x0, 0x0, 0x0
    .long 0x208000, 0x1a2100, 0x14400, 0x61a80, 0x200084, 0x0, 0x0, 0x14000, 0x0, 0x14400, 0xe, 0x3, 0x0, 0x0, 0x0, 0x0
    .long 0x208000, 0x1a2100, 0x14400, 0x61a80, 0x200084, 0x0, 0x0, 0x14000, 0x0, 0x14400, 0xe, 0x3, 0x0, 0x0, 0x0, 0x0
    .long 0x208000, 0x1a2100, 0x14400, 0x61a80, 0x200084, 0x0, 0x0, 0x14000, 0x0, 0x14400, 0xe, 0x3, 0x0, 0x0, 0x0, 0x0
    .long 0x208000, 0x1a2100, 0x14400, 0x61a80, 0x200080, 0x160000, 0xbe00, 0x14000, 0x0, 0x14400, 0xe, 0x3, 0x12000, 0x0, 0x0, 0x0
    .long 0x208000, 0x1a2100, 0x14400, 0x61a80, 0x200980, 0x180000, 0xde80, 0x14000, 0x0, 0x14400, 0xe, 0x3, 0x13000, 0x0, 0x0, 0x0
    .long 0x208000, 0x1a2100, 0x14400, 0x61a80, 0x201280, 0x1a0000, 0xff00, 0x14000, 0x0, 0x14400, 0xe, 0x3, 0x24400, 0x0, 0x0, 0x0
    .long 0x208000, 0x1a2100, 0x14400, 0x61a80, 0x200082, 0x0, 0x0, 0x14000, 0x0, 0x14400, 0x0, 0x3, 0x0, 0x0, 0x0, 0x0
    .long 0x208000, 0x1a2100, 0x14400, 0x61a80, 0x200084, 0x0, 0x0, 0x14000, 0x0, 0x14400, 0xe, 0x3, 0x0, 0x0, 0x0, 0x0
    .long 0x208000, 0x1a2100, 0x14400, 0x61a80, 0x200084, 0x0, 0x0, 0x14000, 0x0, 0x14400, 0xe, 0x3, 0x0, 0x0, 0x0, 0x0
    .long 0x208000, 0x1a2100, 0x14400, 0x61a80, 0x200084, 0x0, 0x0, 0x14000, 0x0, 0x14400, 0xe, 0x3, 0x0, 0x0, 0x0, 0x0
    .long 0x208000, 0x1a2100, 0x14400, 0x61a80, 0x200084, 0x0, 0x0, 0x14000, 0x0, 0x14400, 0xe, 0x3, 0x0, 0x0, 0x0, 0x0
    .long 0x682000, 0x132100, 0x14400, 0x61a80, 0x402000, 0x0, 0x1e280, 0x14000, 0x0, 0x14400, 0xa, 0x13, 0x0, 0x0, 0x0, 0x0
    .long 0x682000, 0x132100, 0x14400, 0x61a80, 0x402000, 0x20000, 0x20300, 0x14000, 0x0, 0x14400, 0xa, 0x13, 0x1000, 0x0, 0x0, 0x0
    .long 0x682000, 0x132100, 0x14400, 0x61a80, 0x402000, 0x40000, 0x22380, 0x14000, 0x0, 0x14400, 0xa, 0x13, 0x2000, 0x0, 0x0, 0x0
    .long 0x682000, 0x132100, 0x14400, 0x61a80, 0x402000, 0x60000, 0x24400, 0x14000, 0x0, 0x14400, 0xa, 0x13, 0x3000, 0x0, 0x0, 0x0
    .long 0x682000, 0x132100, 0x1, 0x61a80, 0x871841, 0x80000, 0x11f80, 0x14000, 0x0, 0x14400, 0x4, 0x40, 0x18100, 0x14000, 0x0, 0x1e680
    .long 0x682000, 0x132100, 0x1, 0x61a80, 0x8b1801, 0x80000, 0x11f80, 0x1c200, 0x8000, 0x15440, 0x3, 0x40, 0x18100, 0x4014000, 0x1e680, 0x1ea90
    .long 0x682000, 0x132100, 0x14400, 0x61a80, 0x892001, 0x80000, 0x11f80, 0x22380, 0xe000, 0x16070, 0x3, 0x13, 0x18100, 0x4014000, 0x1ea90, 0x0
    .long 0x682000, 0x132100, 0x14400, 0x61a80, 0x400005, 0x0, 0x0, 0x14000, 0x0, 0x14400, 0xa, 0x13, 0x0, 0x0, 0x0, 0x0
    .long 0x682000, 0x132100, 0x14400, 0x61a80, 0x402000, 0xa0000, 0x1e280, 0x14000, 0x0, 0x14400, 0xa, 0x13, 0x0, 0x0, 0x0, 0x0
    .long 0x682000, 0x132100, 0x14400, 0x61a80, 0x402000, 0xc0000, 0x20300, 0x14000, 0x0, 0x14400, 0xa, 0x13, 0x1000, 0x0, 0x0, 0x0
    .long 0x682000, 0x132100, 0x14400, 0x61a80, 0x402000, 0xe0000, 0x22380, 0x14000, 0x0, 0x14400, 0xa, 0x13, 0x2000, 0x0, 0x0, 0x0
    .long 0x682000, 0x132100, 0x14400, 0x61a80, 0x402000, 0x100000, 0x24400, 0x14000, 0x0, 0x14400, 0xa, 0x13, 0x3000, 0x0, 0x0, 0x0
    .long 0x682000, 0x132100, 0x1, 0x61a80, 0x871841, 0x120000, 0x11f80, 0x14000, 0x0, 0x14400, 0x4, 0x40, 0x18100, 0x14000, 0x0, 0x1e680
    .long 0x682000, 0x132100, 0x1, 0x61a80, 0x8b1801, 0x120000, 0x11f80, 0x1c200, 0x8000, 0x15440, 0x3, 0x40, 0x18100, 0x4014000, 0x1e680, 0x1ea90
    .long 0x682000, 0x132100, 0x14400, 0x61a80, 0x892001, 0x120000, 0x11f80, 0x22380, 0xe000, 0x16070, 0x3, 0x13, 0x18100, 0x4014000, 0x1ea90, 0x0
    .long 0x682000, 0x132100, 0x14400, 0x61a80, 0x400005, 0x0, 0x0, 0x14000, 0x0, 0x14400, 0xa, 0x13, 0x0, 0x0, 0x0, 0x0
    .long 0x57a000, 0x107100, 0x14400, 0x61a80, 0x202800, 0x0, 0x1e280, 0x14000, 0x0, 0x14400, 0x9, 0x8, 0x0, 0x0, 0x0, 0x0
    .long 0x57a000, 0x107100, 0x14400, 0x61a80, 0x202800, 0x20000, 0x20300, 0x14000, 0x0, 0x14400, 0x9, 0x8, 0x1000, 0x0, 0x0, 0x0
    .long 0x57a000, 0x107100, 0x14400, 0x61a80, 0x202800, 0x40000, 0x22380, 0x14000, 0x0, 0x14400, 0x9, 0x8, 0x2000, 0x0, 0x0, 0x0
    .long 0x57a000, 0x107100, 0x14400, 0x61a80, 0x202800, 0x60000, 0x24400, 0x14000, 0x0, 0x14400, 0x9, 0x8, 0x3000, 0x0, 0x0, 0x0
    .long 0x57a000, 0x107100, 0x1, 0x61a80, 0x872841, 0x80000, 0xff00, 0x14000, 0x0, 0x14400, 0x5, 0x40, 0x12000, 0x14000, 0x0, 0x1e680
    .long 0x57a000, 0x107100, 0x14400, 0x61a80, 0x852841, 0xa0000, 0x11f80, 0x14000, 0x0, 0x14400, 0x6, 0x40, 0x13000, 0x18100, 0x0, 0x1ea90
    .long 0x57a000, 0x107100, 0x1, 0x61a80, 0x8b2801, 0x80000, 0xff00, 0x1e280, 0xa000, 0x15850, 0x4, 0x8, 0x12000, 0x4014000, 0x1e680, 0x0
    .long 0x57a000, 0x107100, 0x14400, 0x61a80, 0x892806, 0xa0000, 0x11f80, 0x20300, 0xc000, 0x15c60, 0x3, 0x8, 0x13000, 0x5018100, 0x1ea90, 0x0
    .long 0x0, 0x120100, 0x14400, 0x61a80, 0x202000, 0x0, 0x1e280, 0x14000, 0x0, 0x14400, 0xa, 0x1, 0x0, 0x0, 0x0, 0x0
    .long 0x0, 0x120100, 0x14400, 0x61a80, 0x202000, 0x20000, 0x20300, 0x14000, 0x0, 0x14400, 0xa, 0x1, 0x1000, 0x0, 0x0, 0x0
    .long 0x0, 0x120100, 0x14400, 0x61a80, 0x202000, 0x40000, 0x22380, 0x14000, 0x0, 0x14400, 0xa, 0x1, 0x2000, 0x0, 0x0, 0x0
    .long 0x0, 0x120100, 0x14400, 0x61a80, 0x202000, 0x60000, 0x24400, 0x14000, 0x0, 0x14400, 0xa, 0x1, 0x3000, 0x0, 0x0, 0x0
    .long 0x0, 0x120100, 0x1, 0x61a80, 0x871841, 0x80000, 0x11f80, 0x14000, 0x0, 0x14400, 0x4, 0x40, 0x18100, 0x14000, 0x0, 0x1e680
    .long 0x0, 0x120100, 0x1, 0x61a80, 0x8b1801, 0x80000, 0x11f80, 0x1c200, 0x8000, 0x15440, 0x3, 0x40, 0x18100, 0x4014000, 0x1e680, 0x1ea90
    .long 0x0, 0x120100, 0x14400, 0x61a80, 0x892001, 0x80000, 0x11f80, 0x22380, 0xe000, 0x16070, 0x3, 0x1, 0x18100, 0x4014000, 0x1ea90, 0x0
    .long 0x0, 0x120100, 0x14400, 0x61a80, 0x200005, 0x0, 0x0, 0x14000, 0x0, 0x14400, 0xa, 0x1, 0x0, 0x0, 0x0, 0x0
    .long 0x0, 0x120100, 0x14400, 0x61a80, 0x202000, 0xa0000, 0x1e280, 0x14000, 0x0, 0x14400, 0xa, 0x1, 0x0, 0x0, 0x0, 0x0
    .long 0x0, 0x120100, 0x14400, 0x61a80, 0x202000, 0xc0000, 0x20300, 0x14000, 0x0, 0x14400, 0xa, 0x1, 0x1000, 0x0, 0x0, 0x0
    .long 0x0, 0x120100, 0x14400, 0x61a80, 0x202000, 0xe0000, 0x22380, 0x14000, 0x0, 0x14400, 0xa, 0x1, 0x2000, 0x0, 0x0, 0x0
    .long 0x0, 0x120100, 0x14400, 0x61a80, 0x202000, 0x100000, 0x24400, 0x14000, 0x0, 0x14400, 0xa, 0x1, 0x3000, 0x0, 0x0, 0x0
    .long 0x0, 0x120100, 0x1, 0x61a80, 0x871841, 0x120000, 0x11f80, 0x14000, 0x0, 0x14400, 0x4, 0x40, 0x18100, 0x14000, 0x0, 0x1e680
    .long 0x0, 0x120100, 0x1, 0x61a80, 0x8b1801, 0x120000, 0x11f80, 0x1c200, 0x8000, 0x15440, 0x3, 0x40, 0x18100, 0x4014000, 0x1e680, 0x1ea90
    .long 0x0, 0x120100, 0x14400, 0x61a80, 0x892001, 0x120000, 0x11f80, 0x22380, 0xe000, 0x16070, 0x3, 0x1, 0x18100, 0x4014000, 0x1ea90, 0x0
    .long 0x0, 0x120100, 0x14400, 0x61a80, 0x200005, 0x0, 0x0, 0x14000, 0x0, 0x14400, 0xa, 0x1, 0x0, 0x0, 0x0, 0x0
    .long 0x509000, 0x70100, 0x14400, 0x61a80, 0x403400, 0x0, 0x18100, 0x20300, 0xc000, 0x18500, 0x4, 0x11, 0x0, 0x0, 0x0, 0x0
    .long 0x509000, 0x70100, 0x14400, 0x61a80, 0x403400, 0x20000, 0x1a180, 0x20300, 0xc000, 0x18500, 0x4, 0x11, 0x1000, 0x0, 0x0, 0x0
    .long 0x509000, 0x70100, 0x14400, 0x61a80, 0x403400, 0x40000, 0x1c200, 0x20300, 0xc000, 0x18500, 0x4, 0x11, 0x2000, 0x0, 0x0, 0x0
    .long 0x509000, 0x70100, 0x14400, 0x61a80, 0x403400, 0x60000, 0x1e280, 0x20300, 0xc000, 0x18500, 0x4, 0x11, 0x3000, 0x0, 0x0, 0x0
    .long 0x57a000, 0x107100, 0x14c20, 0x61a80, 0x203441, 0xc0000, 0x4000, 0x14000, 0x0, 0x14400, 0x9, 0x8, 0x4000, 0x0, 0x0, 0x0
    .long 0x57a000, 0x107100, 0x14c20, 0x61a80, 0x203441, 0xe0000, 0x6080, 0x14000, 0x0, 0x14400, 0x9, 0x8, 0x5000, 0x0, 0x0, 0x0
    .long 0x57a000, 0x107100, 0x14c20, 0x61a80, 0x203441, 0x100000, 0x8100, 0x14000, 0x0, 0x14400, 0x9, 0x8, 0x6000, 0x0, 0x0, 0x0
    .long 0x57a000, 0x107100, 0x14400, 0x61a80, 0x200007, 0x0, 0x0, 0x14000, 0x0, 0x14400, 0x9, 0x8, 0x0, 0x0, 0x0, 0x0
    .long 0x3ab000, 0x15d100, 0x14400, 0x61a80, 0x400080, 0x0, 0xbe00, 0x14000, 0x0, 0x14400, 0xb, 0x1e, 0x12000, 0x0, 0x0, 0x0
    .long 0x3ab000, 0x15d100, 0x14400, 0x61a80, 0x400980, 0x20000, 0xde80, 0x14000, 0x0, 0x14400, 0xb, 0x1e, 0x13000, 0x0, 0x0, 0x0
    .long 0x3ab000, 0x15d100, 0x14400, 0x61a80, 0x401280, 0x40000, 0xff00, 0x14000, 0x0, 0x14400, 0xb, 0x1e, 0x24400, 0x0, 0x0, 0x0
    .long 0x3ab000, 0x15d100, 0x14400, 0x61a80, 0x401b80, 0x60000, 0x11f80, 0x14000, 0x0, 0x14400, 0xb, 0x1e, 0x25400, 0x0, 0x0, 0x0
    .long 0x3ab000, 0x15d100, 0x14400, 0x61a80, 0x400088, 0x0, 0x0, 0x14000, 0x0, 0x14400, 0xb, 0x1e, 0x0, 0x0, 0x0, 0x0
    .long 0x3ab000, 0x15d100, 0x14400, 0x61a80, 0x400088, 0x0, 0x0, 0x14000, 0x0, 0x14400, 0xb, 0x1e, 0x0, 0x0, 0x0, 0x0
    .long 0x3ab000, 0x15d100, 0x14400, 0x61a80, 0x400088, 0x0, 0x0, 0x14000, 0x0, 0x14400, 0xb, 0x1e, 0x0, 0x0, 0x0, 0x0
    .long 0x3ab000, 0x15d100, 0x14400, 0x61a80, 0x400088, 0x0, 0x0, 0x14000, 0x0, 0x14400, 0xb, 0x1e, 0x0, 0x0, 0x0, 0x0
    .long 0x3ab000, 0x15d100, 0x14400, 0x61a80, 0x400080, 0x80000, 0xbe00, 0x14000, 0x0, 0x14400, 0xb, 0x1e, 0x12000, 0x0, 0x0, 0x0
    .long 0x3ab000, 0x15d100, 0x14400, 0x61a80, 0x400980, 0xa0000, 0xde80, 0x14000, 0x0, 0x14400, 0xb, 0x1e, 0x13000, 0x0, 0x0, 0x0
    .long 0x3ab000, 0x15d100, 0x14400, 0x61a80, 0x401280, 0xc0000, 0xff00, 0x14000, 0x0, 0x14400, 0xb, 0x1e, 0x24400, 0x0, 0x0, 0x0
    .long 0x3ab000, 0x15d100, 0x14400, 0x61a80, 0x401b80, 0xe0000, 0x11f80, 0x14000, 0x0, 0x14400, 0xb, 0x1e, 0x25400, 0x0, 0x0, 0x0
    .long 0x3ab000, 0x15d100, 0x14400, 0x61a80, 0x400088, 0x0, 0x0, 0x14000, 0x0, 0x14400, 0xb, 0x1e, 0x0, 0x0, 0x0, 0x0
    .long 0x3ab000, 0x15d100, 0x14400, 0x61a80, 0x400088, 0x0, 0x0, 0x14000, 0x0, 0x14400, 0xb, 0x1e, 0x0, 0x0, 0x0, 0x0
    .long 0x3ab000, 0x15d100, 0x14400, 0x61a80, 0x400088, 0x0, 0x0, 0x14000, 0x0, 0x14400, 0xb, 0x1e, 0x0, 0x0, 0x0, 0x0
    .long 0x3ab000, 0x15d100, 0x14400, 0x61a80, 0x400088, 0x0, 0x0, 0x14000, 0x0, 0x14400, 0xb, 0x1e, 0x0, 0x0, 0x0, 0x0
    .long 0x3ab000, 0x15d100, 0x14400, 0x61a80, 0x400080, 0x100000, 0xbe00, 0x14000, 0x0, 0x14400, 0xb, 0x1e, 0x12000, 0x0, 0x0, 0x0
    .long 0x3ab000, 0x15d100, 0x14400, 0x61a80, 0x400980, 0x120000, 0xde80, 0x14000, 0x0, 0x14400, 0xb, 0x1e, 0x13000, 0x0, 0x0, 0x0
    .long 0x3ab000, 0x15d100, 0x14400, 0x61a80, 0x401280, 0x140000, 0xff00, 0x14000, 0x0, 0x14400, 0xb, 0x1e, 0x24400, 0x0, 0x0, 0x0
    .long 0x3ab000, 0x15d100, 0x14400, 0x61a80, 0x400082, 0x0, 0x0, 0x14000, 0x0, 0x14400, 0x0, 0x1e, 0x0, 0x0, 0x0, 0x0
    .long 0x3ab000, 0x15d100, 0x14400, 0x61a80, 0x400088, 0x0, 0x0, 0x14000, 0x0, 0x14400, 0xb, 0x1e, 0x0, 0x0, 0x0, 0x0
    .long 0x3ab000, 0x15d100, 0x14400, 0x61a80, 0x400088, 0x0, 0x0, 0x14000, 0x0, 0x14400, 0xb, 0x1e, 0x0, 0x0, 0x0, 0x0
    .long 0x3ab000, 0x15d100, 0x14400, 0x61a80, 0x400088, 0x0, 0x0, 0x14000, 0x0, 0x14400, 0xb, 0x1e, 0x0, 0x0, 0x0, 0x0
    .long 0x3ab000, 0x15d100, 0x14400, 0x61a80, 0x400088, 0x0, 0x0, 0x14000, 0x0, 0x14400, 0xb, 0x1e, 0x0, 0x0, 0x0, 0x0
    .long 0x7b5000, 0x12d100, 0x14400, 0x61a80, 0x402000, 0x0, 0x1e280, 0x14000, 0x0, 0x14400, 0xa, 0xe, 0x0, 0x0, 0x0, 0x0
    .long 0x7b5000, 0x12d100, 0x14400, 0x61a80, 0x402000, 0x20000, 0x20300, 0x14000, 0x0, 0x14400, 0xa, 0xe, 0x1000, 0x0, 0x0, 0x0
    .long 0x7b5000, 0x12d100, 0x14400, 0x61a80, 0x402000, 0x40000, 0x22380, 0x14000, 0x0, 0x14400, 0xa, 0xe, 0x2000, 0x0, 0x0, 0x0
    .long 0x7b5000, 0x12d100, 0x14400, 0x61a80, 0x402000, 0x60000, 0x24400, 0x14000, 0x0, 0x14400, 0xa, 0xe, 0x3000, 0x0, 0x0, 0x0
    .long 0x7b5000, 0x12d100, 0x1, 0x61a80, 0x871841, 0x80000, 0x11f80, 0x14000, 0x0, 0x14400, 0x4, 0x40, 0x18100, 0x14000, 0x0, 0x1e680
    .long 0x7b5000, 0x12d100, 0x1, 0x61a80, 0x8b1801, 0x80000, 0x11f80, 0x1c200, 0x8000, 0x15440, 0x3, 0x40, 0x18100, 0x4014000, 0x1e680, 0x1ea90
    .long 0x7b5000, 0x12d100, 0x14400, 0x61a80, 0x892001, 0x80000, 0x11f80, 0x22380, 0xe000, 0x16070, 0x3, 0xe, 0x18100, 0x4014000, 0x1ea90, 0x0
    .long 0x7b5000, 0x12d100, 0x14400, 0x61a80, 0x400005, 0x0, 0x0, 0x14000, 0x0, 0x14400, 0xa, 0xe, 0x0, 0x0, 0x0, 0x0
    .long 0x7b5000, 0x12d100, 0x14400, 0x61a80, 0x402000, 0xa0000, 0x1e280, 0x14000, 0x0, 0x14400, 0xa, 0xe, 0x0, 0x0, 0x0, 0x0
    .long 0x7b5000, 0x12d100, 0x14400, 0x61a80, 0x402000, 0xc0000, 0x20300, 0x14000, 0x0, 0x14400, 0xa, 0xe, 0x1000, 0x0, 0x0, 0x0
    .long 0x7b5000, 0x12d100, 0x14400, 0x61a80, 0x402000, 0xe0000, 0x22380, 0x14000, 0x0, 0x14400, 0xa, 0xe, 0x2000, 0x0, 0x0, 0x0
    .long 0x7b5000, 0x12d100, 0x14400, 0x61a80, 0x402000, 0x100000, 0x24400, 0x14000, 0x0, 0x14400, 0xa, 0xe, 0x3000, 0x0, 0x0, 0x0
    .long 0x7b5000, 0x12d100, 0x1, 0x61a80, 0x871841, 0x120000, 0x11f80, 0x14000, 0x0, 0x14400, 0x4, 0x40, 0x18100, 0x14000, 0x0, 0x1e680
    .long 0x7b5000, 0x12d100, 0x1, 0x61a80, 0x8b1801, 0x120000, 0x11f80, 0x1c200, 0x8000, 0x15440, 0x3, 0x40, 0x18100, 0x4014000, 0x1e680, 0x1ea90
    .long 0x7b5000, 0x12d100, 0x14400, 0x61a80, 0x892001, 0x120000, 0x11f80, 0x22380, 0xe000, 0x16070, 0x3, 0xe, 0x18100, 0x4014000, 0x1ea90, 0x0
    .long 0x7b5000, 0x12d100, 0x14400, 0x61a80, 0x400005, 0x0, 0x0, 0x14000, 0x0, 0x14400, 0xa, 0xe, 0x0, 0x0, 0x0, 0x0
.size L_table, .-L_table
.type L_padding,@object
L_padding:
    .fill 8192, 4, 0
.size L_padding, .-L_padding
.section .rodata,"a"
.p2align 6
.amdhsa_kernel standalone__varlen_attn_packed__ragged_kernel
  .amdhsa_next_free_vgpr 256
  .amdhsa_next_free_sgpr 102
  .amdhsa_accum_offset 256
  .amdhsa_group_segment_fixed_size 0
  .amdhsa_kernarg_size 56
  .amdhsa_user_sgpr_count 2
  .amdhsa_user_sgpr_kernarg_segment_ptr 1
  .amdhsa_system_sgpr_workgroup_id_x 1
.end_amdhsa_kernel
```
